```python
import torch

def _softmax(x, axis=-1):
    return torch.softmax(x, dim=axis)

def _gelu(x):
    return torch.nn.functional.gelu(x, approximate='tanh')

def _silu(x):
    return torch.nn.functional.silu(x)

def _sigmoid(x):
    return torch.sigmoid(x)

def _layernorm(x, axis=-1, eps=1e-05):
    m = x.mean(dim=axis, keepdim=True)
    v = x.var(dim=axis, keepdim=True, unbiased=False)
    return (x - m) / torch.sqrt(v + eps)

def _scatter_add(tgt, idx, src, axis=0):
    return tgt.clone().index_add_(axis, idx, src)

def _segment_sum(src, seg, n):
    out = torch.zeros((n,) + src.shape[1:], dtype=src.dtype)
    return out.index_add_(0, seg, src)

def _pad(x, pw):
    flat = tuple((v for pair in reversed(pw) for v in pair))
    return torch.nn.functional.pad(x, flat)
kernel_name = 'adaLN_cond__mha_block__glu_gated_geglu__prompt'

def setup_inputs():

    _w = lambda a: (lambda t: t.to(torch.bfloat16) if t.is_floating_point() else t)(torch.as_tensor(a))

    def _A_setup():
        B, S, D, H = (1, 2048, 448, 16)
        return {'x': _w((lambda *s: torch.randn(*s, dtype=torch.bfloat16) * 0.05)(B, S, D)), 'wqkv': _w((lambda *s: torch.randn(*s, dtype=torch.bfloat16) * 0.05)(D, 3 * D)), 'wo': _w((lambda *s: torch.randn(*s, dtype=torch.bfloat16) * 0.05)(D, D))}
    _A_in = _A_setup()

    def _B_setup():
        B, S, Dm, Df = (1, 2048, 448, 1792)
        return {'x': _w((lambda *s: torch.randn(*s, dtype=torch.bfloat16) * 0.05)(B, S, Dm)), 'w_gate': _w((lambda *s: torch.randn(*s, dtype=torch.bfloat16) * 0.8)(Dm, Df) * Dm ** (-0.5)), 'w_up': _w((lambda *s: torch.randn(*s, dtype=torch.bfloat16) * 0.8)(Dm, Df) * Dm ** (-0.5)), 'w_down': _w((lambda *s: torch.randn(*s, dtype=torch.bfloat16) * 0.8)(Df, Dm) * Df ** (-0.5))}
    _B_in = _B_setup()
    return {'A_x': _A_in['x'], 'A_wqkv': _A_in['wqkv'], 'A_wo': _A_in['wo'], 'B_x': _B_in['x'], 'B_w_gate': _B_in['w_gate'], 'B_w_up': _B_in['w_up'], 'B_w_down': _B_in['w_down'], 'c': _w((lambda *s: torch.randn(*s, dtype=torch.bfloat16) * 0.1)(1, 448) * 8.0), 'w_mod': _w((lambda *s: torch.randn(*s, dtype=torch.bfloat16) * 0.1)(448, 6 * 448) * 448 ** (-0.5) * 8.0)}

def reference(A_x, A_wqkv, A_wo, B_x, B_w_gate, B_w_up, B_w_down, c, w_mod):

    def _A_ref(x, wqkv, wo):
        B, S, D = x.shape
        H = 16
        Dh = D // H
        qkv = (lambda x, *d: x.permute(*d))((x @ wqkv).reshape(B, S, 3, H, Dh), 2, 0, 3, 1, 4)
        q, k, v = (qkv[0], qkv[1], qkv[2])
        scores = torch.einsum('bhqd,bhkd->bhqk', q, k) * Dh ** (-0.5)
        p = _softmax(scores, axis=-1)
        o = torch.einsum('bhqk,bhkd->bhqd', p, v)
        return (lambda x, *d: x.permute(*d))(o, 0, 2, 1, 3).reshape(B, S, D) @ wo

    def _B_ref(x, w_gate, w_up, w_down):
        g = torch.einsum('bsd,df->bsf', x, w_gate)
        u = torch.einsum('bsd,df->bsf', x, w_up)
        h = _gelu(g) * u
        return torch.einsum('bsf,fd->bsd', h, w_down)
    x = A_x
    mod = (_silu(c) @ w_mod).reshape(c.shape[0], 6, 1, -1)
    sa, ca, ga, sb, cb, gb = (mod[:, 0].clone(), mod[:, 1].clone(), mod[:, 2].clone(), mod[:, 3].clone(), mod[:, 4].clone(), mod[:, 5].clone())
    h = _layernorm(x, axis=-1) * (1 + ca) + sa
    x = x + ga * _A_ref(h, A_wqkv, A_wo)
    h = _layernorm(x, axis=-1) * (1 + cb) + sb
    x = x + gb * _B_ref(h, B_w_gate, B_w_up, B_w_down)
    return x
```

```asm
; @launch grid=(256,1,1) block=(256,1,1) lds=163840
.amdgcn_target "amdgcn-amd-amdhsa--gfx950"
.text
.globl adaLN_cond__mha_block__glu_gated_geglu__prompt_kernel
.p2align 8
.type adaLN_cond__mha_block__glu_gated_geglu__prompt_kernel,@function
adaLN_cond__mha_block__glu_gated_geglu__prompt_kernel:
    s_cmp_ge_u32 s2, 256
    s_cbranch_scc1 L_END0
    s_load_dwordx16 s[16:31], s[0:1], 0
    s_load_dwordx8 s[32:39], s[0:1], 64
    v_and_b32 v1, 63, v0
    v_lshrrev_b32 v2, 6, v0
    s_and_b32 s12, s2, 7
    s_lshr_b32 s13, s2, 3
    v_readfirstlane_b32 s4, v2
    s_and_b32 s5, s12, 3
    s_lshl_b32 s5, s5, 2
    s_and_b32 s58, s13, 3
    s_add_u32 s5, s5, s58
    s_lshr_b32 s6, s12, 2
    s_lshl_b32 s6, s6, 3
    s_lshr_b32 s14, s13, 2
    s_add_u32 s6, s6, s14
    s_mov_b32 s56, 0xffff0000
    v_lshlrev_b32 v15, 4, v1
    v_lshlrev_b32 v16, 2, v1
    v_mov_b32 v21, 0
    s_mul_i32 s57, s12, 7
    s_add_u32 s57, s57, s14
    s_and_b32 s59, s57, 3
    s_lshr_b32 s57, s57, 2
    s_lshl_b32 s57, s57, 2
    s_add_u32 s57, s57, s58
    v_min_u32 v4, 223, v0
    v_and_b32 v5, 1, v4
    v_lshrrev_b32 v4, 1, v4
    v_lshlrev_b32 v5, 4, v5
    s_movk_i32 s9, 5376
    v_mad_u32_u24 v255, v4, s9, v5
    v_lshlrev_b32 v7, 1, v4
    s_mul_i32 s72, s59, 602112
    s_lshl_b32 s9, s57, 5
    s_add_u32 s72, s72, s9
    s_mul_i32 s73, s59, 224
    s_cmp_lt_u32 s14, 7
    s_cselect_b32 s72, s72, 2147418112
    s_mul_i32 s61, s4, 28672
    s_lshl_b32 s9, s14, 1
    s_add_u32 s62, s9, 0
    s_and_b32 s62, s62, 7
    v_xor_b32 v32, s62, v1
    v_lshlrev_b32 v32, 4, v32
    s_add_u32 s62, s9, 1
    s_and_b32 s62, s62, 7
    v_xor_b32 v33, s62, v1
    v_lshlrev_b32 v33, 4, v33
    s_add_u32 s62, s9, 2
    s_and_b32 s62, s62, 7
    v_xor_b32 v34, s62, v1
    v_lshlrev_b32 v34, 4, v34
    s_add_u32 s62, s9, 3
    s_and_b32 s62, s62, 7
    v_xor_b32 v35, s62, v1
    v_lshlrev_b32 v35, 4, v35
    s_add_u32 s62, s9, 4
    s_and_b32 s62, s62, 7
    v_xor_b32 v36, s62, v1
    v_lshlrev_b32 v36, 4, v36
    s_add_u32 s62, s9, 5
    s_and_b32 s62, s62, 7
    v_xor_b32 v37, s62, v1
    v_lshlrev_b32 v37, 4, v37
    s_add_u32 s62, s9, 6
    s_and_b32 s62, s62, 7
    v_xor_b32 v38, s62, v1
    v_lshlrev_b32 v38, 4, v38
    s_add_u32 s62, s9, 7
    s_and_b32 s62, s62, 7
    v_xor_b32 v39, s62, v1
    v_lshlrev_b32 v39, 4, v39
    s_lshl_b32 s60, s5, 2
    s_add_u32 s60, s60, s4
    s_mul_i32 s60, s60, 28672
    v_lshrrev_b32 v2, 2, v1
    v_and_b32 v3, 3, v1
    s_movk_i32 s9, 2688
    v_lshlrev_b32 v4, 7, v3
    v_mad_u32_u24 v42, v2, s9, v4
    v_lshlrev_b32 v4, 4, v3
    v_mad_u32_u24 v40, v2, s9, v4
    s_mul_i32 s63, s13, 37632
    s_mul_i32 s9, s4, 896
    s_add_u32 s63, s63, s9
    s_lshr_b32 s9, s12, 2
    s_mul_i32 s9, s9, 384
    s_add_u32 s63, s63, s9
    s_mov_b32 s46, 2408448
    s_mov_b32 s47, 0x20000
    s_mov_b32 s50, 896
    s_mov_b32 s51, 0x20000
    s_mov_b32 s54, 1835008
    s_mov_b32 s55, 0x20000
    s_mov_b32 s70, 1204224
    s_mov_b32 s71, 0x20000
    s_mov_b32 s42, 268435456
    s_mov_b32 s43, 0x20000
    s_mul_i32 s62, s14, 3584
    s_add_u32 m0, s62, s61
    s_add_u32 s67, s62, s60
    s_waitcnt lgkmcnt(0)
    s_load_dword s3, s[38:39], 0
    s_mov_b64 s[44:45], s[32:33]
    s_mov_b64 s[48:49], s[30:31]
    s_mov_b64 s[52:53], s[16:17]
    buffer_load_dwordx4 v[240:243], v255, s[44:47], s72 offen
    buffer_load_ushort v252, v7, s[48:51], s73 offen
    s_mov_b32 exec_lo, 0xffffffff
    s_mov_b32 exec_hi, 0xffffff
    buffer_load_dwordx4 v32, s[52:55], s67 offen offset:0 lds
    buffer_load_dwordx4 v32, s[52:55], s67 offen offset:896 lds
    buffer_load_dwordx4 v33, s[52:55], s67 offen offset:1792 lds
    buffer_load_dwordx4 v33, s[52:55], s67 offen offset:2688 lds
    s_mov_b64 s[68:69], s[18:19]
    s_mov_b64 s[40:41], s[38:39]
    s_cmp_eq_u32 s4, 3
    s_cbranch_scc1 L_CPF
    buffer_load_dword v19, v42, s[68:71], s63 offen
    s_branch L_CPF2
L_CPF:
    s_getpc_b64 s[10:11]
L_PC:
    s_lshl_b32 s9, s13, 13
    s_mov_b64 exec, -1
    v_lshl_add_u32 v3, v1, 7, s9
    v_min_u32 v3, L_CODE_END-L_PC-4, v3
    global_load_dword v19, v3, s[10:11]
    s_mov_b32 exec_lo, 0xffffffff
    s_mov_b32 exec_hi, 0xffffff
L_CPF2:
    s_getpc_b64 s[100:101]
L_PC2:
    s_add_u32 s62, s14, 1
    s_and_b32 s62, s62, 7
    s_mul_i32 s62, s62, 3584
    s_add_u32 m0, s62, s61
    s_add_u32 s67, s62, s60
    buffer_load_dwordx4 v34, s[52:55], s67 offen offset:0 lds
    buffer_load_dwordx4 v34, s[52:55], s67 offen offset:896 lds
    buffer_load_dwordx4 v35, s[52:55], s67 offen offset:1792 lds
    buffer_load_dwordx4 v35, s[52:55], s67 offen offset:2688 lds
    s_mov_b64 exec, -1
    v_and_b32 v2, 31, v1
    v_lshrrev_b32 v3, 5, v1
    v_bfe_u32 v4, v1, 1, 3
    s_movk_i32 s9, 896
    v_mul_lo_u32 v5, v2, s9
    v_add_u32 v5, s61, v5
    v_add_u32 v44, 0, v3
    v_xor_b32 v44, v44, v4
    v_lshl_add_u32 v44, v44, 4, v5
    v_add_u32 v45, 2, v3
    v_xor_b32 v45, v45, v4
    v_lshl_add_u32 v45, v45, 4, v5
    v_add_u32 v46, 4, v3
    v_xor_b32 v46, v46, v4
    v_lshl_add_u32 v46, v46, 4, v5
    v_add_u32 v47, 6, v3
    v_xor_b32 v47, v47, v4
    v_lshl_add_u32 v47, v47, 4, v5
    v_bfe_u32 v4, v1, 2, 2
    v_lshl_add_u32 v4, v3, 3, v4
    v_lshlrev_b32 v48, 6, v4
    v_bfe_u32 v4, v1, 4, 1
    v_lshl_add_u32 v48, v4, 5, v48
    v_and_b32 v4, 3, v1
    v_lshl_add_u32 v48, v4, 3, v48
    s_cmp_eq_u32 s6, 15
    s_cselect_b32 s9, 8, 0
    v_add_u32 v48, s9, v48
    v_add_u32 v50, 57344, v48
    v_add_u32 v51, 114688, v48
    v_lshlrev_b32 v49, 5, v3
    v_add_u32 v49, 153088, v49
    v_cmp_lt_u32 vcc, 111, v0
    s_nop 1
    v_cndmask_b32_e64 v20, 0, 1.0, vcc
    v_min_u32 v17, 223, v0
    v_lshlrev_b32 v17, 4, v17
    v_add_u32 v28, 153088, v17
    s_mov_b32 s86, 327680
    s_mov_b32 s87, 334848
    s_mov_b32 s76, 0x0c04000c
    s_mov_b32 s77, 0x0402010c
    s_sub_u32 s9, s2, 196
    s_mov_b32 s98, 1605632
    s_movk_i32 s10, 896
    s_mov_b32 s11, 57344
    s_mov_b32 s79, 57344
    s_cmp_lt_u32 s2, 196
    s_cselect_b32 s9, s2, s9
    s_cselect_b64 s[96:97], s[24:25], s[28:29]
    s_cselect_b64 s[48:49], s[26:27], s[28:29]
    s_cselect_b32 s98, 1605632, s98
    s_cselect_b32 s10, 3584, s10
    s_cselect_b32 s11, 57344, s11
    s_cselect_b32 s79, 53248, s79
    s_mov_b32 s50, s98
    s_mov_b32 s99, 0x20000
    s_mul_i32 s80, s9, 9363
    s_lshr_b32 s80, s80, 16
    s_mul_i32 s81, s80, 7
    s_sub_u32 s81, s9, s81
    s_lshl_b32 s81, s81, 2
    s_add_u32 s81, s81, s4
    s_mul_i32 s82, s81, s11
    s_lshl_b32 s9, s80, 7
    s_add_u32 s82, s82, s9
    s_add_u32 s79, s79, s9
    s_lshl_b32 s9, s81, 2
    s_add_u32 s79, s79, s9
    v_lshrrev_b32 v2, 3, v1
    v_and_b32 v3, 7, v1
    v_lshlrev_b32 v3, 4, v3
    v_mad_u32_u24 v41, v2, s10, v3
    s_lshl_b32 s83, s10, 3
    s_add_u32 s75, s61, 14336
    s_cmp_lt_u32 s2, 245
    s_cselect_b32 s79, s79, 2147418112
    s_cselect_b32 s82, s82, 2147418112
    s_lshl_b32 s9, s83, 1
    s_add_u32 s84, s82, s9
    s_add_u32 s85, s84, s9
    s_cmp_lt_u32 s2, 196
    s_cselect_b32 s84, s82, s84
    s_cselect_b32 s85, 2147418112, s85
    s_lshl_b32 s9, s13, 2
    s_add_u32 s9, s9, s4
    s_mul_i32 s9, s9, 25
    v_min_u32 v43, 24, v1
    v_add_lshl_u32 v43, v43, s9, 7
    s_mov_b64 exec, -1
    v_and_b32 v2, 1, v1
    v_lshlrev_b32 v2, 9, v2
    v_lshrrev_b32 v3, 4, v0
    v_lshl_add_u32 v2, v3, 2, v2
    v_add_u32 v253, 150528, v2
    v_and_b32 v2, 15, v1
    v_lshlrev_b32 v2, 6, v2
    v_add_u32 v254, 150528, v2
    v_cmp_gt_u32 vcc, 224, v0
    s_mul_i32 s74, s59, 3584
    s_lshl_b32 s9, s57, 6
    s_add_u32 s74, s74, s9
    s_add_u32 s74, s74, 327680
    s_waitcnt lgkmcnt(0)
    s_add_u32 s65, s3, 1
    s_mul_i32 s3, s3, 0x9E3779B1
    s_xor_b32 s3, s3, 0x5BD1E995
    v_mov_b32 v22, s3
    s_cmp_ge_u32 s14, 7
    s_cbranch_scc1 L_NOMOD
    s_waitcnt vmcnt(9)
    v_lshlrev_b32 v252, 16, v252
    v_mul_f32 v2, 0xbfb8aa3b, v252
    v_exp_f32 v2, v2
    s_nop 0
    v_add_f32 v2, 1.0, v2
    v_rcp_f32 v2, v2
    s_nop 0
    v_mul_f32 v252, v252, v2
    v_cvt_pk_bf16_f32 v252, v252, v252
    v_and_b32 v252, s56, v252
    v_cndmask_b32 v252, 0, v252, vcc
    v_lshlrev_b32 v244, 16, v240
    v_and_b32 v245, s56, v240
    v_lshlrev_b32 v246, 16, v241
    v_and_b32 v247, s56, v241
    v_lshlrev_b32 v248, 16, v242
    v_and_b32 v249, s56, v242
    v_lshlrev_b32 v250, 16, v243
    v_and_b32 v251, s56, v243
    v_mul_f32 v244, v244, v252
    v_mul_f32 v245, v245, v252
    v_mul_f32 v246, v246, v252
    v_mul_f32 v247, v247, v252
    v_mul_f32 v248, v248, v252
    v_mul_f32 v249, v249, v252
    v_mul_f32 v250, v250, v252
    v_mul_f32 v251, v251, v252
    v_add_f32_dpp v244, v244, v244 row_shr:2 row_mask:0xf bank_mask:0xf
    v_add_f32_dpp v245, v245, v245 row_shr:2 row_mask:0xf bank_mask:0xf
    v_add_f32_dpp v246, v246, v246 row_shr:2 row_mask:0xf bank_mask:0xf
    v_add_f32_dpp v247, v247, v247 row_shr:2 row_mask:0xf bank_mask:0xf
    v_add_f32_dpp v248, v248, v248 row_shr:2 row_mask:0xf bank_mask:0xf
    v_add_f32_dpp v249, v249, v249 row_shr:2 row_mask:0xf bank_mask:0xf
    v_add_f32_dpp v250, v250, v250 row_shr:2 row_mask:0xf bank_mask:0xf
    v_add_f32_dpp v251, v251, v251 row_shr:2 row_mask:0xf bank_mask:0xf
    v_add_f32_dpp v244, v244, v244 row_shr:4 row_mask:0xf bank_mask:0xf
    v_add_f32_dpp v245, v245, v245 row_shr:4 row_mask:0xf bank_mask:0xf
    v_add_f32_dpp v246, v246, v246 row_shr:4 row_mask:0xf bank_mask:0xf
    v_add_f32_dpp v247, v247, v247 row_shr:4 row_mask:0xf bank_mask:0xf
    v_add_f32_dpp v248, v248, v248 row_shr:4 row_mask:0xf bank_mask:0xf
    v_add_f32_dpp v249, v249, v249 row_shr:4 row_mask:0xf bank_mask:0xf
    v_add_f32_dpp v250, v250, v250 row_shr:4 row_mask:0xf bank_mask:0xf
    v_add_f32_dpp v251, v251, v251 row_shr:4 row_mask:0xf bank_mask:0xf
    v_add_f32_dpp v244, v244, v244 row_shr:8 row_mask:0xf bank_mask:0xf
    v_add_f32_dpp v245, v245, v245 row_shr:8 row_mask:0xf bank_mask:0xf
    v_add_f32_dpp v246, v246, v246 row_shr:8 row_mask:0xf bank_mask:0xf
    v_add_f32_dpp v247, v247, v247 row_shr:8 row_mask:0xf bank_mask:0xf
    v_add_f32_dpp v248, v248, v248 row_shr:8 row_mask:0xf bank_mask:0xf
    v_add_f32_dpp v249, v249, v249 row_shr:8 row_mask:0xf bank_mask:0xf
    v_add_f32_dpp v250, v250, v250 row_shr:8 row_mask:0xf bank_mask:0xf
    v_add_f32_dpp v251, v251, v251 row_shr:8 row_mask:0xf bank_mask:0xf
    s_mov_b32 exec_lo, 0xc000c000
    s_mov_b32 exec_hi, 0xc000c000
    ds_write_b32 v253, v244 offset:1024
    ds_write_b32 v253, v245 offset:1088
    ds_write_b32 v253, v246 offset:1152
    ds_write_b32 v253, v247 offset:1216
    ds_write_b32 v253, v248 offset:1280
    ds_write_b32 v253, v249 offset:1344
    ds_write_b32 v253, v250 offset:1408
    ds_write_b32 v253, v251 offset:1472
    s_mov_b64 exec, -1
    s_waitcnt lgkmcnt(0)
    s_barrier
    s_cmp_lg_u32 s4, 0
    s_cbranch_scc1 L_NOMOD
    ds_read_b128 v[224:227], v254 offset:1024
    ds_read_b128 v[228:231], v254 offset:1040
    ds_read_b128 v[232:235], v254 offset:1056
    ds_read_b128 v[236:239], v254 offset:1072
    s_mov_b32 s9, 0x07060501
    s_mov_b32 s10, 0x07060502
    s_mov_b32 s11, 0x07060503
    s_waitcnt lgkmcnt(0)
    v_add_f32 v224, v224, v232
    v_add_f32 v225, v225, v233
    v_add_f32 v226, v226, v234
    v_add_f32 v227, v227, v235
    v_add_f32 v228, v228, v236
    v_add_f32 v229, v229, v237
    v_add_f32 v230, v230, v238
    v_add_f32 v231, v231, v239
    v_add_f32 v224, v224, v228
    v_add_f32 v225, v225, v229
    v_add_f32 v226, v226, v230
    v_add_f32 v227, v227, v231
    v_add_f32 v224, v224, v226
    v_add_f32 v225, v225, v227
    v_add_f32 v224, v224, v225
    s_nop 1
    v_mov_b32_dpp v225, v224 quad_perm:[1,1,1,1] row_mask:0xf bank_mask:0xf
    v_mov_b32_dpp v226, v224 quad_perm:[2,2,2,2] row_mask:0xf bank_mask:0xf
    v_mov_b32_dpp v228, v224 quad_perm:[3,3,3,3] row_mask:0xf bank_mask:0xf
    v_mov_b32 v227, s3
    v_perm_b32 v224, v224, v228, s9
    v_perm_b32 v225, v225, v228, s10
    v_perm_b32 v226, v226, v228, s11
    s_mov_b64 exec, 0x1111
    buffer_store_dwordx4 v[224:227], v16, s[40:43], s74 offen sc1
    s_mov_b64 exec, -1
L_NOMOD:
    s_mov_b32 exec_lo, 0xffffffff
    s_mov_b32 exec_hi, 0xffffff
    s_add_u32 s62, s14, 2
    s_and_b32 s62, s62, 7
    s_mul_i32 s62, s62, 3584
    s_add_u32 m0, s62, s61
    s_add_u32 s67, s62, s60
    buffer_load_dwordx4 v36, s[52:55], s67 offen offset:0 lds
    buffer_load_dwordx4 v36, s[52:55], s67 offen offset:896 lds
    buffer_load_dwordx4 v37, s[52:55], s67 offen offset:1792 lds
    buffer_load_dwordx4 v37, s[52:55], s67 offen offset:2688 lds
    s_add_u32 s62, s14, 3
    s_and_b32 s62, s62, 7
    s_mul_i32 s62, s62, 3584
    s_add_u32 m0, s62, s61
    s_add_u32 s67, s62, s60
    buffer_load_dwordx4 v38, s[52:55], s67 offen offset:0 lds
    buffer_load_dwordx4 v38, s[52:55], s67 offen offset:896 lds
    buffer_load_dwordx4 v39, s[52:55], s67 offen offset:1792 lds
    buffer_load_dwordx4 v39, s[52:55], s67 offen offset:2688 lds
    s_add_u32 s62, s14, 4
    s_and_b32 s62, s62, 7
    s_mul_i32 s62, s62, 3584
    s_add_u32 m0, s62, s61
    s_add_u32 s67, s62, s60
    buffer_load_dwordx4 v32, s[52:55], s67 offen offset:0 lds
    buffer_load_dwordx4 v32, s[52:55], s67 offen offset:896 lds
    buffer_load_dwordx4 v33, s[52:55], s67 offen offset:1792 lds
    buffer_load_dwordx4 v33, s[52:55], s67 offen offset:2688 lds
    s_add_u32 s62, s14, 5
    s_and_b32 s62, s62, 7
    s_mul_i32 s62, s62, 3584
    s_add_u32 m0, s62, s61
    s_add_u32 s67, s62, s60
    buffer_load_dwordx4 v34, s[52:55], s67 offen offset:0 lds
    buffer_load_dwordx4 v34, s[52:55], s67 offen offset:896 lds
    buffer_load_dwordx4 v35, s[52:55], s67 offen offset:1792 lds
    buffer_load_dwordx4 v35, s[52:55], s67 offen offset:2688 lds
    s_add_u32 s62, s14, 6
    s_and_b32 s62, s62, 7
    s_mul_i32 s62, s62, 3584
    s_add_u32 m0, s62, s61
    s_add_u32 s67, s62, s60
    buffer_load_dwordx4 v36, s[52:55], s67 offen offset:0 lds
    buffer_load_dwordx4 v36, s[52:55], s67 offen offset:896 lds
    buffer_load_dwordx4 v37, s[52:55], s67 offen offset:1792 lds
    buffer_load_dwordx4 v37, s[52:55], s67 offen offset:2688 lds
    s_mov_b64 exec, -1
    buffer_load_dwordx4 v[176:179], v17, s[40:43], s86 offen offset:0 sc1
    buffer_load_dwordx4 v[180:183], v17, s[40:43], s86 offen offset:3584 sc1
    buffer_load_dwordx4 v[184:187], v17, s[40:43], s87 offen offset:0 sc1
    buffer_load_dwordx4 v[188:191], v17, s[40:43], s87 offen offset:3584 sc1
    s_mov_b32 exec_lo, 0xffffffff
    s_mov_b32 exec_hi, 0xffffff
    s_add_u32 s62, s14, 7
    s_and_b32 s62, s62, 7
    s_mul_i32 s62, s62, 3584
    s_add_u32 m0, s62, s61
    s_add_u32 s67, s62, s60
    buffer_load_dwordx4 v38, s[52:55], s67 offen offset:0 lds
    buffer_load_dwordx4 v38, s[52:55], s67 offen offset:896 lds
    buffer_load_dwordx4 v39, s[52:55], s67 offen offset:1792 lds
    buffer_load_dwordx4 v39, s[52:55], s67 offen offset:2688 lds
    s_mov_b64 exec, -1
    s_mul_i32 s62, s6, 56
    s_mul_i32 s9, s4, 43008
    s_add_u32 s62, s62, s9
    s_cmp_eq_u32 s6, 15
    s_cselect_b32 s9, 8, 0
    s_sub_u32 s62, s62, s9
    s_lshl_b32 s63, s4, 10
    s_mov_b32 s9, 0
    s_waitcnt vmcnt(4)
    s_branch L_MP1C
L_MP1:
    buffer_load_dwordx4 v[176:179], v17, s[40:43], s86 offen offset:0 sc1
    buffer_load_dwordx4 v[180:183], v17, s[40:43], s86 offen offset:3584 sc1
    buffer_load_dwordx4 v[184:187], v17, s[40:43], s87 offen offset:0 sc1
    buffer_load_dwordx4 v[188:191], v17, s[40:43], s87 offen offset:3584 sc1
    s_add_u32 s9, s9, 1
    s_cmp_gt_u32 s9, 0x8000
    s_cbranch_scc1 L_ABORT
    s_waitcnt vmcnt(0)
L_MP1C:
    v_xor_b32 v179, s3, v179
    v_xor_b32 v183, s3, v183
    v_xor_b32 v187, s3, v187
    v_xor_b32 v191, s3, v191
    v_or3_b32 v179, v179, v183, v187
    v_or_b32 v179, v179, v191
    v_cmp_ne_u32 vcc, 0, v179
    s_cbranch_vccnz L_MP1
    v_perm_b32 v179, v177, v176, s76
    v_perm_b32 v179, v178, v179, s77
    v_perm_b32 v183, v181, v180, s76
    v_perm_b32 v183, v182, v183, s77
    v_perm_b32 v187, v185, v184, s76
    v_perm_b32 v187, v186, v187, s77
    v_perm_b32 v191, v189, v188, s76
    v_perm_b32 v191, v190, v191, s77
    v_add_f32 v176, v176, v180
    v_add_f32 v184, v184, v188
    v_add_f32 v177, v177, v181
    v_add_f32 v185, v185, v189
    v_add_f32 v178, v178, v182
    v_add_f32 v186, v186, v190
    v_add_f32 v179, v179, v183
    v_add_f32 v187, v187, v191
    v_add_f32 v176, v176, v184
    v_add_f32 v177, v177, v185
    v_add_f32 v178, v178, v186
    v_add_f32 v179, v179, v187
    v_cvt_pk_bf16_f32 v176, v176, v177
    v_cvt_pk_bf16_f32 v177, v178, v179
    v_lshlrev_b32 v24, 16, v176
    v_and_b32 v25, s56, v176
    v_lshlrev_b32 v26, 16, v177
    v_and_b32 v27, s56, v177
    v_add_f32 v24, v24, v20
    v_add_f32 v25, v25, v20
    v_add_f32 v26, v26, v20
    v_add_f32 v27, v27, v20
    v_cvt_pk_bf16_f32 v176, v24, v25
    v_cvt_pk_bf16_f32 v177, v26, v27
    v_lshlrev_b32 v24, 16, v176
    v_and_b32 v25, s56, v176
    v_lshlrev_b32 v26, 16, v177
    v_and_b32 v27, s56, v177
    ds_write_b128 v28, v[24:27]
    s_add_u32 m0, s63, 114688
    s_add_u32 s64, s62, 0
    buffer_load_dwordx4 v40, s[68:71], s64 offen lds
    s_add_u32 m0, s63, 118784
    s_add_u32 s64, s62, 896
    buffer_load_dwordx4 v40, s[68:71], s64 offen lds
    s_add_u32 m0, s63, 122880
    s_add_u32 s64, s62, 1792
    buffer_load_dwordx4 v40, s[68:71], s64 offen lds
    s_add_u32 m0, s63, 126976
    s_add_u32 s64, s62, 172032
    buffer_load_dwordx4 v40, s[68:71], s64 offen lds
    s_add_u32 m0, s63, 131072
    s_add_u32 s64, s62, 172928
    buffer_load_dwordx4 v40, s[68:71], s64 offen lds
    s_add_u32 m0, s63, 135168
    s_add_u32 s64, s62, 173824
    buffer_load_dwordx4 v40, s[68:71], s64 offen lds
    s_add_u32 m0, s63, 139264
    s_add_u32 s64, s62, 344064
    buffer_load_dwordx4 v40, s[68:71], s64 offen lds
    s_add_u32 m0, s63, 143360
    s_add_u32 s64, s62, 344960
    buffer_load_dwordx4 v40, s[68:71], s64 offen lds
    s_add_u32 m0, s63, 147456
    s_add_u32 s64, s62, 345856
    buffer_load_dwordx4 v40, s[68:71], s64 offen lds
    s_waitcnt vmcnt(9)
    ds_read_b128 v[64:67], v44 offset:0
    ds_read_b128 v[68:71], v45 offset:0
    ds_read_b128 v[72:75], v46 offset:0
    ds_read_b128 v[76:79], v47 offset:0
    ds_read_b128 v[80:83], v44 offset:128
    ds_read_b128 v[84:87], v45 offset:128
    ds_read_b128 v[88:91], v46 offset:128
    ds_read_b128 v[92:95], v47 offset:128
    ds_read_b128 v[96:99], v44 offset:256
    ds_read_b128 v[100:103], v45 offset:256
    ds_read_b128 v[104:107], v46 offset:256
    ds_read_b128 v[108:111], v47 offset:256
    ds_read_b128 v[112:115], v44 offset:384
    ds_read_b128 v[116:119], v45 offset:384
    ds_read_b128 v[120:123], v46 offset:384
    ds_read_b128 v[124:127], v47 offset:384
    ds_read_b128 v[128:131], v44 offset:512
    ds_read_b128 v[132:135], v45 offset:512
    ds_read_b128 v[136:139], v46 offset:512
    ds_read_b128 v[140:143], v47 offset:512
    ds_read_b128 v[144:147], v44 offset:640
    ds_read_b128 v[148:151], v45 offset:640
    ds_read_b128 v[152:155], v46 offset:640
    ds_read_b128 v[156:159], v47 offset:640
    ds_read_b128 v[160:163], v44 offset:768
    ds_read_b128 v[164:167], v45 offset:768
    ds_read_b128 v[168:171], v46 offset:768
    ds_read_b128 v[172:175], v47 offset:768
    v_mov_b32 v2, 0x3f803f80
    v_mov_b32 v24, 0
    v_mov_b32 v25, 0
    v_mov_b32 v26, 0
    v_mov_b32 v27, 0
    v_mov_b32 v28, 0
    v_mov_b32 v29, 0
    v_mov_b32 v30, 0
    v_mov_b32 v31, 0
    s_waitcnt lgkmcnt(15)
    v_dot2c_f32_bf16 v24, v64, v2
    v_dot2c_f32_bf16 v28, v64, v64
    v_dot2c_f32_bf16 v25, v65, v2
    v_dot2c_f32_bf16 v29, v65, v65
    v_dot2c_f32_bf16 v26, v66, v2
    v_dot2c_f32_bf16 v30, v66, v66
    v_dot2c_f32_bf16 v27, v67, v2
    v_dot2c_f32_bf16 v31, v67, v67
    v_dot2c_f32_bf16 v24, v68, v2
    v_dot2c_f32_bf16 v28, v68, v68
    v_dot2c_f32_bf16 v25, v69, v2
    v_dot2c_f32_bf16 v29, v69, v69
    v_dot2c_f32_bf16 v26, v70, v2
    v_dot2c_f32_bf16 v30, v70, v70
    v_dot2c_f32_bf16 v27, v71, v2
    v_dot2c_f32_bf16 v31, v71, v71
    s_waitcnt lgkmcnt(15)
    v_dot2c_f32_bf16 v24, v72, v2
    v_dot2c_f32_bf16 v28, v72, v72
    v_dot2c_f32_bf16 v25, v73, v2
    v_dot2c_f32_bf16 v29, v73, v73
    v_dot2c_f32_bf16 v26, v74, v2
    v_dot2c_f32_bf16 v30, v74, v74
    v_dot2c_f32_bf16 v27, v75, v2
    v_dot2c_f32_bf16 v31, v75, v75
    v_dot2c_f32_bf16 v24, v76, v2
    v_dot2c_f32_bf16 v28, v76, v76
    v_dot2c_f32_bf16 v25, v77, v2
    v_dot2c_f32_bf16 v29, v77, v77
    v_dot2c_f32_bf16 v26, v78, v2
    v_dot2c_f32_bf16 v30, v78, v78
    v_dot2c_f32_bf16 v27, v79, v2
    v_dot2c_f32_bf16 v31, v79, v79
    s_waitcnt lgkmcnt(15)
    v_dot2c_f32_bf16 v24, v80, v2
    v_dot2c_f32_bf16 v28, v80, v80
    v_dot2c_f32_bf16 v25, v81, v2
    v_dot2c_f32_bf16 v29, v81, v81
    v_dot2c_f32_bf16 v26, v82, v2
    v_dot2c_f32_bf16 v30, v82, v82
    v_dot2c_f32_bf16 v27, v83, v2
    v_dot2c_f32_bf16 v31, v83, v83
    v_dot2c_f32_bf16 v24, v84, v2
    v_dot2c_f32_bf16 v28, v84, v84
    v_dot2c_f32_bf16 v25, v85, v2
    v_dot2c_f32_bf16 v29, v85, v85
    v_dot2c_f32_bf16 v26, v86, v2
    v_dot2c_f32_bf16 v30, v86, v86
    v_dot2c_f32_bf16 v27, v87, v2
    v_dot2c_f32_bf16 v31, v87, v87
    s_waitcnt lgkmcnt(15)
    v_dot2c_f32_bf16 v24, v88, v2
    v_dot2c_f32_bf16 v28, v88, v88
    v_dot2c_f32_bf16 v25, v89, v2
    v_dot2c_f32_bf16 v29, v89, v89
    v_dot2c_f32_bf16 v26, v90, v2
    v_dot2c_f32_bf16 v30, v90, v90
    v_dot2c_f32_bf16 v27, v91, v2
    v_dot2c_f32_bf16 v31, v91, v91
    v_dot2c_f32_bf16 v24, v92, v2
    v_dot2c_f32_bf16 v28, v92, v92
    v_dot2c_f32_bf16 v25, v93, v2
    v_dot2c_f32_bf16 v29, v93, v93
    v_dot2c_f32_bf16 v26, v94, v2
    v_dot2c_f32_bf16 v30, v94, v94
    v_dot2c_f32_bf16 v27, v95, v2
    v_dot2c_f32_bf16 v31, v95, v95
    s_waitcnt lgkmcnt(15)
    v_dot2c_f32_bf16 v24, v96, v2
    v_dot2c_f32_bf16 v28, v96, v96
    v_dot2c_f32_bf16 v25, v97, v2
    v_dot2c_f32_bf16 v29, v97, v97
    v_dot2c_f32_bf16 v26, v98, v2
    v_dot2c_f32_bf16 v30, v98, v98
    v_dot2c_f32_bf16 v27, v99, v2
    v_dot2c_f32_bf16 v31, v99, v99
    v_dot2c_f32_bf16 v24, v100, v2
    v_dot2c_f32_bf16 v28, v100, v100
    v_dot2c_f32_bf16 v25, v101, v2
    v_dot2c_f32_bf16 v29, v101, v101
    v_dot2c_f32_bf16 v26, v102, v2
    v_dot2c_f32_bf16 v30, v102, v102
    v_dot2c_f32_bf16 v27, v103, v2
    v_dot2c_f32_bf16 v31, v103, v103
    s_waitcnt lgkmcnt(15)
    v_dot2c_f32_bf16 v24, v104, v2
    v_dot2c_f32_bf16 v28, v104, v104
    v_dot2c_f32_bf16 v25, v105, v2
    v_dot2c_f32_bf16 v29, v105, v105
    v_dot2c_f32_bf16 v26, v106, v2
    v_dot2c_f32_bf16 v30, v106, v106
    v_dot2c_f32_bf16 v27, v107, v2
    v_dot2c_f32_bf16 v31, v107, v107
    v_dot2c_f32_bf16 v24, v108, v2
    v_dot2c_f32_bf16 v28, v108, v108
    v_dot2c_f32_bf16 v25, v109, v2
    v_dot2c_f32_bf16 v29, v109, v109
    v_dot2c_f32_bf16 v26, v110, v2
    v_dot2c_f32_bf16 v30, v110, v110
    v_dot2c_f32_bf16 v27, v111, v2
    v_dot2c_f32_bf16 v31, v111, v111
    s_waitcnt lgkmcnt(14)
    v_dot2c_f32_bf16 v24, v112, v2
    v_dot2c_f32_bf16 v28, v112, v112
    v_dot2c_f32_bf16 v25, v113, v2
    v_dot2c_f32_bf16 v29, v113, v113
    v_dot2c_f32_bf16 v26, v114, v2
    v_dot2c_f32_bf16 v30, v114, v114
    v_dot2c_f32_bf16 v27, v115, v2
    v_dot2c_f32_bf16 v31, v115, v115
    v_dot2c_f32_bf16 v24, v116, v2
    v_dot2c_f32_bf16 v28, v116, v116
    v_dot2c_f32_bf16 v25, v117, v2
    v_dot2c_f32_bf16 v29, v117, v117
    v_dot2c_f32_bf16 v26, v118, v2
    v_dot2c_f32_bf16 v30, v118, v118
    v_dot2c_f32_bf16 v27, v119, v2
    v_dot2c_f32_bf16 v31, v119, v119
    s_waitcnt lgkmcnt(12)
    v_dot2c_f32_bf16 v24, v120, v2
    v_dot2c_f32_bf16 v28, v120, v120
    v_dot2c_f32_bf16 v25, v121, v2
    v_dot2c_f32_bf16 v29, v121, v121
    v_dot2c_f32_bf16 v26, v122, v2
    v_dot2c_f32_bf16 v30, v122, v122
    v_dot2c_f32_bf16 v27, v123, v2
    v_dot2c_f32_bf16 v31, v123, v123
    v_dot2c_f32_bf16 v24, v124, v2
    v_dot2c_f32_bf16 v28, v124, v124
    v_dot2c_f32_bf16 v25, v125, v2
    v_dot2c_f32_bf16 v29, v125, v125
    v_dot2c_f32_bf16 v26, v126, v2
    v_dot2c_f32_bf16 v30, v126, v126
    v_dot2c_f32_bf16 v27, v127, v2
    v_dot2c_f32_bf16 v31, v127, v127
    s_waitcnt lgkmcnt(10)
    v_dot2c_f32_bf16 v24, v128, v2
    v_dot2c_f32_bf16 v28, v128, v128
    v_dot2c_f32_bf16 v25, v129, v2
    v_dot2c_f32_bf16 v29, v129, v129
    v_dot2c_f32_bf16 v26, v130, v2
    v_dot2c_f32_bf16 v30, v130, v130
    v_dot2c_f32_bf16 v27, v131, v2
    v_dot2c_f32_bf16 v31, v131, v131
    v_dot2c_f32_bf16 v24, v132, v2
    v_dot2c_f32_bf16 v28, v132, v132
    v_dot2c_f32_bf16 v25, v133, v2
    v_dot2c_f32_bf16 v29, v133, v133
    v_dot2c_f32_bf16 v26, v134, v2
    v_dot2c_f32_bf16 v30, v134, v134
    v_dot2c_f32_bf16 v27, v135, v2
    v_dot2c_f32_bf16 v31, v135, v135
    s_waitcnt lgkmcnt(8)
    v_dot2c_f32_bf16 v24, v136, v2
    v_dot2c_f32_bf16 v28, v136, v136
    v_dot2c_f32_bf16 v25, v137, v2
    v_dot2c_f32_bf16 v29, v137, v137
    v_dot2c_f32_bf16 v26, v138, v2
    v_dot2c_f32_bf16 v30, v138, v138
    v_dot2c_f32_bf16 v27, v139, v2
    v_dot2c_f32_bf16 v31, v139, v139
    v_dot2c_f32_bf16 v24, v140, v2
    v_dot2c_f32_bf16 v28, v140, v140
    v_dot2c_f32_bf16 v25, v141, v2
    v_dot2c_f32_bf16 v29, v141, v141
    v_dot2c_f32_bf16 v26, v142, v2
    v_dot2c_f32_bf16 v30, v142, v142
    v_dot2c_f32_bf16 v27, v143, v2
    v_dot2c_f32_bf16 v31, v143, v143
    s_waitcnt lgkmcnt(6)
    v_dot2c_f32_bf16 v24, v144, v2
    v_dot2c_f32_bf16 v28, v144, v144
    v_dot2c_f32_bf16 v25, v145, v2
    v_dot2c_f32_bf16 v29, v145, v145
    v_dot2c_f32_bf16 v26, v146, v2
    v_dot2c_f32_bf16 v30, v146, v146
    v_dot2c_f32_bf16 v27, v147, v2
    v_dot2c_f32_bf16 v31, v147, v147
    v_dot2c_f32_bf16 v24, v148, v2
    v_dot2c_f32_bf16 v28, v148, v148
    v_dot2c_f32_bf16 v25, v149, v2
    v_dot2c_f32_bf16 v29, v149, v149
    v_dot2c_f32_bf16 v26, v150, v2
    v_dot2c_f32_bf16 v30, v150, v150
    v_dot2c_f32_bf16 v27, v151, v2
    v_dot2c_f32_bf16 v31, v151, v151
    s_waitcnt lgkmcnt(4)
    v_dot2c_f32_bf16 v24, v152, v2
    v_dot2c_f32_bf16 v28, v152, v152
    v_dot2c_f32_bf16 v25, v153, v2
    v_dot2c_f32_bf16 v29, v153, v153
    v_dot2c_f32_bf16 v26, v154, v2
    v_dot2c_f32_bf16 v30, v154, v154
    v_dot2c_f32_bf16 v27, v155, v2
    v_dot2c_f32_bf16 v31, v155, v155
    v_dot2c_f32_bf16 v24, v156, v2
    v_dot2c_f32_bf16 v28, v156, v156
    v_dot2c_f32_bf16 v25, v157, v2
    v_dot2c_f32_bf16 v29, v157, v157
    v_dot2c_f32_bf16 v26, v158, v2
    v_dot2c_f32_bf16 v30, v158, v158
    v_dot2c_f32_bf16 v27, v159, v2
    v_dot2c_f32_bf16 v31, v159, v159
    s_waitcnt lgkmcnt(2)
    v_dot2c_f32_bf16 v24, v160, v2
    v_dot2c_f32_bf16 v28, v160, v160
    v_dot2c_f32_bf16 v25, v161, v2
    v_dot2c_f32_bf16 v29, v161, v161
    v_dot2c_f32_bf16 v26, v162, v2
    v_dot2c_f32_bf16 v30, v162, v162
    v_dot2c_f32_bf16 v27, v163, v2
    v_dot2c_f32_bf16 v31, v163, v163
    v_dot2c_f32_bf16 v24, v164, v2
    v_dot2c_f32_bf16 v28, v164, v164
    v_dot2c_f32_bf16 v25, v165, v2
    v_dot2c_f32_bf16 v29, v165, v165
    v_dot2c_f32_bf16 v26, v166, v2
    v_dot2c_f32_bf16 v30, v166, v166
    v_dot2c_f32_bf16 v27, v167, v2
    v_dot2c_f32_bf16 v31, v167, v167
    s_waitcnt lgkmcnt(0)
    v_dot2c_f32_bf16 v24, v168, v2
    v_dot2c_f32_bf16 v28, v168, v168
    v_dot2c_f32_bf16 v25, v169, v2
    v_dot2c_f32_bf16 v29, v169, v169
    s_add_u32 m0, s61, 0
    s_add_u32 s64, s62, 516096
    buffer_load_dwordx4 v40, s[68:71], s64 offen lds
    v_dot2c_f32_bf16 v26, v170, v2
    v_dot2c_f32_bf16 v30, v170, v170
    v_dot2c_f32_bf16 v27, v171, v2
    v_dot2c_f32_bf16 v31, v171, v171
    v_dot2c_f32_bf16 v24, v172, v2
    v_dot2c_f32_bf16 v28, v172, v172
    s_add_u32 m0, s61, 1024
    s_add_u32 s64, s62, 516992
    buffer_load_dwordx4 v40, s[68:71], s64 offen lds
    v_dot2c_f32_bf16 v25, v173, v2
    v_dot2c_f32_bf16 v29, v173, v173
    v_dot2c_f32_bf16 v26, v174, v2
    v_dot2c_f32_bf16 v30, v174, v174
    v_dot2c_f32_bf16 v27, v175, v2
    v_dot2c_f32_bf16 v31, v175, v175
    s_add_u32 m0, s61, 2048
    s_add_u32 s64, s62, 517888
    buffer_load_dwordx4 v40, s[68:71], s64 offen lds
    s_nop 2
    v_add_f32 v24, v24, v25
    v_add_f32 v26, v26, v27
    v_add_f32 v28, v28, v29
    v_add_f32 v30, v30, v31
    v_add_f32 v24, v24, v26
    v_add_f32 v28, v28, v30
    v_mov_b32 v25, v24
    v_mov_b32 v29, v28
    s_nop 0
    v_permlane32_swap_b32 v24, v25
    v_permlane32_swap_b32 v28, v29
    v_add_f32 v24, v24, v25
    v_add_f32 v28, v28, v29
    v_mul_f32 v24, 0.002232142857142857, v24
    v_mul_f32 v28, 0.002232142857142857, v28
    v_fma_f32 v28, -v24, v24, v28
    v_max_f32 v28, 0, v28
    v_add_f32 v28, 0x3727c5ac, v28
    v_rsq_f32 v4, v28
    s_nop 0
    v_mul_f32 v6, v24, v4
    v_sub_f32 v6, 0, v6
    s_waitcnt vmcnt(9)
    s_barrier
    ds_read_b128 v[176:179], v49 offset:1792
    ds_read_b128 v[180:183], v49 offset:1808
    ds_read_b128 v[184:187], v49 offset:0
    ds_read_b128 v[188:191], v49 offset:16
    ds_read_b128 v[192:195], v49 offset:1856
    ds_read_b128 v[196:199], v49 offset:1872
    ds_read_b128 v[200:203], v49 offset:64
    ds_read_b128 v[204:207], v49 offset:80
    ds_read_b64_tr_b16 v[208:209], v51 offset:0
    ds_read_b64_tr_b16 v[210:211], v51 offset:256
    ds_read_b64_tr_b16 v[212:213], v51 offset:4096
    ds_read_b64_tr_b16 v[214:215], v51 offset:4352
    ds_read_b64_tr_b16 v[216:217], v51 offset:8192
    ds_read_b64_tr_b16 v[218:219], v51 offset:8448
    s_waitcnt lgkmcnt(10)
    v_lshlrev_b32 v24, 16, v64
    v_and_b32 v25, s56, v64
    v_lshlrev_b32 v26, 16, v65
    v_and_b32 v27, s56, v65
    v_lshlrev_b32 v28, 16, v66
    v_and_b32 v29, s56, v66
    v_lshlrev_b32 v30, 16, v67
    v_and_b32 v31, s56, v67
    v_fma_f32 v24, v24, v4, v6
    v_fma_f32 v25, v25, v4, v6
    v_fma_f32 v26, v26, v4, v6
    v_fma_f32 v27, v27, v4, v6
    v_fma_f32 v28, v28, v4, v6
    v_fma_f32 v29, v29, v4, v6
    v_fma_f32 v30, v30, v4, v6
    v_fma_f32 v31, v31, v4, v6
    v_fma_f32 v24, v24, v176, v184
    v_fma_f32 v25, v25, v177, v185
    v_fma_f32 v26, v26, v178, v186
    v_fma_f32 v27, v27, v179, v187
    v_fma_f32 v28, v28, v180, v188
    v_fma_f32 v29, v29, v181, v189
    v_fma_f32 v30, v30, v182, v190
    v_fma_f32 v31, v31, v183, v191
    v_cvt_pk_bf16_f32 v232, v24, v25
    v_cvt_pk_bf16_f32 v233, v26, v27
    v_cvt_pk_bf16_f32 v234, v28, v29
    v_cvt_pk_bf16_f32 v235, v30, v31
    s_waitcnt lgkmcnt(0)
    s_nop 0
    v_mfma_f32_32x32x16_bf16 a[112:127], v[208:211], v[232:235], 0
    ds_read_b64_tr_b16 v[220:221], v51 offset:1024
    ds_read_b64_tr_b16 v[222:223], v51 offset:1280
    ds_read_b64_tr_b16 v[224:225], v51 offset:5120
    ds_read_b64_tr_b16 v[226:227], v51 offset:5376
    v_lshlrev_b32 v24, 16, v68
    v_and_b32 v25, s56, v68
    v_lshlrev_b32 v26, 16, v69
    v_and_b32 v27, s56, v69
    v_lshlrev_b32 v28, 16, v70
    v_and_b32 v29, s56, v70
    v_lshlrev_b32 v30, 16, v71
    v_and_b32 v31, s56, v71
    v_mfma_f32_32x32x16_bf16 a[128:143], v[212:215], v[232:235], 0
    ds_read_b64_tr_b16 v[228:229], v51 offset:9216
    ds_read_b64_tr_b16 v[230:231], v51 offset:9472
    ds_read_b128 v[176:179], v49 offset:1920
    ds_read_b128 v[180:183], v49 offset:1936
    v_fma_f32 v24, v24, v4, v6
    v_fma_f32 v25, v25, v4, v6
    v_fma_f32 v26, v26, v4, v6
    v_fma_f32 v27, v27, v4, v6
    v_fma_f32 v28, v28, v4, v6
    v_fma_f32 v29, v29, v4, v6
    v_fma_f32 v30, v30, v4, v6
    v_fma_f32 v31, v31, v4, v6
    v_mfma_f32_32x32x16_bf16 a[144:159], v[232:235], v[216:219], 0
    ds_read_b128 v[184:187], v49 offset:128
    ds_read_b128 v[188:191], v49 offset:144
    v_fma_f32 v24, v24, v192, v200
    v_fma_f32 v25, v25, v193, v201
    v_fma_f32 v26, v26, v194, v202
    v_fma_f32 v27, v27, v195, v203
    v_fma_f32 v28, v28, v196, v204
    v_fma_f32 v29, v29, v197, v205
    v_fma_f32 v30, v30, v198, v206
    v_fma_f32 v31, v31, v199, v207
    v_cvt_pk_bf16_f32 v236, v24, v25
    v_cvt_pk_bf16_f32 v237, v26, v27
    v_cvt_pk_bf16_f32 v238, v28, v29
    v_cvt_pk_bf16_f32 v239, v30, v31
    s_add_u32 m0, s61, 3072
    s_add_u32 s64, s62, 688128
    buffer_load_dwordx4 v40, s[68:71], s64 offen lds
    s_waitcnt lgkmcnt(4)
    v_mfma_f32_32x32x16_bf16 a[112:127], v[220:223], v[236:239], a[112:127]
    ds_read_b64_tr_b16 v[208:209], v51 offset:2048
    ds_read_b64_tr_b16 v[210:211], v51 offset:2304
    ds_read_b64_tr_b16 v[212:213], v51 offset:6144
    ds_read_b64_tr_b16 v[214:215], v51 offset:6400
    v_lshlrev_b32 v24, 16, v72
    v_and_b32 v25, s56, v72
    v_lshlrev_b32 v26, 16, v73
    v_and_b32 v27, s56, v73
    v_lshlrev_b32 v28, 16, v74
    v_and_b32 v29, s56, v74
    v_lshlrev_b32 v30, 16, v75
    v_and_b32 v31, s56, v75
    v_mfma_f32_32x32x16_bf16 a[128:143], v[224:227], v[236:239], a[128:143]
    ds_read_b64_tr_b16 v[216:217], v51 offset:10240
    ds_read_b64_tr_b16 v[218:219], v51 offset:10496
    ds_read_b128 v[192:195], v49 offset:1984
    ds_read_b128 v[196:199], v49 offset:2000
    v_fma_f32 v24, v24, v4, v6
    v_fma_f32 v25, v25, v4, v6
    v_fma_f32 v26, v26, v4, v6
    v_fma_f32 v27, v27, v4, v6
    v_fma_f32 v28, v28, v4, v6
    v_fma_f32 v29, v29, v4, v6
    v_fma_f32 v30, v30, v4, v6
    v_fma_f32 v31, v31, v4, v6
    v_mfma_f32_32x32x16_bf16 a[144:159], v[236:239], v[228:231], a[144:159]
    s_waitcnt lgkmcnt(8)
    ds_read_b128 v[200:203], v49 offset:192
    ds_read_b128 v[204:207], v49 offset:208
    v_fma_f32 v24, v24, v176, v184
    v_fma_f32 v25, v25, v177, v185
    v_fma_f32 v26, v26, v178, v186
    v_fma_f32 v27, v27, v179, v187
    v_fma_f32 v28, v28, v180, v188
    v_fma_f32 v29, v29, v181, v189
    v_fma_f32 v30, v30, v182, v190
    v_fma_f32 v31, v31, v183, v191
    v_cvt_pk_bf16_f32 v232, v24, v25
    v_cvt_pk_bf16_f32 v233, v26, v27
    v_cvt_pk_bf16_f32 v234, v28, v29
    v_cvt_pk_bf16_f32 v235, v30, v31
    s_add_u32 m0, s61, 4096
    s_add_u32 s64, s62, 689024
    buffer_load_dwordx4 v40, s[68:71], s64 offen lds
    s_waitcnt lgkmcnt(4)
    v_mfma_f32_32x32x16_bf16 a[112:127], v[208:211], v[232:235], a[112:127]
    ds_read_b64_tr_b16 v[220:221], v51 offset:3072
    ds_read_b64_tr_b16 v[222:223], v51 offset:3328
    ds_read_b64_tr_b16 v[224:225], v51 offset:7168
    ds_read_b64_tr_b16 v[226:227], v51 offset:7424
    v_lshlrev_b32 v24, 16, v76
    v_and_b32 v25, s56, v76
    v_lshlrev_b32 v26, 16, v77
    v_and_b32 v27, s56, v77
    v_lshlrev_b32 v28, 16, v78
    v_and_b32 v29, s56, v78
    v_lshlrev_b32 v30, 16, v79
    v_and_b32 v31, s56, v79
    v_mfma_f32_32x32x16_bf16 a[128:143], v[212:215], v[232:235], a[128:143]
    ds_read_b64_tr_b16 v[228:229], v51 offset:11264
    ds_read_b64_tr_b16 v[230:231], v51 offset:11520
    ds_read_b128 v[176:179], v49 offset:2048
    ds_read_b128 v[180:183], v49 offset:2064
    v_fma_f32 v24, v24, v4, v6
    v_fma_f32 v25, v25, v4, v6
    v_fma_f32 v26, v26, v4, v6
    v_fma_f32 v27, v27, v4, v6
    v_fma_f32 v28, v28, v4, v6
    v_fma_f32 v29, v29, v4, v6
    v_fma_f32 v30, v30, v4, v6
    v_fma_f32 v31, v31, v4, v6
    v_mfma_f32_32x32x16_bf16 a[144:159], v[232:235], v[216:219], a[144:159]
    s_waitcnt lgkmcnt(8)
    ds_read_b128 v[184:187], v49 offset:256
    ds_read_b128 v[188:191], v49 offset:272
    v_fma_f32 v24, v24, v192, v200
    v_fma_f32 v25, v25, v193, v201
    v_fma_f32 v26, v26, v194, v202
    v_fma_f32 v27, v27, v195, v203
    v_fma_f32 v28, v28, v196, v204
    v_fma_f32 v29, v29, v197, v205
    v_fma_f32 v30, v30, v198, v206
    v_fma_f32 v31, v31, v199, v207
    v_cvt_pk_bf16_f32 v236, v24, v25
    v_cvt_pk_bf16_f32 v237, v26, v27
    v_cvt_pk_bf16_f32 v238, v28, v29
    v_cvt_pk_bf16_f32 v239, v30, v31
    s_add_u32 m0, s61, 5120
    s_add_u32 s64, s62, 689920
    buffer_load_dwordx4 v40, s[68:71], s64 offen lds
    s_waitcnt lgkmcnt(4)
    s_waitcnt vmcnt(9)
    s_barrier
    v_mfma_f32_32x32x16_bf16 a[112:127], v[220:223], v[236:239], a[112:127]
    ds_read_b64_tr_b16 v[208:209], v51 offset:12288
    ds_read_b64_tr_b16 v[210:211], v51 offset:12544
    ds_read_b64_tr_b16 v[212:213], v51 offset:16384
    ds_read_b64_tr_b16 v[214:215], v51 offset:16640
    v_lshlrev_b32 v24, 16, v80
    v_and_b32 v25, s56, v80
    v_lshlrev_b32 v26, 16, v81
    v_and_b32 v27, s56, v81
    v_lshlrev_b32 v28, 16, v82
    v_and_b32 v29, s56, v82
    v_lshlrev_b32 v30, 16, v83
    v_and_b32 v31, s56, v83
    v_mfma_f32_32x32x16_bf16 a[128:143], v[224:227], v[236:239], a[128:143]
    ds_read_b64_tr_b16 v[216:217], v51 offset:20480
    ds_read_b64_tr_b16 v[218:219], v51 offset:20736
    ds_read_b128 v[192:195], v49 offset:2112
    ds_read_b128 v[196:199], v49 offset:2128
    v_fma_f32 v24, v24, v4, v6
    v_fma_f32 v25, v25, v4, v6
    v_fma_f32 v26, v26, v4, v6
    v_fma_f32 v27, v27, v4, v6
    v_fma_f32 v28, v28, v4, v6
    v_fma_f32 v29, v29, v4, v6
    v_fma_f32 v30, v30, v4, v6
    v_fma_f32 v31, v31, v4, v6
    v_mfma_f32_32x32x16_bf16 a[144:159], v[236:239], v[228:231], a[144:159]
    s_waitcnt lgkmcnt(8)
    ds_read_b128 v[200:203], v49 offset:320
    ds_read_b128 v[204:207], v49 offset:336
    v_fma_f32 v24, v24, v176, v184
    v_fma_f32 v25, v25, v177, v185
    v_fma_f32 v26, v26, v178, v186
    v_fma_f32 v27, v27, v179, v187
    v_fma_f32 v28, v28, v180, v188
    v_fma_f32 v29, v29, v181, v189
    v_fma_f32 v30, v30, v182, v190
    v_fma_f32 v31, v31, v183, v191
    v_cvt_pk_bf16_f32 v232, v24, v25
    v_cvt_pk_bf16_f32 v233, v26, v27
    v_cvt_pk_bf16_f32 v234, v28, v29
    v_cvt_pk_bf16_f32 v235, v30, v31
    s_add_u32 m0, s61, 6144
    s_add_u32 s64, s62, 860160
    buffer_load_dwordx4 v40, s[68:71], s64 offen lds
    s_waitcnt lgkmcnt(4)
    v_mfma_f32_32x32x16_bf16 a[112:127], v[208:211], v[232:235], a[112:127]
    ds_read_b64_tr_b16 v[220:221], v51 offset:13312
    ds_read_b64_tr_b16 v[222:223], v51 offset:13568
    ds_read_b64_tr_b16 v[224:225], v51 offset:17408
    ds_read_b64_tr_b16 v[226:227], v51 offset:17664
    v_lshlrev_b32 v24, 16, v84
    v_and_b32 v25, s56, v84
    v_lshlrev_b32 v26, 16, v85
    v_and_b32 v27, s56, v85
    v_lshlrev_b32 v28, 16, v86
    v_and_b32 v29, s56, v86
    v_lshlrev_b32 v30, 16, v87
    v_and_b32 v31, s56, v87
    v_mfma_f32_32x32x16_bf16 a[128:143], v[212:215], v[232:235], a[128:143]
    ds_read_b64_tr_b16 v[228:229], v51 offset:21504
    ds_read_b64_tr_b16 v[230:231], v51 offset:21760
    ds_read_b128 v[176:179], v49 offset:2176
    ds_read_b128 v[180:183], v49 offset:2192
    v_fma_f32 v24, v24, v4, v6
    v_fma_f32 v25, v25, v4, v6
    v_fma_f32 v26, v26, v4, v6
    v_fma_f32 v27, v27, v4, v6
    v_fma_f32 v28, v28, v4, v6
    v_fma_f32 v29, v29, v4, v6
    v_fma_f32 v30, v30, v4, v6
    v_fma_f32 v31, v31, v4, v6
    v_mfma_f32_32x32x16_bf16 a[144:159], v[232:235], v[216:219], a[144:159]
    s_waitcnt lgkmcnt(8)
    ds_read_b128 v[184:187], v49 offset:384
    ds_read_b128 v[188:191], v49 offset:400
    v_fma_f32 v24, v24, v192, v200
    v_fma_f32 v25, v25, v193, v201
    v_fma_f32 v26, v26, v194, v202
    v_fma_f32 v27, v27, v195, v203
    v_fma_f32 v28, v28, v196, v204
    v_fma_f32 v29, v29, v197, v205
    v_fma_f32 v30, v30, v198, v206
    v_fma_f32 v31, v31, v199, v207
    v_cvt_pk_bf16_f32 v236, v24, v25
    v_cvt_pk_bf16_f32 v237, v26, v27
    v_cvt_pk_bf16_f32 v238, v28, v29
    v_cvt_pk_bf16_f32 v239, v30, v31
    s_add_u32 m0, s61, 7168
    s_add_u32 s64, s62, 861056
    buffer_load_dwordx4 v40, s[68:71], s64 offen lds
    s_waitcnt lgkmcnt(4)
    v_mfma_f32_32x32x16_bf16 a[112:127], v[220:223], v[236:239], a[112:127]
    ds_read_b64_tr_b16 v[208:209], v51 offset:14336
    ds_read_b64_tr_b16 v[210:211], v51 offset:14592
    ds_read_b64_tr_b16 v[212:213], v51 offset:18432
    ds_read_b64_tr_b16 v[214:215], v51 offset:18688
    v_lshlrev_b32 v24, 16, v88
    v_and_b32 v25, s56, v88
    v_lshlrev_b32 v26, 16, v89
    v_and_b32 v27, s56, v89
    v_lshlrev_b32 v28, 16, v90
    v_and_b32 v29, s56, v90
    v_lshlrev_b32 v30, 16, v91
    v_and_b32 v31, s56, v91
    v_mfma_f32_32x32x16_bf16 a[128:143], v[224:227], v[236:239], a[128:143]
    ds_read_b64_tr_b16 v[216:217], v51 offset:22528
    ds_read_b64_tr_b16 v[218:219], v51 offset:22784
    ds_read_b128 v[192:195], v49 offset:2240
    ds_read_b128 v[196:199], v49 offset:2256
    v_fma_f32 v24, v24, v4, v6
    v_fma_f32 v25, v25, v4, v6
    v_fma_f32 v26, v26, v4, v6
    v_fma_f32 v27, v27, v4, v6
    v_fma_f32 v28, v28, v4, v6
    v_fma_f32 v29, v29, v4, v6
    v_fma_f32 v30, v30, v4, v6
    v_fma_f32 v31, v31, v4, v6
    v_mfma_f32_32x32x16_bf16 a[144:159], v[236:239], v[228:231], a[144:159]
    s_waitcnt lgkmcnt(8)
    ds_read_b128 v[200:203], v49 offset:448
    ds_read_b128 v[204:207], v49 offset:464
    v_fma_f32 v24, v24, v176, v184
    v_fma_f32 v25, v25, v177, v185
    v_fma_f32 v26, v26, v178, v186
    v_fma_f32 v27, v27, v179, v187
    v_fma_f32 v28, v28, v180, v188
    v_fma_f32 v29, v29, v181, v189
    v_fma_f32 v30, v30, v182, v190
    v_fma_f32 v31, v31, v183, v191
    v_cvt_pk_bf16_f32 v232, v24, v25
    v_cvt_pk_bf16_f32 v233, v26, v27
    v_cvt_pk_bf16_f32 v234, v28, v29
    v_cvt_pk_bf16_f32 v235, v30, v31
    s_add_u32 m0, s61, 8192
    s_add_u32 s64, s62, 861952
    buffer_load_dwordx4 v40, s[68:71], s64 offen lds
    s_waitcnt lgkmcnt(4)
    v_mfma_f32_32x32x16_bf16 a[112:127], v[208:211], v[232:235], a[112:127]
    ds_read_b64_tr_b16 v[220:221], v51 offset:15360
    ds_read_b64_tr_b16 v[222:223], v51 offset:15616
    ds_read_b64_tr_b16 v[224:225], v51 offset:19456
    ds_read_b64_tr_b16 v[226:227], v51 offset:19712
    v_lshlrev_b32 v24, 16, v92
    v_and_b32 v25, s56, v92
    v_lshlrev_b32 v26, 16, v93
    v_and_b32 v27, s56, v93
    v_lshlrev_b32 v28, 16, v94
    v_and_b32 v29, s56, v94
    v_lshlrev_b32 v30, 16, v95
    v_and_b32 v31, s56, v95
    v_mfma_f32_32x32x16_bf16 a[128:143], v[212:215], v[232:235], a[128:143]
    ds_read_b64_tr_b16 v[228:229], v51 offset:23552
    ds_read_b64_tr_b16 v[230:231], v51 offset:23808
    ds_read_b128 v[176:179], v49 offset:2304
    ds_read_b128 v[180:183], v49 offset:2320
    v_fma_f32 v24, v24, v4, v6
    v_fma_f32 v25, v25, v4, v6
    v_fma_f32 v26, v26, v4, v6
    v_fma_f32 v27, v27, v4, v6
    v_fma_f32 v28, v28, v4, v6
    v_fma_f32 v29, v29, v4, v6
    v_fma_f32 v30, v30, v4, v6
    v_fma_f32 v31, v31, v4, v6
    v_mfma_f32_32x32x16_bf16 a[144:159], v[232:235], v[216:219], a[144:159]
    s_waitcnt lgkmcnt(8)
    ds_read_b128 v[184:187], v49 offset:512
    ds_read_b128 v[188:191], v49 offset:528
    v_fma_f32 v24, v24, v192, v200
    v_fma_f32 v25, v25, v193, v201
    v_fma_f32 v26, v26, v194, v202
    v_fma_f32 v27, v27, v195, v203
    v_fma_f32 v28, v28, v196, v204
    v_fma_f32 v29, v29, v197, v205
    v_fma_f32 v30, v30, v198, v206
    v_fma_f32 v31, v31, v199, v207
    v_cvt_pk_bf16_f32 v236, v24, v25
    v_cvt_pk_bf16_f32 v237, v26, v27
    v_cvt_pk_bf16_f32 v238, v28, v29
    v_cvt_pk_bf16_f32 v239, v30, v31
    s_add_u32 m0, s61, 9216
    s_add_u32 s64, s62, 1032192
    buffer_load_dwordx4 v40, s[68:71], s64 offen lds
    s_waitcnt lgkmcnt(4)
    s_waitcnt vmcnt(10)
    s_barrier
    v_mfma_f32_32x32x16_bf16 a[112:127], v[220:223], v[236:239], a[112:127]
    ds_read_b64_tr_b16 v[208:209], v51 offset:24576
    ds_read_b64_tr_b16 v[210:211], v51 offset:24832
    ds_read_b64_tr_b16 v[212:213], v51 offset:28672
    ds_read_b64_tr_b16 v[214:215], v51 offset:28928
    v_lshlrev_b32 v24, 16, v96
    v_and_b32 v25, s56, v96
    v_lshlrev_b32 v26, 16, v97
    v_and_b32 v27, s56, v97
    v_lshlrev_b32 v28, 16, v98
    v_and_b32 v29, s56, v98
    v_lshlrev_b32 v30, 16, v99
    v_and_b32 v31, s56, v99
    v_mfma_f32_32x32x16_bf16 a[128:143], v[224:227], v[236:239], a[128:143]
    ds_read_b64_tr_b16 v[216:217], v51 offset:32768
    ds_read_b64_tr_b16 v[218:219], v51 offset:33024
    ds_read_b128 v[192:195], v49 offset:2368
    ds_read_b128 v[196:199], v49 offset:2384
    v_fma_f32 v24, v24, v4, v6
    v_fma_f32 v25, v25, v4, v6
    v_fma_f32 v26, v26, v4, v6
    v_fma_f32 v27, v27, v4, v6
    v_fma_f32 v28, v28, v4, v6
    v_fma_f32 v29, v29, v4, v6
    v_fma_f32 v30, v30, v4, v6
    v_fma_f32 v31, v31, v4, v6
    v_mfma_f32_32x32x16_bf16 a[144:159], v[236:239], v[228:231], a[144:159]
    s_waitcnt lgkmcnt(8)
    ds_read_b128 v[200:203], v49 offset:576
    ds_read_b128 v[204:207], v49 offset:592
    v_fma_f32 v24, v24, v176, v184
    v_fma_f32 v25, v25, v177, v185
    v_fma_f32 v26, v26, v178, v186
    v_fma_f32 v27, v27, v179, v187
    v_fma_f32 v28, v28, v180, v188
    v_fma_f32 v29, v29, v181, v189
    v_fma_f32 v30, v30, v182, v190
    v_fma_f32 v31, v31, v183, v191
    v_cvt_pk_bf16_f32 v232, v24, v25
    v_cvt_pk_bf16_f32 v233, v26, v27
    v_cvt_pk_bf16_f32 v234, v28, v29
    v_cvt_pk_bf16_f32 v235, v30, v31
    s_add_u32 m0, s61, 10240
    s_add_u32 s64, s62, 1033088
    buffer_load_dwordx4 v40, s[68:71], s64 offen lds
    s_waitcnt lgkmcnt(4)
    v_mfma_f32_32x32x16_bf16 a[112:127], v[208:211], v[232:235], a[112:127]
    ds_read_b64_tr_b16 v[220:221], v51 offset:25600
    ds_read_b64_tr_b16 v[222:223], v51 offset:25856
    ds_read_b64_tr_b16 v[224:225], v51 offset:29696
    ds_read_b64_tr_b16 v[226:227], v51 offset:29952
    v_lshlrev_b32 v24, 16, v100
    v_and_b32 v25, s56, v100
    v_lshlrev_b32 v26, 16, v101
    v_and_b32 v27, s56, v101
    v_lshlrev_b32 v28, 16, v102
    v_and_b32 v29, s56, v102
    v_lshlrev_b32 v30, 16, v103
    v_and_b32 v31, s56, v103
    v_mfma_f32_32x32x16_bf16 a[128:143], v[212:215], v[232:235], a[128:143]
    ds_read_b64_tr_b16 v[228:229], v51 offset:33792
    ds_read_b64_tr_b16 v[230:231], v51 offset:34048
    ds_read_b128 v[176:179], v49 offset:2432
    ds_read_b128 v[180:183], v49 offset:2448
    v_fma_f32 v24, v24, v4, v6
    v_fma_f32 v25, v25, v4, v6
    v_fma_f32 v26, v26, v4, v6
    v_fma_f32 v27, v27, v4, v6
    v_fma_f32 v28, v28, v4, v6
    v_fma_f32 v29, v29, v4, v6
    v_fma_f32 v30, v30, v4, v6
    v_fma_f32 v31, v31, v4, v6
    v_mfma_f32_32x32x16_bf16 a[144:159], v[232:235], v[216:219], a[144:159]
    s_waitcnt lgkmcnt(8)
    ds_read_b128 v[184:187], v49 offset:640
    ds_read_b128 v[188:191], v49 offset:656
    v_fma_f32 v24, v24, v192, v200
    v_fma_f32 v25, v25, v193, v201
    v_fma_f32 v26, v26, v194, v202
    v_fma_f32 v27, v27, v195, v203
    v_fma_f32 v28, v28, v196, v204
    v_fma_f32 v29, v29, v197, v205
    v_fma_f32 v30, v30, v198, v206
    v_fma_f32 v31, v31, v199, v207
    v_cvt_pk_bf16_f32 v236, v24, v25
    v_cvt_pk_bf16_f32 v237, v26, v27
    v_cvt_pk_bf16_f32 v238, v28, v29
    v_cvt_pk_bf16_f32 v239, v30, v31
    s_add_u32 m0, s61, 11264
    s_add_u32 s64, s62, 1033984
    buffer_load_dwordx4 v40, s[68:71], s64 offen lds
    s_waitcnt lgkmcnt(4)
    v_mfma_f32_32x32x16_bf16 a[112:127], v[220:223], v[236:239], a[112:127]
    ds_read_b64_tr_b16 v[208:209], v51 offset:26624
    ds_read_b64_tr_b16 v[210:211], v51 offset:26880
    ds_read_b64_tr_b16 v[212:213], v51 offset:30720
    ds_read_b64_tr_b16 v[214:215], v51 offset:30976
    v_lshlrev_b32 v24, 16, v104
    v_and_b32 v25, s56, v104
    v_lshlrev_b32 v26, 16, v105
    v_and_b32 v27, s56, v105
    v_lshlrev_b32 v28, 16, v106
    v_and_b32 v29, s56, v106
    v_lshlrev_b32 v30, 16, v107
    v_and_b32 v31, s56, v107
    v_mfma_f32_32x32x16_bf16 a[128:143], v[224:227], v[236:239], a[128:143]
    ds_read_b64_tr_b16 v[216:217], v51 offset:34816
    ds_read_b64_tr_b16 v[218:219], v51 offset:35072
    ds_read_b128 v[192:195], v49 offset:2496
    ds_read_b128 v[196:199], v49 offset:2512
    v_fma_f32 v24, v24, v4, v6
    v_fma_f32 v25, v25, v4, v6
    v_fma_f32 v26, v26, v4, v6
    v_fma_f32 v27, v27, v4, v6
    v_fma_f32 v28, v28, v4, v6
    v_fma_f32 v29, v29, v4, v6
    v_fma_f32 v30, v30, v4, v6
    v_fma_f32 v31, v31, v4, v6
    v_mfma_f32_32x32x16_bf16 a[144:159], v[236:239], v[228:231], a[144:159]
    s_waitcnt lgkmcnt(8)
    ds_read_b128 v[200:203], v49 offset:704
    ds_read_b128 v[204:207], v49 offset:720
    v_fma_f32 v24, v24, v176, v184
    v_fma_f32 v25, v25, v177, v185
    v_fma_f32 v26, v26, v178, v186
    v_fma_f32 v27, v27, v179, v187
    v_fma_f32 v28, v28, v180, v188
    v_fma_f32 v29, v29, v181, v189
    v_fma_f32 v30, v30, v182, v190
    v_fma_f32 v31, v31, v183, v191
    v_cvt_pk_bf16_f32 v232, v24, v25
    v_cvt_pk_bf16_f32 v233, v26, v27
    v_cvt_pk_bf16_f32 v234, v28, v29
    v_cvt_pk_bf16_f32 v235, v30, v31
    s_mov_b64 s[52:53], s[20:21]
    s_mov_b32 s54, 401408
    buffer_load_dword v18, v43, s[52:55], 0 offen
    s_waitcnt lgkmcnt(4)
    v_mfma_f32_32x32x16_bf16 a[112:127], v[208:211], v[232:235], a[112:127]
    ds_read_b64_tr_b16 v[220:221], v51 offset:27648
    ds_read_b64_tr_b16 v[222:223], v51 offset:27904
    ds_read_b64_tr_b16 v[224:225], v51 offset:31744
    ds_read_b64_tr_b16 v[226:227], v51 offset:32000
    v_lshlrev_b32 v24, 16, v108
    v_and_b32 v25, s56, v108
    v_lshlrev_b32 v26, 16, v109
    v_and_b32 v27, s56, v109
    v_lshlrev_b32 v28, 16, v110
    v_and_b32 v29, s56, v110
    v_lshlrev_b32 v30, 16, v111
    v_and_b32 v31, s56, v111
    v_mfma_f32_32x32x16_bf16 a[128:143], v[212:215], v[232:235], a[128:143]
    ds_read_b64_tr_b16 v[228:229], v51 offset:35840
    ds_read_b64_tr_b16 v[230:231], v51 offset:36096
    ds_read_b128 v[176:179], v49 offset:2560
    ds_read_b128 v[180:183], v49 offset:2576
    v_fma_f32 v24, v24, v4, v6
    v_fma_f32 v25, v25, v4, v6
    v_fma_f32 v26, v26, v4, v6
    v_fma_f32 v27, v27, v4, v6
    v_fma_f32 v28, v28, v4, v6
    v_fma_f32 v29, v29, v4, v6
    v_fma_f32 v30, v30, v4, v6
    v_fma_f32 v31, v31, v4, v6
    v_mfma_f32_32x32x16_bf16 a[144:159], v[232:235], v[216:219], a[144:159]
    s_waitcnt lgkmcnt(8)
    ds_read_b128 v[184:187], v49 offset:768
    ds_read_b128 v[188:191], v49 offset:784
    v_fma_f32 v24, v24, v192, v200
    v_fma_f32 v25, v25, v193, v201
    v_fma_f32 v26, v26, v194, v202
    v_fma_f32 v27, v27, v195, v203
    v_fma_f32 v28, v28, v196, v204
    v_fma_f32 v29, v29, v197, v205
    v_fma_f32 v30, v30, v198, v206
    v_fma_f32 v31, v31, v199, v207
    v_cvt_pk_bf16_f32 v236, v24, v25
    v_cvt_pk_bf16_f32 v237, v26, v27
    v_cvt_pk_bf16_f32 v238, v28, v29
    v_cvt_pk_bf16_f32 v239, v30, v31
    s_add_u32 m0, s75, 0
    s_nop 0
    buffer_load_dwordx4 v41, s[96:99], s82 offen lds
    s_waitcnt lgkmcnt(4)
    s_waitcnt vmcnt(11)
    s_barrier
    v_mfma_f32_32x32x16_bf16 a[112:127], v[220:223], v[236:239], a[112:127]
    ds_read_b64_tr_b16 v[208:209], v48 offset:0
    ds_read_b64_tr_b16 v[210:211], v48 offset:256
    ds_read_b64_tr_b16 v[212:213], v48 offset:1024
    ds_read_b64_tr_b16 v[214:215], v48 offset:1280
    v_lshlrev_b32 v24, 16, v112
    v_and_b32 v25, s56, v112
    v_lshlrev_b32 v26, 16, v113
    v_and_b32 v27, s56, v113
    v_lshlrev_b32 v28, 16, v114
    v_and_b32 v29, s56, v114
    v_lshlrev_b32 v30, 16, v115
    v_and_b32 v31, s56, v115
    v_mfma_f32_32x32x16_bf16 a[128:143], v[224:227], v[236:239], a[128:143]
    ds_read_b64_tr_b16 v[216:217], v48 offset:2048
    ds_read_b64_tr_b16 v[218:219], v48 offset:2304
    ds_read_b128 v[192:195], v49 offset:2624
    ds_read_b128 v[196:199], v49 offset:2640
    v_fma_f32 v24, v24, v4, v6
    v_fma_f32 v25, v25, v4, v6
    v_fma_f32 v26, v26, v4, v6
    v_fma_f32 v27, v27, v4, v6
    v_fma_f32 v28, v28, v4, v6
    v_fma_f32 v29, v29, v4, v6
    v_fma_f32 v30, v30, v4, v6
    v_fma_f32 v31, v31, v4, v6
    v_mfma_f32_32x32x16_bf16 a[144:159], v[236:239], v[228:231], a[144:159]
    s_waitcnt lgkmcnt(8)
    ds_read_b128 v[200:203], v49 offset:832
    ds_read_b128 v[204:207], v49 offset:848
    v_fma_f32 v24, v24, v176, v184
    v_fma_f32 v25, v25, v177, v185
    v_fma_f32 v26, v26, v178, v186
    v_fma_f32 v27, v27, v179, v187
    v_fma_f32 v28, v28, v180, v188
    v_fma_f32 v29, v29, v181, v189
    v_fma_f32 v30, v30, v182, v190
    v_fma_f32 v31, v31, v183, v191
    v_cvt_pk_bf16_f32 v232, v24, v25
    v_cvt_pk_bf16_f32 v233, v26, v27
    v_cvt_pk_bf16_f32 v234, v28, v29
    v_cvt_pk_bf16_f32 v235, v30, v31
    s_add_u32 m0, s75, 1024
    s_add_u32 s64, s82, s83
    buffer_load_dwordx4 v41, s[96:99], s64 offen lds
    s_waitcnt lgkmcnt(4)
    v_mfma_f32_32x32x16_bf16 a[112:127], v[208:211], v[232:235], a[112:127]
    ds_read_b64_tr_b16 v[220:221], v48 offset:28672
    ds_read_b64_tr_b16 v[222:223], v48 offset:28928
    ds_read_b64_tr_b16 v[224:225], v48 offset:29696
    ds_read_b64_tr_b16 v[226:227], v48 offset:29952
    v_lshlrev_b32 v24, 16, v116
    v_and_b32 v25, s56, v116
    v_lshlrev_b32 v26, 16, v117
    v_and_b32 v27, s56, v117
    v_lshlrev_b32 v28, 16, v118
    v_and_b32 v29, s56, v118
    v_lshlrev_b32 v30, 16, v119
    v_and_b32 v31, s56, v119
    v_mfma_f32_32x32x16_bf16 a[128:143], v[212:215], v[232:235], a[128:143]
    ds_read_b64_tr_b16 v[228:229], v48 offset:30720
    ds_read_b64_tr_b16 v[230:231], v48 offset:30976
    ds_read_b128 v[176:179], v49 offset:2688
    ds_read_b128 v[180:183], v49 offset:2704
    v_fma_f32 v24, v24, v4, v6
    v_fma_f32 v25, v25, v4, v6
    v_fma_f32 v26, v26, v4, v6
    v_fma_f32 v27, v27, v4, v6
    v_fma_f32 v28, v28, v4, v6
    v_fma_f32 v29, v29, v4, v6
    v_fma_f32 v30, v30, v4, v6
    v_fma_f32 v31, v31, v4, v6
    v_mfma_f32_32x32x16_bf16 a[144:159], v[232:235], v[216:219], a[144:159]
    s_waitcnt lgkmcnt(8)
    ds_read_b128 v[184:187], v49 offset:896
    ds_read_b128 v[188:191], v49 offset:912
    v_fma_f32 v24, v24, v192, v200
    v_fma_f32 v25, v25, v193, v201
    v_fma_f32 v26, v26, v194, v202
    v_fma_f32 v27, v27, v195, v203
    v_fma_f32 v28, v28, v196, v204
    v_fma_f32 v29, v29, v197, v205
    v_fma_f32 v30, v30, v198, v206
    v_fma_f32 v31, v31, v199, v207
    v_cvt_pk_bf16_f32 v236, v24, v25
    v_cvt_pk_bf16_f32 v237, v26, v27
    v_cvt_pk_bf16_f32 v238, v28, v29
    v_cvt_pk_bf16_f32 v239, v30, v31
    s_add_u32 m0, s75, 2048
    s_nop 0
    buffer_load_dwordx4 v41, s[48:51], s84 offen lds
    s_waitcnt lgkmcnt(4)
    v_mfma_f32_32x32x16_bf16 a[112:127], v[220:223], v[236:239], a[112:127]
    ds_read_b64_tr_b16 v[208:209], v50 offset:0
    ds_read_b64_tr_b16 v[210:211], v50 offset:256
    ds_read_b64_tr_b16 v[212:213], v50 offset:1024
    ds_read_b64_tr_b16 v[214:215], v50 offset:1280
    v_lshlrev_b32 v24, 16, v120
    v_and_b32 v25, s56, v120
    v_lshlrev_b32 v26, 16, v121
    v_and_b32 v27, s56, v121
    v_lshlrev_b32 v28, 16, v122
    v_and_b32 v29, s56, v122
    v_lshlrev_b32 v30, 16, v123
    v_and_b32 v31, s56, v123
    v_mfma_f32_32x32x16_bf16 a[128:143], v[224:227], v[236:239], a[128:143]
    ds_read_b64_tr_b16 v[216:217], v50 offset:2048
    ds_read_b64_tr_b16 v[218:219], v50 offset:2304
    ds_read_b128 v[192:195], v49 offset:2752
    ds_read_b128 v[196:199], v49 offset:2768
    v_fma_f32 v24, v24, v4, v6
    v_fma_f32 v25, v25, v4, v6
    v_fma_f32 v26, v26, v4, v6
    v_fma_f32 v27, v27, v4, v6
    v_fma_f32 v28, v28, v4, v6
    v_fma_f32 v29, v29, v4, v6
    v_fma_f32 v30, v30, v4, v6
    v_fma_f32 v31, v31, v4, v6
    v_mfma_f32_32x32x16_bf16 a[144:159], v[236:239], v[228:231], a[144:159]
    s_waitcnt lgkmcnt(8)
    ds_read_b128 v[200:203], v49 offset:960
    ds_read_b128 v[204:207], v49 offset:976
    v_fma_f32 v24, v24, v176, v184
    v_fma_f32 v25, v25, v177, v185
    v_fma_f32 v26, v26, v178, v186
    v_fma_f32 v27, v27, v179, v187
    v_fma_f32 v28, v28, v180, v188
    v_fma_f32 v29, v29, v181, v189
    v_fma_f32 v30, v30, v182, v190
    v_fma_f32 v31, v31, v183, v191
    v_cvt_pk_bf16_f32 v232, v24, v25
    v_cvt_pk_bf16_f32 v233, v26, v27
    v_cvt_pk_bf16_f32 v234, v28, v29
    v_cvt_pk_bf16_f32 v235, v30, v31
    s_add_u32 m0, s75, 3072
    s_add_u32 s64, s84, s83
    buffer_load_dwordx4 v41, s[48:51], s64 offen lds
    s_waitcnt lgkmcnt(4)
    v_mfma_f32_32x32x16_bf16 a[112:127], v[208:211], v[232:235], a[112:127]
    ds_read_b64_tr_b16 v[220:221], v50 offset:28672
    ds_read_b64_tr_b16 v[222:223], v50 offset:28928
    ds_read_b64_tr_b16 v[224:225], v50 offset:29696
    ds_read_b64_tr_b16 v[226:227], v50 offset:29952
    v_lshlrev_b32 v24, 16, v124
    v_and_b32 v25, s56, v124
    v_lshlrev_b32 v26, 16, v125
    v_and_b32 v27, s56, v125
    v_lshlrev_b32 v28, 16, v126
    v_and_b32 v29, s56, v126
    v_lshlrev_b32 v30, 16, v127
    v_and_b32 v31, s56, v127
    v_mfma_f32_32x32x16_bf16 a[128:143], v[212:215], v[232:235], a[128:143]
    ds_read_b64_tr_b16 v[228:229], v50 offset:30720
    ds_read_b64_tr_b16 v[230:231], v50 offset:30976
    ds_read_b128 v[176:179], v49 offset:2816
    ds_read_b128 v[180:183], v49 offset:2832
    v_fma_f32 v24, v24, v4, v6
    v_fma_f32 v25, v25, v4, v6
    v_fma_f32 v26, v26, v4, v6
    v_fma_f32 v27, v27, v4, v6
    v_fma_f32 v28, v28, v4, v6
    v_fma_f32 v29, v29, v4, v6
    v_fma_f32 v30, v30, v4, v6
    v_fma_f32 v31, v31, v4, v6
    v_mfma_f32_32x32x16_bf16 a[144:159], v[232:235], v[216:219], a[144:159]
    s_waitcnt lgkmcnt(8)
    ds_read_b128 v[184:187], v49 offset:1024
    ds_read_b128 v[188:191], v49 offset:1040
    v_fma_f32 v24, v24, v192, v200
    v_fma_f32 v25, v25, v193, v201
    v_fma_f32 v26, v26, v194, v202
    v_fma_f32 v27, v27, v195, v203
    v_fma_f32 v28, v28, v196, v204
    v_fma_f32 v29, v29, v197, v205
    v_fma_f32 v30, v30, v198, v206
    v_fma_f32 v31, v31, v199, v207
    v_cvt_pk_bf16_f32 v236, v24, v25
    v_cvt_pk_bf16_f32 v237, v26, v27
    v_cvt_pk_bf16_f32 v238, v28, v29
    v_cvt_pk_bf16_f32 v239, v30, v31
    s_add_u32 m0, s75, 4096
    s_nop 0
    buffer_load_dwordx4 v41, s[96:99], s85 offen lds
    s_waitcnt lgkmcnt(4)
    s_waitcnt vmcnt(12)
    s_barrier
    v_mfma_f32_32x32x16_bf16 a[112:127], v[220:223], v[236:239], a[112:127]
    ds_read_b64_tr_b16 v[208:209], v48 offset:3072
    ds_read_b64_tr_b16 v[210:211], v48 offset:3328
    ds_read_b64_tr_b16 v[212:213], v48 offset:4096
    ds_read_b64_tr_b16 v[214:215], v48 offset:4352
    v_lshlrev_b32 v24, 16, v128
    v_and_b32 v25, s56, v128
    v_lshlrev_b32 v26, 16, v129
    v_and_b32 v27, s56, v129
    v_lshlrev_b32 v28, 16, v130
    v_and_b32 v29, s56, v130
    v_lshlrev_b32 v30, 16, v131
    v_and_b32 v31, s56, v131
    v_mfma_f32_32x32x16_bf16 a[128:143], v[224:227], v[236:239], a[128:143]
    ds_read_b64_tr_b16 v[216:217], v48 offset:5120
    ds_read_b64_tr_b16 v[218:219], v48 offset:5376
    ds_read_b128 v[192:195], v49 offset:2880
    ds_read_b128 v[196:199], v49 offset:2896
    v_fma_f32 v24, v24, v4, v6
    v_fma_f32 v25, v25, v4, v6
    v_fma_f32 v26, v26, v4, v6
    v_fma_f32 v27, v27, v4, v6
    v_fma_f32 v28, v28, v4, v6
    v_fma_f32 v29, v29, v4, v6
    v_fma_f32 v30, v30, v4, v6
    v_fma_f32 v31, v31, v4, v6
    v_mfma_f32_32x32x16_bf16 a[144:159], v[236:239], v[228:231], a[144:159]
    s_waitcnt lgkmcnt(8)
    ds_read_b128 v[200:203], v49 offset:1088
    ds_read_b128 v[204:207], v49 offset:1104
    v_fma_f32 v24, v24, v176, v184
    v_fma_f32 v25, v25, v177, v185
    v_fma_f32 v26, v26, v178, v186
    v_fma_f32 v27, v27, v179, v187
    v_fma_f32 v28, v28, v180, v188
    v_fma_f32 v29, v29, v181, v189
    v_fma_f32 v30, v30, v182, v190
    v_fma_f32 v31, v31, v183, v191
    v_cvt_pk_bf16_f32 v232, v24, v25
    v_cvt_pk_bf16_f32 v233, v26, v27
    v_cvt_pk_bf16_f32 v234, v28, v29
    v_cvt_pk_bf16_f32 v235, v30, v31
    s_add_u32 m0, s75, 5120
    s_add_u32 s85, s85, s83
    buffer_load_dwordx4 v41, s[96:99], s85 offen lds
    s_waitcnt lgkmcnt(4)
    v_mfma_f32_32x32x16_bf16 a[112:127], v[208:211], v[232:235], a[112:127]
    ds_read_b64_tr_b16 v[220:221], v48 offset:31744
    ds_read_b64_tr_b16 v[222:223], v48 offset:32000
    ds_read_b64_tr_b16 v[224:225], v48 offset:32768
    ds_read_b64_tr_b16 v[226:227], v48 offset:33024
    v_lshlrev_b32 v24, 16, v132
    v_and_b32 v25, s56, v132
    v_lshlrev_b32 v26, 16, v133
    v_and_b32 v27, s56, v133
    v_lshlrev_b32 v28, 16, v134
    v_and_b32 v29, s56, v134
    v_lshlrev_b32 v30, 16, v135
    v_and_b32 v31, s56, v135
    v_mfma_f32_32x32x16_bf16 a[128:143], v[212:215], v[232:235], a[128:143]
    ds_read_b64_tr_b16 v[228:229], v48 offset:33792
    ds_read_b64_tr_b16 v[230:231], v48 offset:34048
    ds_read_b128 v[176:179], v49 offset:2944
    ds_read_b128 v[180:183], v49 offset:2960
    v_fma_f32 v24, v24, v4, v6
    v_fma_f32 v25, v25, v4, v6
    v_fma_f32 v26, v26, v4, v6
    v_fma_f32 v27, v27, v4, v6
    v_fma_f32 v28, v28, v4, v6
    v_fma_f32 v29, v29, v4, v6
    v_fma_f32 v30, v30, v4, v6
    v_fma_f32 v31, v31, v4, v6
    v_mfma_f32_32x32x16_bf16 a[144:159], v[232:235], v[216:219], a[144:159]
    s_waitcnt lgkmcnt(8)
    ds_read_b128 v[184:187], v49 offset:1152
    ds_read_b128 v[188:191], v49 offset:1168
    v_fma_f32 v24, v24, v192, v200
    v_fma_f32 v25, v25, v193, v201
    v_fma_f32 v26, v26, v194, v202
    v_fma_f32 v27, v27, v195, v203
    v_fma_f32 v28, v28, v196, v204
    v_fma_f32 v29, v29, v197, v205
    v_fma_f32 v30, v30, v198, v206
    v_fma_f32 v31, v31, v199, v207
    v_cvt_pk_bf16_f32 v236, v24, v25
    v_cvt_pk_bf16_f32 v237, v26, v27
    v_cvt_pk_bf16_f32 v238, v28, v29
    v_cvt_pk_bf16_f32 v239, v30, v31
    s_add_u32 m0, s75, 6144
    s_add_u32 s85, s85, s83
    buffer_load_dwordx4 v41, s[96:99], s85 offen lds
    s_waitcnt lgkmcnt(4)
    v_mfma_f32_32x32x16_bf16 a[112:127], v[220:223], v[236:239], a[112:127]
    ds_read_b64_tr_b16 v[208:209], v50 offset:3072
    ds_read_b64_tr_b16 v[210:211], v50 offset:3328
    ds_read_b64_tr_b16 v[212:213], v50 offset:4096
    ds_read_b64_tr_b16 v[214:215], v50 offset:4352
    v_lshlrev_b32 v24, 16, v136
    v_and_b32 v25, s56, v136
    v_lshlrev_b32 v26, 16, v137
    v_and_b32 v27, s56, v137
    v_lshlrev_b32 v28, 16, v138
    v_and_b32 v29, s56, v138
    v_lshlrev_b32 v30, 16, v139
    v_and_b32 v31, s56, v139
    v_mfma_f32_32x32x16_bf16 a[128:143], v[224:227], v[236:239], a[128:143]
    ds_read_b64_tr_b16 v[216:217], v50 offset:5120
    ds_read_b64_tr_b16 v[218:219], v50 offset:5376
    ds_read_b128 v[192:195], v49 offset:3008
    ds_read_b128 v[196:199], v49 offset:3024
    v_fma_f32 v24, v24, v4, v6
    v_fma_f32 v25, v25, v4, v6
    v_fma_f32 v26, v26, v4, v6
    v_fma_f32 v27, v27, v4, v6
    v_fma_f32 v28, v28, v4, v6
    v_fma_f32 v29, v29, v4, v6
    v_fma_f32 v30, v30, v4, v6
    v_fma_f32 v31, v31, v4, v6
    v_mfma_f32_32x32x16_bf16 a[144:159], v[236:239], v[228:231], a[144:159]
    s_waitcnt lgkmcnt(8)
    ds_read_b128 v[200:203], v49 offset:1216
    ds_read_b128 v[204:207], v49 offset:1232
    v_fma_f32 v24, v24, v176, v184
    v_fma_f32 v25, v25, v177, v185
    v_fma_f32 v26, v26, v178, v186
    v_fma_f32 v27, v27, v179, v187
    v_fma_f32 v28, v28, v180, v188
    v_fma_f32 v29, v29, v181, v189
    v_fma_f32 v30, v30, v182, v190
    v_fma_f32 v31, v31, v183, v191
    v_cvt_pk_bf16_f32 v232, v24, v25
    v_cvt_pk_bf16_f32 v233, v26, v27
    v_cvt_pk_bf16_f32 v234, v28, v29
    v_cvt_pk_bf16_f32 v235, v30, v31
    s_add_u32 m0, s75, 7168
    s_add_u32 s85, s85, s83
    buffer_load_dwordx4 v41, s[96:99], s85 offen lds
    s_waitcnt lgkmcnt(4)
    v_mfma_f32_32x32x16_bf16 a[112:127], v[208:211], v[232:235], a[112:127]
    ds_read_b64_tr_b16 v[220:221], v50 offset:31744
    ds_read_b64_tr_b16 v[222:223], v50 offset:32000
    ds_read_b64_tr_b16 v[224:225], v50 offset:32768
    ds_read_b64_tr_b16 v[226:227], v50 offset:33024
    v_lshlrev_b32 v24, 16, v140
    v_and_b32 v25, s56, v140
    v_lshlrev_b32 v26, 16, v141
    v_and_b32 v27, s56, v141
    v_lshlrev_b32 v28, 16, v142
    v_and_b32 v29, s56, v142
    v_lshlrev_b32 v30, 16, v143
    v_and_b32 v31, s56, v143
    v_mfma_f32_32x32x16_bf16 a[128:143], v[212:215], v[232:235], a[128:143]
    ds_read_b64_tr_b16 v[228:229], v50 offset:33792
    ds_read_b64_tr_b16 v[230:231], v50 offset:34048
    ds_read_b128 v[176:179], v49 offset:3072
    ds_read_b128 v[180:183], v49 offset:3088
    v_fma_f32 v24, v24, v4, v6
    v_fma_f32 v25, v25, v4, v6
    v_fma_f32 v26, v26, v4, v6
    v_fma_f32 v27, v27, v4, v6
    v_fma_f32 v28, v28, v4, v6
    v_fma_f32 v29, v29, v4, v6
    v_fma_f32 v30, v30, v4, v6
    v_fma_f32 v31, v31, v4, v6
    v_mfma_f32_32x32x16_bf16 a[144:159], v[232:235], v[216:219], a[144:159]
    s_waitcnt lgkmcnt(8)
    ds_read_b128 v[184:187], v49 offset:1280
    ds_read_b128 v[188:191], v49 offset:1296
    v_fma_f32 v24, v24, v192, v200
    v_fma_f32 v25, v25, v193, v201
    v_fma_f32 v26, v26, v194, v202
    v_fma_f32 v27, v27, v195, v203
    v_fma_f32 v28, v28, v196, v204
    v_fma_f32 v29, v29, v197, v205
    v_fma_f32 v30, v30, v198, v206
    v_fma_f32 v31, v31, v199, v207
    v_cvt_pk_bf16_f32 v236, v24, v25
    v_cvt_pk_bf16_f32 v237, v26, v27
    v_cvt_pk_bf16_f32 v238, v28, v29
    v_cvt_pk_bf16_f32 v239, v30, v31
    buffer_load_dwordx4 v[240:243], v255, s[44:47], s72 offen offset:1792
    s_waitcnt lgkmcnt(4)
    s_waitcnt vmcnt(13)
    s_barrier
    v_mfma_f32_32x32x16_bf16 a[112:127], v[220:223], v[236:239], a[112:127]
    ds_read_b64_tr_b16 v[208:209], v48 offset:6144
    ds_read_b64_tr_b16 v[210:211], v48 offset:6400
    ds_read_b64_tr_b16 v[212:213], v48 offset:7168
    ds_read_b64_tr_b16 v[214:215], v48 offset:7424
    v_lshlrev_b32 v24, 16, v144
    v_and_b32 v25, s56, v144
    v_lshlrev_b32 v26, 16, v145
    v_and_b32 v27, s56, v145
    v_lshlrev_b32 v28, 16, v146
    v_and_b32 v29, s56, v146
    v_lshlrev_b32 v30, 16, v147
    v_and_b32 v31, s56, v147
    v_mfma_f32_32x32x16_bf16 a[128:143], v[224:227], v[236:239], a[128:143]
    ds_read_b64_tr_b16 v[216:217], v48 offset:8192
    ds_read_b64_tr_b16 v[218:219], v48 offset:8448
    ds_read_b128 v[192:195], v49 offset:3136
    ds_read_b128 v[196:199], v49 offset:3152
    v_fma_f32 v24, v24, v4, v6
    v_fma_f32 v25, v25, v4, v6
    v_fma_f32 v26, v26, v4, v6
    v_fma_f32 v27, v27, v4, v6
    v_fma_f32 v28, v28, v4, v6
    v_fma_f32 v29, v29, v4, v6
    v_fma_f32 v30, v30, v4, v6
    v_fma_f32 v31, v31, v4, v6
    v_mfma_f32_32x32x16_bf16 a[144:159], v[236:239], v[228:231], a[144:159]
    s_waitcnt lgkmcnt(8)
    ds_read_b128 v[200:203], v49 offset:1344
    ds_read_b128 v[204:207], v49 offset:1360
    v_fma_f32 v24, v24, v176, v184
    v_fma_f32 v25, v25, v177, v185
    v_fma_f32 v26, v26, v178, v186
    v_fma_f32 v27, v27, v179, v187
    v_fma_f32 v28, v28, v180, v188
    v_fma_f32 v29, v29, v181, v189
    v_fma_f32 v30, v30, v182, v190
    v_fma_f32 v31, v31, v183, v191
    v_cvt_pk_bf16_f32 v232, v24, v25
    v_cvt_pk_bf16_f32 v233, v26, v27
    v_cvt_pk_bf16_f32 v234, v28, v29
    v_cvt_pk_bf16_f32 v235, v30, v31
    buffer_load_dwordx4 v[244:247], v255, s[44:47], s72 offen offset:3584
    s_waitcnt lgkmcnt(4)
    v_mfma_f32_32x32x16_bf16 a[112:127], v[208:211], v[232:235], a[112:127]
    ds_read_b64_tr_b16 v[220:221], v48 offset:34816
    ds_read_b64_tr_b16 v[222:223], v48 offset:35072
    ds_read_b64_tr_b16 v[224:225], v48 offset:35840
    ds_read_b64_tr_b16 v[226:227], v48 offset:36096
    v_lshlrev_b32 v24, 16, v148
    v_and_b32 v25, s56, v148
    v_lshlrev_b32 v26, 16, v149
    v_and_b32 v27, s56, v149
    v_lshlrev_b32 v28, 16, v150
    v_and_b32 v29, s56, v150
    v_lshlrev_b32 v30, 16, v151
    v_and_b32 v31, s56, v151
    v_mfma_f32_32x32x16_bf16 a[128:143], v[212:215], v[232:235], a[128:143]
    ds_read_b64_tr_b16 v[228:229], v48 offset:36864
    ds_read_b64_tr_b16 v[230:231], v48 offset:37120
    ds_read_b128 v[176:179], v49 offset:3200
    ds_read_b128 v[180:183], v49 offset:3216
    v_fma_f32 v24, v24, v4, v6
    v_fma_f32 v25, v25, v4, v6
    v_fma_f32 v26, v26, v4, v6
    v_fma_f32 v27, v27, v4, v6
    v_fma_f32 v28, v28, v4, v6
    v_fma_f32 v29, v29, v4, v6
    v_fma_f32 v30, v30, v4, v6
    v_fma_f32 v31, v31, v4, v6
    v_mfma_f32_32x32x16_bf16 a[144:159], v[232:235], v[216:219], a[144:159]
    s_waitcnt lgkmcnt(8)
    ds_read_b128 v[184:187], v49 offset:1408
    ds_read_b128 v[188:191], v49 offset:1424
    v_fma_f32 v24, v24, v192, v200
    v_fma_f32 v25, v25, v193, v201
    v_fma_f32 v26, v26, v194, v202
    v_fma_f32 v27, v27, v195, v203
    v_fma_f32 v28, v28, v196, v204
    v_fma_f32 v29, v29, v197, v205
    v_fma_f32 v30, v30, v198, v206
    v_fma_f32 v31, v31, v199, v207
    v_cvt_pk_bf16_f32 v236, v24, v25
    v_cvt_pk_bf16_f32 v237, v26, v27
    v_cvt_pk_bf16_f32 v238, v28, v29
    v_cvt_pk_bf16_f32 v239, v30, v31
    s_waitcnt lgkmcnt(4)
    s_nop 0
    v_mfma_f32_32x32x16_bf16 a[112:127], v[220:223], v[236:239], a[112:127]
    ds_read_b64_tr_b16 v[208:209], v50 offset:6144
    ds_read_b64_tr_b16 v[210:211], v50 offset:6400
    ds_read_b64_tr_b16 v[212:213], v50 offset:7168
    ds_read_b64_tr_b16 v[214:215], v50 offset:7424
    v_lshlrev_b32 v24, 16, v152
    v_and_b32 v25, s56, v152
    v_lshlrev_b32 v26, 16, v153
    v_and_b32 v27, s56, v153
    v_lshlrev_b32 v28, 16, v154
    v_and_b32 v29, s56, v154
    v_lshlrev_b32 v30, 16, v155
    v_and_b32 v31, s56, v155
    v_mfma_f32_32x32x16_bf16 a[128:143], v[224:227], v[236:239], a[128:143]
    ds_read_b64_tr_b16 v[216:217], v50 offset:8192
    ds_read_b64_tr_b16 v[218:219], v50 offset:8448
    ds_read_b128 v[192:195], v49 offset:3264
    ds_read_b128 v[196:199], v49 offset:3280
    v_fma_f32 v24, v24, v4, v6
    v_fma_f32 v25, v25, v4, v6
    v_fma_f32 v26, v26, v4, v6
    v_fma_f32 v27, v27, v4, v6
    v_fma_f32 v28, v28, v4, v6
    v_fma_f32 v29, v29, v4, v6
    v_fma_f32 v30, v30, v4, v6
    v_fma_f32 v31, v31, v4, v6
    v_mfma_f32_32x32x16_bf16 a[144:159], v[236:239], v[228:231], a[144:159]
    s_waitcnt lgkmcnt(8)
    ds_read_b128 v[200:203], v49 offset:1472
    ds_read_b128 v[204:207], v49 offset:1488
    v_fma_f32 v24, v24, v176, v184
    v_fma_f32 v25, v25, v177, v185
    v_fma_f32 v26, v26, v178, v186
    v_fma_f32 v27, v27, v179, v187
    v_fma_f32 v28, v28, v180, v188
    v_fma_f32 v29, v29, v181, v189
    v_fma_f32 v30, v30, v182, v190
    v_fma_f32 v31, v31, v183, v191
    v_cvt_pk_bf16_f32 v232, v24, v25
    v_cvt_pk_bf16_f32 v233, v26, v27
    v_cvt_pk_bf16_f32 v234, v28, v29
    v_cvt_pk_bf16_f32 v235, v30, v31
    s_waitcnt lgkmcnt(4)
    s_nop 0
    v_mfma_f32_32x32x16_bf16 a[112:127], v[208:211], v[232:235], a[112:127]
    ds_read_b64_tr_b16 v[220:221], v50 offset:34816
    ds_read_b64_tr_b16 v[222:223], v50 offset:35072
    ds_read_b64_tr_b16 v[224:225], v50 offset:35840
    ds_read_b64_tr_b16 v[226:227], v50 offset:36096
    v_lshlrev_b32 v24, 16, v156
    v_and_b32 v25, s56, v156
    v_lshlrev_b32 v26, 16, v157
    v_and_b32 v27, s56, v157
    v_lshlrev_b32 v28, 16, v158
    v_and_b32 v29, s56, v158
    v_lshlrev_b32 v30, 16, v159
    v_and_b32 v31, s56, v159
    v_mfma_f32_32x32x16_bf16 a[128:143], v[212:215], v[232:235], a[128:143]
    ds_read_b64_tr_b16 v[228:229], v50 offset:36864
    ds_read_b64_tr_b16 v[230:231], v50 offset:37120
    ds_read_b128 v[176:179], v49 offset:3328
    ds_read_b128 v[180:183], v49 offset:3344
    v_fma_f32 v24, v24, v4, v6
    v_fma_f32 v25, v25, v4, v6
    v_fma_f32 v26, v26, v4, v6
    v_fma_f32 v27, v27, v4, v6
    v_fma_f32 v28, v28, v4, v6
    v_fma_f32 v29, v29, v4, v6
    v_fma_f32 v30, v30, v4, v6
    v_fma_f32 v31, v31, v4, v6
    v_mfma_f32_32x32x16_bf16 a[144:159], v[232:235], v[216:219], a[144:159]
    s_waitcnt lgkmcnt(8)
    ds_read_b128 v[184:187], v49 offset:1536
    ds_read_b128 v[188:191], v49 offset:1552
    v_fma_f32 v24, v24, v192, v200
    v_fma_f32 v25, v25, v193, v201
    v_fma_f32 v26, v26, v194, v202
    v_fma_f32 v27, v27, v195, v203
    v_fma_f32 v28, v28, v196, v204
    v_fma_f32 v29, v29, v197, v205
    v_fma_f32 v30, v30, v198, v206
    v_fma_f32 v31, v31, v199, v207
    v_cvt_pk_bf16_f32 v236, v24, v25
    v_cvt_pk_bf16_f32 v237, v26, v27
    v_cvt_pk_bf16_f32 v238, v28, v29
    v_cvt_pk_bf16_f32 v239, v30, v31
    s_waitcnt lgkmcnt(4)
    s_waitcnt vmcnt(11)
    s_barrier
    v_mfma_f32_32x32x16_bf16 a[112:127], v[220:223], v[236:239], a[112:127]
    ds_read_b64_tr_b16 v[208:209], v48 offset:9216
    ds_read_b64_tr_b16 v[210:211], v48 offset:9472
    ds_read_b64_tr_b16 v[212:213], v48 offset:10240
    ds_read_b64_tr_b16 v[214:215], v48 offset:10496
    v_lshlrev_b32 v24, 16, v160
    v_and_b32 v25, s56, v160
    v_lshlrev_b32 v26, 16, v161
    v_and_b32 v27, s56, v161
    v_lshlrev_b32 v28, 16, v162
    v_and_b32 v29, s56, v162
    v_lshlrev_b32 v30, 16, v163
    v_and_b32 v31, s56, v163
    v_mfma_f32_32x32x16_bf16 a[128:143], v[224:227], v[236:239], a[128:143]
    ds_read_b64_tr_b16 v[216:217], v48 offset:11264
    ds_read_b64_tr_b16 v[218:219], v48 offset:11520
    ds_read_b128 v[192:195], v49 offset:3392
    ds_read_b128 v[196:199], v49 offset:3408
    v_fma_f32 v24, v24, v4, v6
    v_fma_f32 v25, v25, v4, v6
    v_fma_f32 v26, v26, v4, v6
    v_fma_f32 v27, v27, v4, v6
    v_fma_f32 v28, v28, v4, v6
    v_fma_f32 v29, v29, v4, v6
    v_fma_f32 v30, v30, v4, v6
    v_fma_f32 v31, v31, v4, v6
    v_mfma_f32_32x32x16_bf16 a[144:159], v[236:239], v[228:231], a[144:159]
    s_waitcnt lgkmcnt(8)
    ds_read_b128 v[200:203], v49 offset:1600
    ds_read_b128 v[204:207], v49 offset:1616
    v_fma_f32 v24, v24, v176, v184
    v_fma_f32 v25, v25, v177, v185
    v_fma_f32 v26, v26, v178, v186
    v_fma_f32 v27, v27, v179, v187
    v_fma_f32 v28, v28, v180, v188
    v_fma_f32 v29, v29, v181, v189
    v_fma_f32 v30, v30, v182, v190
    v_fma_f32 v31, v31, v183, v191
    v_cvt_pk_bf16_f32 v232, v24, v25
    v_cvt_pk_bf16_f32 v233, v26, v27
    v_cvt_pk_bf16_f32 v234, v28, v29
    v_cvt_pk_bf16_f32 v235, v30, v31
    s_waitcnt lgkmcnt(4)
    s_nop 0
    v_mfma_f32_32x32x16_bf16 a[112:127], v[208:211], v[232:235], a[112:127]
    ds_read_b64_tr_b16 v[220:221], v48 offset:37888
    ds_read_b64_tr_b16 v[222:223], v48 offset:38144
    ds_read_b64_tr_b16 v[224:225], v48 offset:38912
    ds_read_b64_tr_b16 v[226:227], v48 offset:39168
    v_lshlrev_b32 v24, 16, v164
    v_and_b32 v25, s56, v164
    v_lshlrev_b32 v26, 16, v165
    v_and_b32 v27, s56, v165
    v_lshlrev_b32 v28, 16, v166
    v_and_b32 v29, s56, v166
    v_lshlrev_b32 v30, 16, v167
    v_and_b32 v31, s56, v167
    v_mfma_f32_32x32x16_bf16 a[128:143], v[212:215], v[232:235], a[128:143]
    ds_read_b64_tr_b16 v[228:229], v48 offset:39936
    ds_read_b64_tr_b16 v[230:231], v48 offset:40192
    ds_read_b128 v[176:179], v49 offset:3456
    ds_read_b128 v[180:183], v49 offset:3472
    v_fma_f32 v24, v24, v4, v6
    v_fma_f32 v25, v25, v4, v6
    v_fma_f32 v26, v26, v4, v6
    v_fma_f32 v27, v27, v4, v6
    v_fma_f32 v28, v28, v4, v6
    v_fma_f32 v29, v29, v4, v6
    v_fma_f32 v30, v30, v4, v6
    v_fma_f32 v31, v31, v4, v6
    v_mfma_f32_32x32x16_bf16 a[144:159], v[232:235], v[216:219], a[144:159]
    s_waitcnt lgkmcnt(8)
    ds_read_b128 v[184:187], v49 offset:1664
    ds_read_b128 v[188:191], v49 offset:1680
    v_fma_f32 v24, v24, v192, v200
    v_fma_f32 v25, v25, v193, v201
    v_fma_f32 v26, v26, v194, v202
    v_fma_f32 v27, v27, v195, v203
    v_fma_f32 v28, v28, v196, v204
    v_fma_f32 v29, v29, v197, v205
    v_fma_f32 v30, v30, v198, v206
    v_fma_f32 v31, v31, v199, v207
    v_cvt_pk_bf16_f32 v236, v24, v25
    v_cvt_pk_bf16_f32 v237, v26, v27
    v_cvt_pk_bf16_f32 v238, v28, v29
    v_cvt_pk_bf16_f32 v239, v30, v31
    s_waitcnt lgkmcnt(4)
    s_nop 0
    v_mfma_f32_32x32x16_bf16 a[112:127], v[220:223], v[236:239], a[112:127]
    ds_read_b64_tr_b16 v[208:209], v50 offset:9216
    ds_read_b64_tr_b16 v[210:211], v50 offset:9472
    ds_read_b64_tr_b16 v[212:213], v50 offset:10240
    ds_read_b64_tr_b16 v[214:215], v50 offset:10496
    v_lshlrev_b32 v24, 16, v168
    v_and_b32 v25, s56, v168
    v_lshlrev_b32 v26, 16, v169
    v_and_b32 v27, s56, v169
    v_lshlrev_b32 v28, 16, v170
    v_and_b32 v29, s56, v170
    v_lshlrev_b32 v30, 16, v171
    v_and_b32 v31, s56, v171
    v_mfma_f32_32x32x16_bf16 a[128:143], v[224:227], v[236:239], a[128:143]
    ds_read_b64_tr_b16 v[216:217], v50 offset:11264
    ds_read_b64_tr_b16 v[218:219], v50 offset:11520
    ds_read_b128 v[192:195], v49 offset:3520
    ds_read_b128 v[196:199], v49 offset:3536
    v_fma_f32 v24, v24, v4, v6
    v_fma_f32 v25, v25, v4, v6
    v_fma_f32 v26, v26, v4, v6
    v_fma_f32 v27, v27, v4, v6
    v_fma_f32 v28, v28, v4, v6
    v_fma_f32 v29, v29, v4, v6
    v_fma_f32 v30, v30, v4, v6
    v_fma_f32 v31, v31, v4, v6
    v_mfma_f32_32x32x16_bf16 a[144:159], v[236:239], v[228:231], a[144:159]
    s_waitcnt lgkmcnt(8)
    ds_read_b128 v[200:203], v49 offset:1728
    ds_read_b128 v[204:207], v49 offset:1744
    v_fma_f32 v24, v24, v176, v184
    v_fma_f32 v25, v25, v177, v185
    v_fma_f32 v26, v26, v178, v186
    v_fma_f32 v27, v27, v179, v187
    v_fma_f32 v28, v28, v180, v188
    v_fma_f32 v29, v29, v181, v189
    v_fma_f32 v30, v30, v182, v190
    v_fma_f32 v31, v31, v183, v191
    v_cvt_pk_bf16_f32 v232, v24, v25
    v_cvt_pk_bf16_f32 v233, v26, v27
    v_cvt_pk_bf16_f32 v234, v28, v29
    v_cvt_pk_bf16_f32 v235, v30, v31
    s_waitcnt lgkmcnt(4)
    s_nop 0
    v_mfma_f32_32x32x16_bf16 a[112:127], v[208:211], v[232:235], a[112:127]
    ds_read_b64_tr_b16 v[220:221], v50 offset:37888
    ds_read_b64_tr_b16 v[222:223], v50 offset:38144
    ds_read_b64_tr_b16 v[224:225], v50 offset:38912
    ds_read_b64_tr_b16 v[226:227], v50 offset:39168
    v_lshlrev_b32 v24, 16, v172
    v_and_b32 v25, s56, v172
    v_lshlrev_b32 v26, 16, v173
    v_and_b32 v27, s56, v173
    v_lshlrev_b32 v28, 16, v174
    v_and_b32 v29, s56, v174
    v_lshlrev_b32 v30, 16, v175
    v_and_b32 v31, s56, v175
    v_mfma_f32_32x32x16_bf16 a[128:143], v[212:215], v[232:235], a[128:143]
    ds_read_b64_tr_b16 v[228:229], v50 offset:39936
    ds_read_b64_tr_b16 v[230:231], v50 offset:40192
    v_fma_f32 v24, v24, v4, v6
    v_fma_f32 v25, v25, v4, v6
    v_fma_f32 v26, v26, v4, v6
    v_fma_f32 v27, v27, v4, v6
    v_fma_f32 v28, v28, v4, v6
    v_fma_f32 v29, v29, v4, v6
    v_fma_f32 v30, v30, v4, v6
    v_fma_f32 v31, v31, v4, v6
    v_mfma_f32_32x32x16_bf16 a[144:159], v[232:235], v[216:219], a[144:159]
    s_waitcnt lgkmcnt(6)
    v_fma_f32 v24, v24, v192, v200
    v_fma_f32 v25, v25, v193, v201
    v_fma_f32 v26, v26, v194, v202
    v_fma_f32 v27, v27, v195, v203
    v_fma_f32 v28, v28, v196, v204
    v_fma_f32 v29, v29, v197, v205
    v_fma_f32 v30, v30, v198, v206
    v_fma_f32 v31, v31, v199, v207
    v_cvt_pk_bf16_f32 v236, v24, v25
    v_cvt_pk_bf16_f32 v237, v26, v27
    v_cvt_pk_bf16_f32 v238, v28, v29
    v_cvt_pk_bf16_f32 v239, v30, v31
    s_waitcnt lgkmcnt(0)
    s_nop 0
    v_mfma_f32_32x32x16_bf16 a[112:127], v[220:223], v[236:239], a[112:127]
    v_mfma_f32_32x32x16_bf16 a[128:143], v[224:227], v[236:239], a[128:143]
    v_mfma_f32_32x32x16_bf16 a[144:159], v[236:239], v[228:231], a[144:159]
    v_cmp_gt_u32 vcc, 32, v1
    v_mov_b32 v13, 0x3f803f80
    v_mov_b32 v14, 0x3f80
    v_cndmask_b32_e64 v8, 0, -1, vcc
    v_cndmask_b32_e64 v9, v13, 0, vcc
    v_cndmask_b32_e64 v10, v14, 0, vcc
    v_and_b32 v2, 31, v1
    v_cmp_gt_u32 vcc, 28, v2
    s_nop 1
    v_cndmask_b32_e64 v11, 0, -1, vcc
    v_cmp_eq_u32 vcc, 28, v2
    s_nop 1
    v_cndmask_b32_e64 v12, 0, v13, vcc
    s_lshl_b32 s60, s6, 6
    s_lshl_b32 s64, s5, 2
    s_add_u32 s60, s60, s64
    s_add_u32 s60, s60, s4
    s_lshl_b32 s64, s60, 12
    s_add_u32 s64, s64, 2097152
    s_lshl_b32 s62, s60, 6
    s_add_u32 s62, s62, 1048576
    v_accvgpr_read_b32 v96, a128
    v_accvgpr_read_b32 v97, a129
    v_accvgpr_read_b32 v98, a130
    v_accvgpr_read_b32 v99, a131
    v_accvgpr_read_b32 v100, a132
    v_accvgpr_read_b32 v101, a133
    v_accvgpr_read_b32 v102, a134
    v_accvgpr_read_b32 v103, a135
    v_accvgpr_read_b32 v104, a136
    v_accvgpr_read_b32 v105, a137
    v_accvgpr_read_b32 v106, a138
    v_accvgpr_read_b32 v107, a139
    v_accvgpr_read_b32 v108, a140
    v_accvgpr_read_b32 v109, a141
    v_accvgpr_read_b32 v110, a142
    v_accvgpr_read_b32 v111, a143
    v_cvt_pk_bf16_f32 v64, v96, v97
    v_cvt_pk_bf16_f32 v65, v98, v99
    v_cvt_pk_bf16_f32 v66, v100, v101
    v_cvt_pk_bf16_f32 v67, v102, v103
    v_cvt_pk_bf16_f32 v68, v104, v105
    v_cvt_pk_bf16_f32 v69, v106, v107
    v_cvt_pk_bf16_f32 v70, v108, v109
    v_cvt_pk_bf16_f32 v71, v110, v111
    v_and_or_b32 v70, v70, v8, v9
    v_and_or_b32 v71, v71, v8, v10
    buffer_store_dwordx4 v[64:67], v15, s[40:43], s64 offen sc1
    buffer_store_dwordx4 v[68:71], v15, s[40:43], s64 offen offset:1024 sc1
    v_accvgpr_read_b32 v144, a144
    v_accvgpr_read_b32 v145, a145
    v_accvgpr_read_b32 v146, a146
    v_accvgpr_read_b32 v147, a147
    v_accvgpr_read_b32 v148, a148
    v_accvgpr_read_b32 v149, a149
    v_accvgpr_read_b32 v150, a150
    v_accvgpr_read_b32 v151, a151
    v_accvgpr_read_b32 v152, a152
    v_accvgpr_read_b32 v153, a153
    v_accvgpr_read_b32 v154, a154
    v_accvgpr_read_b32 v155, a155
    v_accvgpr_read_b32 v156, a156
    v_accvgpr_read_b32 v157, a157
    v_accvgpr_read_b32 v158, a158
    v_accvgpr_read_b32 v159, a159
    v_cvt_pk_bf16_f32 v72, v144, v145
    v_cvt_pk_bf16_f32 v73, v146, v147
    v_cvt_pk_bf16_f32 v74, v148, v149
    v_cvt_pk_bf16_f32 v75, v150, v151
    v_cvt_pk_bf16_f32 v76, v152, v153
    v_cvt_pk_bf16_f32 v77, v154, v155
    v_cvt_pk_bf16_f32 v78, v156, v157
    v_cvt_pk_bf16_f32 v79, v158, v159
    v_and_or_b32 v72, v72, v11, v12
    v_and_or_b32 v73, v73, v11, v12
    v_and_or_b32 v74, v74, v11, v12
    v_and_or_b32 v75, v75, v11, v12
    v_and_or_b32 v76, v76, v11, v12
    v_and_or_b32 v77, v77, v11, v12
    v_and_or_b32 v78, v78, v11, v12
    v_and_or_b32 v79, v79, v11, v12
    buffer_store_dwordx4 v[72:75], v15, s[40:43], s64 offen offset:2048 sc1
    buffer_store_dwordx4 v[76:79], v15, s[40:43], s64 offen offset:3072 sc1
    v_accvgpr_read_b32 v96, a112
    v_accvgpr_read_b32 v97, a113
    v_accvgpr_read_b32 v98, a114
    v_accvgpr_read_b32 v99, a115
    v_accvgpr_read_b32 v100, a116
    v_accvgpr_read_b32 v101, a117
    v_accvgpr_read_b32 v102, a118
    v_accvgpr_read_b32 v103, a119
    v_accvgpr_read_b32 v104, a120
    v_accvgpr_read_b32 v105, a121
    v_accvgpr_read_b32 v106, a122
    v_accvgpr_read_b32 v107, a123
    v_accvgpr_read_b32 v108, a124
    v_accvgpr_read_b32 v109, a125
    v_accvgpr_read_b32 v110, a126
    v_accvgpr_read_b32 v111, a127
    v_mul_f32 v96, 0.27264373542131126, v96
    v_mul_f32 v97, 0.27264373542131126, v97
    v_mul_f32 v98, 0.27264373542131126, v98
    v_mul_f32 v99, 0.27264373542131126, v99
    v_mul_f32 v100, 0.27264373542131126, v100
    v_mul_f32 v101, 0.27264373542131126, v101
    v_mul_f32 v102, 0.27264373542131126, v102
    v_mul_f32 v103, 0.27264373542131126, v103
    v_mul_f32 v104, 0.27264373542131126, v104
    v_mul_f32 v105, 0.27264373542131126, v105
    v_mul_f32 v106, 0.27264373542131126, v106
    v_mul_f32 v107, 0.27264373542131126, v107
    v_mul_f32 v108, 0.27264373542131126, v108
    v_mul_f32 v109, 0.27264373542131126, v109
    v_mul_f32 v110, 0.27264373542131126, v110
    v_mul_f32 v111, 0.27264373542131126, v111
    v_cvt_pk_bf16_f32 v120, v96, v97
    v_cvt_pk_bf16_f32 v121, v98, v99
    v_cvt_pk_bf16_f32 v122, v100, v101
    v_cvt_pk_bf16_f32 v123, v102, v103
    v_cvt_pk_bf16_f32 v124, v104, v105
    v_cvt_pk_bf16_f32 v125, v106, v107
    v_cvt_pk_bf16_f32 v126, v108, v109
    v_cvt_pk_bf16_f32 v127, v110, v111
    v_and_b32 v126, v126, v8
    v_and_b32 v127, v127, v8
    v_mfma_f32_32x32x16_bf16 v[128:143], v[64:67], v[120:123], 0
    s_nop 0
    v_mfma_f32_32x32x16_bf16 v[128:143], v[68:71], v[124:127], v[128:143]
    s_nop 11
    v_max3_f32 v128, v128, v129, v130
    v_max3_f32 v131, v131, v132, v133
    v_max3_f32 v134, v134, v135, v136
    v_max3_f32 v137, v137, v138, v139
    v_max3_f32 v140, v140, v141, v142
    v_max3_f32 v128, v128, v131, v134
    v_max3_f32 v137, v137, v140, v143
    v_max_f32 v128, v128, v137
    v_mov_b32 v129, v128
    s_nop 1
    v_permlane32_swap_b32 v128, v129
    v_max_f32 v119, v128, v129
    v_sub_f32 v113, 0, v119
    v_cvt_pk_bf16_f32 v114, v113, v113
    v_and_b32 v114, s56, v114
    v_sub_f32 v113, v113, v114
    v_cvt_pk_bf16_f32 v115, v113, v113
    v_and_b32 v115, s56, v115
    v_sub_f32 v113, v113, v115
    v_cvt_pk_bf16_f32 v116, v114, v115
    v_cvt_pk_bf16_f32 v117, v113, 0
    v_bfi_b32 v126, v8, v126, v116
    v_bfi_b32 v127, v8, v127, v117
    v_mov_b32 v2, 152576
    ds_write_b32 v2, v21
    v_add_u32 v2, s61, v15
    ds_write_b128 v2, v[120:123] offset:24576
    ds_write_b128 v2, v[124:127] offset:25600
    s_mov_b32 s44, s16
    s_mov_b32 s45, s17
    s_mov_b32 s46, 1835008
    s_mov_b32 s47, 0x20000
    v_lshrrev_b32 v2, 2, v1
    v_and_b32 v3, 3, v1
    v_lshlrev_b32 v3, 4, v3
    s_movk_i32 s9, 896
    v_mad_u32_u24 v41, v2, s9, v3
    s_lshr_b32 s9, s12, 2
    s_mul_i32 s71, s9, 7
    s_add_u32 s71, s71, s14
    s_add_u32 s9, s9, 14
    s_cmp_eq_u32 s14, 7
    s_cselect_b32 s71, s9, s71
    s_min_u32 s8, s71, 13
    s_lshl_b32 s69, s8, 6
    s_mul_i32 s9, s4, 100352
    s_add_u32 s69, s69, s9
    s_mul_i32 s63, s4, 7168
    s_add_u32 s63, s63, 118784
    s_mov_b32 s7, 0
    s_lshl_b32 s70, s6, 18
    s_lshl_b32 s9, s4, 12
    s_add_u32 s70, s70, s9
    s_add_u32 s70, s70, 2097152
    s_lshr_b32 s10, s5, 2
    v_lshlrev_b32 v14, 8, v1
    s_xor_b32 s9, s10, 0
    s_lshl_b32 s9, s9, 16
    s_add_u32 s84, s70, s9
    s_xor_b32 s9, s10, 1
    s_lshl_b32 s9, s9, 16
    s_add_u32 s85, s70, s9
    s_xor_b32 s9, s10, 2
    s_lshl_b32 s9, s9, 16
    s_add_u32 s86, s70, s9
    s_xor_b32 s9, s10, 3
    s_lshl_b32 s9, s9, 16
    s_add_u32 s87, s70, s9
    v_accvgpr_write_b32 a96, v64
    v_accvgpr_write_b32 a97, v65
    v_accvgpr_write_b32 a98, v66
    v_accvgpr_write_b32 a99, v67
    v_accvgpr_write_b32 a100, v68
    v_accvgpr_write_b32 a101, v69
    v_accvgpr_write_b32 a102, v70
    v_accvgpr_write_b32 a103, v71
    v_accvgpr_write_b32 a104, v72
    v_accvgpr_write_b32 a105, v73
    v_accvgpr_write_b32 a106, v74
    v_accvgpr_write_b32 a107, v75
    v_accvgpr_write_b32 a108, v76
    v_accvgpr_write_b32 a109, v77
    v_accvgpr_write_b32 a110, v78
    v_accvgpr_write_b32 a111, v79
    s_lshl_b32 s9, s8, 3
    s_lshl_b32 s10, s4, 1
    s_add_u32 s9, s9, s10
    s_mul_i32 s88, s9, 28672
    s_add_u32 s88, s88, 16777216
    s_add_u32 s89, s88, 28672
    s_lshl_b32 s10, s5, 1
    s_add_u32 s10, s10, s71
    s_sub_u32 s10, s10, 14
    s_lshl_b32 s10, s10, 2
    s_add_u32 s10, s10, s4
    s_min_u32 s15, s10, 111
    s_mul_i32 s10, s15, 28672
    s_add_u32 s10, s10, 16777216
    s_cmp_lt_u32 s71, 14
    s_cselect_b32 s88, s88, s10
    s_cselect_b32 s89, s89, 2147418112
    s_cselect_b32 s9, s9, s15
    s_mov_b32 s15, s9
    s_mov_b32 s90, s14
    s_mov_b32 s91, 0
    s_lshr_b32 s9, s9, 2
    s_lshl_b32 s9, s9, 7
    s_add_u32 s9, s9, 53248
    v_min_u32 v2, 27, v1
    v_lshl_add_u32 v2, v2, 2, s9
    s_cmp_ge_u32 s8, 7
    s_cselect_b32 s82, 1, 0
    s_cselect_b32 s83, 7, 0
    s_sub_u32 s83, s8, s83
    s_lshl_b32 s9, s83, 7
    s_mul_i32 s10, s4, 28
    s_add_u32 s9, s9, s10
    s_add_u32 s9, s9, 57344
    v_subrev_u32 v3, 32, v1
    v_min_u32 v3, 6, v3
    v_lshl_add_u32 v3, v3, 2, s9
    v_bfi_b32 v40, v8, v2, v3
    s_lshl_b32 s60, s6, 8
    s_lshl_b32 s9, s4, 2
    s_add_u32 s60, s60, s9
    s_lshl_b32 s60, s60, 4
    s_add_u32 s60, s60, 1048576
    s_lshl_b32 s78, s5, 2
    s_add_u32 s78, s78, s4
    v_and_b32 v2, 31, v1
    s_movk_i32 s9, 896
    v_mul_lo_u32 v42, v2, s9
    v_lshrrev_b32 v3, 5, v1
    v_lshl_add_u32 v42, v3, 3, v42
    s_mul_i32 s68, s78, 28672
    s_lshl_b32 s9, s8, 6
    s_add_u32 s68, s68, s9
    v_min_u32 v43, 223, v0
    v_lshlrev_b32 v43, 4, v43
    s_mov_b32 s72, 342016
    s_mov_b32 s73, 349184
    s_waitcnt vmcnt(0)
    s_mov_b64 exec, 1
    buffer_store_dword v22, v21, s[40:43], s62 offen sc1
    s_mov_b64 exec, -1
    v_lshrrev_b32 v3, 5, v1
    v_bfe_u32 v4, v1, 2, 2
    v_bfe_u32 v5, v1, 4, 1
    s_cmp_lt_u32 s2, 196
    s_cbranch_scc1 L_PG
    v_and_b32 v6, 3, v1
    v_lshl_add_u32 v4, v3, 3, v4
    v_lshlrev_b32 v7, 7, v4
    v_lshl_add_u32 v7, v5, 5, v7
    v_lshl_add_u32 v7, v6, 3, v7
    v_add_u32 v7, s75, v7
    ds_read_b64_tr_b16 v[128:129], v7 offset:0
    ds_read_b64_tr_b16 v[130:131], v7 offset:512
    ds_read_b64_tr_b16 v[132:133], v7 offset:2048
    ds_read_b64_tr_b16 v[134:135], v7 offset:2560
    ds_read_b64_tr_b16 v[136:137], v7 offset:4096
    ds_read_b64_tr_b16 v[138:139], v7 offset:4608
    ds_read_b64_tr_b16 v[140:141], v7 offset:6144
    ds_read_b64_tr_b16 v[142:143], v7 offset:6656
    ds_read_b64_tr_b16 v[144:145], v7 offset:64
    ds_read_b64_tr_b16 v[146:147], v7 offset:576
    ds_read_b64_tr_b16 v[148:149], v7 offset:2112
    ds_read_b64_tr_b16 v[150:151], v7 offset:2624
    ds_read_b64_tr_b16 v[152:153], v7 offset:4160
    ds_read_b64_tr_b16 v[154:155], v7 offset:4672
    ds_read_b64_tr_b16 v[156:157], v7 offset:6208
    ds_read_b64_tr_b16 v[158:159], v7 offset:6720
    s_mul_i32 s75, s80, 224
    s_lshl_b32 s9, s81, 2
    s_add_u32 s75, s75, s9
    s_lshl_b32 s75, s75, 10
    s_add_u32 s75, s75, 14680064
    s_branch L_PE
L_PG:
    v_lshl_add_u32 v4, v3, 2, v4
    v_lshlrev_b32 v7, 7, v4
    v_lshl_add_u32 v7, v5, 3, v7
    v_and_b32 v5, 1, v1
    v_lshl_add_u32 v7, v5, 4, v7
    v_bfe_u32 v6, v1, 1, 1
    v_lshlrev_b32 v6, 11, v6
    v_add3_u32 v7, v7, v6, s75
    ds_read_b64_tr_b16 v[128:129], v7 offset:0
    ds_read_b64_tr_b16 v[130:131], v7 offset:1024
    ds_read_b64_tr_b16 v[132:133], v7 offset:32
    ds_read_b64_tr_b16 v[134:135], v7 offset:1056
    ds_read_b64_tr_b16 v[136:137], v7 offset:64
    ds_read_b64_tr_b16 v[138:139], v7 offset:1088
    ds_read_b64_tr_b16 v[140:141], v7 offset:96
    ds_read_b64_tr_b16 v[142:143], v7 offset:1120
    s_mul_i32 s75, s80, 112
    s_add_u32 s75, s75, s81
    s_lshl_b32 s75, s75, 10
    s_add_u32 s75, s75, 16777216
L_PE:
    v_lshlrev_b32 v224, 16, v240
    v_and_b32 v225, s56, v240
    v_lshlrev_b32 v226, 16, v241
    v_and_b32 v227, s56, v241
    v_lshlrev_b32 v228, 16, v242
    v_and_b32 v229, s56, v242
    v_lshlrev_b32 v230, 16, v243
    v_and_b32 v231, s56, v243
    v_mul_f32 v224, v224, v252
    v_mul_f32 v225, v225, v252
    v_mul_f32 v226, v226, v252
    v_mul_f32 v227, v227, v252
    v_mul_f32 v228, v228, v252
    v_mul_f32 v229, v229, v252
    v_mul_f32 v230, v230, v252
    v_mul_f32 v231, v231, v252
    v_add_f32_dpp v224, v224, v224 row_shr:2 row_mask:0xf bank_mask:0xf
    v_add_f32_dpp v225, v225, v225 row_shr:2 row_mask:0xf bank_mask:0xf
    v_add_f32_dpp v226, v226, v226 row_shr:2 row_mask:0xf bank_mask:0xf
    v_add_f32_dpp v227, v227, v227 row_shr:2 row_mask:0xf bank_mask:0xf
    v_add_f32_dpp v228, v228, v228 row_shr:2 row_mask:0xf bank_mask:0xf
    v_add_f32_dpp v229, v229, v229 row_shr:2 row_mask:0xf bank_mask:0xf
    v_add_f32_dpp v230, v230, v230 row_shr:2 row_mask:0xf bank_mask:0xf
    v_add_f32_dpp v231, v231, v231 row_shr:2 row_mask:0xf bank_mask:0xf
    v_add_f32_dpp v224, v224, v224 row_shr:4 row_mask:0xf bank_mask:0xf
    v_add_f32_dpp v225, v225, v225 row_shr:4 row_mask:0xf bank_mask:0xf
    v_add_f32_dpp v226, v226, v226 row_shr:4 row_mask:0xf bank_mask:0xf
    v_add_f32_dpp v227, v227, v227 row_shr:4 row_mask:0xf bank_mask:0xf
    v_add_f32_dpp v228, v228, v228 row_shr:4 row_mask:0xf bank_mask:0xf
    v_add_f32_dpp v229, v229, v229 row_shr:4 row_mask:0xf bank_mask:0xf
    v_add_f32_dpp v230, v230, v230 row_shr:4 row_mask:0xf bank_mask:0xf
    v_add_f32_dpp v231, v231, v231 row_shr:4 row_mask:0xf bank_mask:0xf
    v_add_f32_dpp v224, v224, v224 row_shr:8 row_mask:0xf bank_mask:0xf
    v_add_f32_dpp v225, v225, v225 row_shr:8 row_mask:0xf bank_mask:0xf
    v_add_f32_dpp v226, v226, v226 row_shr:8 row_mask:0xf bank_mask:0xf
    v_add_f32_dpp v227, v227, v227 row_shr:8 row_mask:0xf bank_mask:0xf
    v_add_f32_dpp v228, v228, v228 row_shr:8 row_mask:0xf bank_mask:0xf
    v_add_f32_dpp v229, v229, v229 row_shr:8 row_mask:0xf bank_mask:0xf
    v_add_f32_dpp v230, v230, v230 row_shr:8 row_mask:0xf bank_mask:0xf
    v_add_f32_dpp v231, v231, v231 row_shr:8 row_mask:0xf bank_mask:0xf
    v_lshlrev_b32 v232, 16, v244
    v_and_b32 v233, s56, v244
    v_lshlrev_b32 v234, 16, v245
    v_and_b32 v235, s56, v245
    v_lshlrev_b32 v236, 16, v246
    v_and_b32 v237, s56, v246
    v_lshlrev_b32 v238, 16, v247
    v_and_b32 v239, s56, v247
    v_mul_f32 v232, v232, v252
    v_mul_f32 v233, v233, v252
    v_mul_f32 v234, v234, v252
    v_mul_f32 v235, v235, v252
    v_mul_f32 v236, v236, v252
    v_mul_f32 v237, v237, v252
    v_mul_f32 v238, v238, v252
    v_mul_f32 v239, v239, v252
    v_add_f32_dpp v232, v232, v232 row_shr:2 row_mask:0xf bank_mask:0xf
    v_add_f32_dpp v233, v233, v233 row_shr:2 row_mask:0xf bank_mask:0xf
    v_add_f32_dpp v234, v234, v234 row_shr:2 row_mask:0xf bank_mask:0xf
    v_add_f32_dpp v235, v235, v235 row_shr:2 row_mask:0xf bank_mask:0xf
    v_add_f32_dpp v236, v236, v236 row_shr:2 row_mask:0xf bank_mask:0xf
    v_add_f32_dpp v237, v237, v237 row_shr:2 row_mask:0xf bank_mask:0xf
    v_add_f32_dpp v238, v238, v238 row_shr:2 row_mask:0xf bank_mask:0xf
    v_add_f32_dpp v239, v239, v239 row_shr:2 row_mask:0xf bank_mask:0xf
    v_add_f32_dpp v232, v232, v232 row_shr:4 row_mask:0xf bank_mask:0xf
    v_add_f32_dpp v233, v233, v233 row_shr:4 row_mask:0xf bank_mask:0xf
    v_add_f32_dpp v234, v234, v234 row_shr:4 row_mask:0xf bank_mask:0xf
    v_add_f32_dpp v235, v235, v235 row_shr:4 row_mask:0xf bank_mask:0xf
    v_add_f32_dpp v236, v236, v236 row_shr:4 row_mask:0xf bank_mask:0xf
    v_add_f32_dpp v237, v237, v237 row_shr:4 row_mask:0xf bank_mask:0xf
    v_add_f32_dpp v238, v238, v238 row_shr:4 row_mask:0xf bank_mask:0xf
    v_add_f32_dpp v239, v239, v239 row_shr:4 row_mask:0xf bank_mask:0xf
    v_add_f32_dpp v232, v232, v232 row_shr:8 row_mask:0xf bank_mask:0xf
    v_add_f32_dpp v233, v233, v233 row_shr:8 row_mask:0xf bank_mask:0xf
    v_add_f32_dpp v234, v234, v234 row_shr:8 row_mask:0xf bank_mask:0xf
    v_add_f32_dpp v235, v235, v235 row_shr:8 row_mask:0xf bank_mask:0xf
    v_add_f32_dpp v236, v236, v236 row_shr:8 row_mask:0xf bank_mask:0xf
    v_add_f32_dpp v237, v237, v237 row_shr:8 row_mask:0xf bank_mask:0xf
    v_add_f32_dpp v238, v238, v238 row_shr:8 row_mask:0xf bank_mask:0xf
    v_add_f32_dpp v239, v239, v239 row_shr:8 row_mask:0xf bank_mask:0xf
    s_mov_b32 exec_lo, 0xc000c000
    s_mov_b32 exec_hi, 0xc000c000
    ds_write_b32 v253, v224 offset:0
    ds_write_b32 v253, v225 offset:64
    ds_write_b32 v253, v226 offset:128
    ds_write_b32 v253, v227 offset:192
    ds_write_b32 v253, v228 offset:256
    ds_write_b32 v253, v229 offset:320
    ds_write_b32 v253, v230 offset:384
    ds_write_b32 v253, v231 offset:448
    ds_write_b32 v253, v232 offset:1024
    ds_write_b32 v253, v233 offset:1088
    ds_write_b32 v253, v234 offset:1152
    ds_write_b32 v253, v235 offset:1216
    ds_write_b32 v253, v236 offset:1280
    ds_write_b32 v253, v237 offset:1344
    ds_write_b32 v253, v238 offset:1408
    ds_write_b32 v253, v239 offset:1472
    s_mov_b64 exec, -1
    s_and_b32 s9, s4, 1
    s_lshl_b32 s9, s9, 10
    v_add_u32 v254, s9, v254
    s_mul_i32 s9, s4, 14336
    s_add_u32 s74, s74, s9
    s_add_u32 s74, s74, 14336
    s_cmp_lt_u32 s14, 7
    s_cselect_b32 s74, s74, 2147418112
    s_cmp_lt_u32 s4, 2
    s_cselect_b32 s74, s74, 2147418112
    s_waitcnt lgkmcnt(0)
    s_barrier
    ds_read_b128 v[160:163], v254 offset:0
    ds_read_b128 v[164:167], v254 offset:16
    ds_read_b128 v[168:171], v254 offset:32
    ds_read_b128 v[172:175], v254 offset:48
    s_mov_b32 s9, 0x07060501
    s_mov_b32 s10, 0x07060502
    s_mov_b32 s11, 0x07060503
    s_waitcnt lgkmcnt(0)
    v_add_f32 v160, v160, v168
    v_add_f32 v161, v161, v169
    v_add_f32 v162, v162, v170
    v_add_f32 v163, v163, v171
    v_add_f32 v164, v164, v172
    v_add_f32 v165, v165, v173
    v_add_f32 v166, v166, v174
    v_add_f32 v167, v167, v175
    v_add_f32 v160, v160, v164
    v_add_f32 v161, v161, v165
    v_add_f32 v162, v162, v166
    v_add_f32 v163, v163, v167
    v_add_f32 v160, v160, v162
    v_add_f32 v161, v161, v163
    v_add_f32 v160, v160, v161
    s_nop 1
    v_mov_b32_dpp v161, v160 quad_perm:[1,1,1,1] row_mask:0xf bank_mask:0xf
    v_mov_b32_dpp v162, v160 quad_perm:[2,2,2,2] row_mask:0xf bank_mask:0xf
    v_mov_b32_dpp v164, v160 quad_perm:[3,3,3,3] row_mask:0xf bank_mask:0xf
    v_mov_b32 v163, s3
    v_perm_b32 v160, v160, v164, s9
    v_perm_b32 v161, v161, v164, s10
    v_perm_b32 v162, v162, v164, s11
L_ATT_START:
    s_xor_b32 s9, s58, 0
    s_lshl_b32 s9, s9, 14
    v_add_u32 v13, s9, v15
    s_xor_b32 s9, s58, 1
    s_lshl_b32 s9, s9, 14
    v_add_u32 v17, s9, v15
    s_xor_b32 s9, s58, 2
    s_lshl_b32 s9, s9, 14
    v_add_u32 v18, s9, v15
    s_xor_b32 s9, s58, 3
    s_lshl_b32 s9, s9, 14
    v_add_u32 v19, s9, v15
    s_add_u32 s9, s4, 1
    s_and_b32 s9, s9, 3
    s_mul_i32 s9, s9, 28672
    v_add_u32 v3, s9, v15
    ds_read_b128 a[0:3], v3 offset:24576
    ds_read_b128 a[4:7], v3 offset:25600
    s_add_u32 s9, s4, 2
    s_and_b32 s9, s9, 3
    s_mul_i32 s9, s9, 28672
    v_add_u32 v3, s9, v15
    ds_read_b128 a[8:11], v3 offset:24576
    ds_read_b128 a[12:15], v3 offset:25600
    s_add_u32 s9, s4, 3
    s_and_b32 s9, s9, 3
    s_mul_i32 s9, s9, 28672
    v_add_u32 v3, s9, v15
    ds_read_b128 a[16:19], v3 offset:24576
    ds_read_b128 a[20:23], v3 offset:25600
    s_add_u32 s9, s4, 4
    s_and_b32 s9, s9, 3
    s_mul_i32 s9, s9, 28672
    v_add_u32 v3, s9, v15
    ds_read_b128 a[24:27], v3 offset:24576
    ds_read_b128 a[28:31], v3 offset:25600
    s_lshl_b32 s9, s91, 12
    v_add_u32 v24, s9, v15
    v_add_u32 v25, 4096, v24
    v_subrev_u32 v31, 28672, v25
    v_min_u32 v25, v25, v31
    v_add_u32 v26, 4096, v25
    v_subrev_u32 v31, 28672, v26
    v_min_u32 v26, v26, v31
    v_add_u32 v27, 4096, v26
    v_subrev_u32 v31, 28672, v27
    v_min_u32 v27, v27, v31
    v_add_u32 v28, 4096, v27
    v_subrev_u32 v31, 28672, v28
    v_min_u32 v28, v28, v31
    v_add_u32 v29, 4096, v28
    v_subrev_u32 v31, 28672, v29
    v_min_u32 v29, v29, v31
    v_add_u32 v30, 4096, v29
    v_subrev_u32 v31, 28672, v30
    v_min_u32 v30, v30, v31
    s_mov_b64 exec, 0xffff
    s_mov_b32 s9, 0
LP_1:
    buffer_load_dword v2, v14, s[40:43], s60 offen sc1
    s_add_u32 s9, s9, 1
    s_cmp_gt_u32 s9, 0x4000
    s_cbranch_scc1 L_ABORT
    s_waitcnt vmcnt(0)
    v_cmp_ne_u32 vcc, s3, v2
    s_cbranch_vccz LD_2
    s_sleep 4
    s_branch LP_1
LD_2:
    s_mov_b64 exec, -1
    buffer_load_dwordx4 a[112:115], v17, s[40:43], s84 offen offset:0 sc1
    buffer_load_dwordx4 a[116:119], v17, s[40:43], s84 offen offset:1024 sc1
    buffer_load_dwordx4 a[120:123], v17, s[40:43], s84 offen offset:2048 sc1
    buffer_load_dwordx4 a[124:127], v17, s[40:43], s84 offen offset:3072 sc1
    s_waitcnt lgkmcnt(0)
    v_mfma_f32_32x32x16_bf16 v[64:79], a[96:99], a[0:3], 0
    v_mfma_f32_32x32x16_bf16 v[64:79], a[100:103], a[4:7], v[64:79]
    v_mfma_f32_32x32x16_bf16 v[80:95], a[96:99], a[8:11], 0
    buffer_load_dwordx4 a[128:131], v18, s[40:43], s84 offen offset:0 sc1
    s_nop 9
    v_exp_f32 v64, v64
    v_exp_f32 v65, v65
    v_exp_f32 v66, v66
    v_exp_f32 v67, v67
    v_mfma_f32_32x32x16_bf16 v[80:95], a[100:103], a[12:15], v[80:95]
    buffer_load_dwordx4 a[132:135], v18, s[40:43], s84 offen offset:1024 sc1
    v_exp_f32 v68, v68
    v_exp_f32 v69, v69
    v_cvt_pk_bf16_f32 v96, v64, v65
    v_exp_f32 v70, v70
    v_exp_f32 v71, v71
    v_cvt_pk_bf16_f32 v97, v66, v67
    buffer_load_dwordx4 a[136:139], v18, s[40:43], s84 offen offset:2048 sc1
    v_exp_f32 v72, v72
    v_exp_f32 v73, v73
    v_cvt_pk_bf16_f32 v98, v68, v69
    v_exp_f32 v74, v74
    v_exp_f32 v75, v75
    v_cvt_pk_bf16_f32 v99, v70, v71
    v_exp_f32 v76, v76
    buffer_load_dwordx4 a[140:143], v18, s[40:43], s84 offen offset:3072 sc1
    v_exp_f32 v77, v77
    v_cvt_pk_bf16_f32 v100, v72, v73
    v_exp_f32 v78, v78
    v_exp_f32 v79, v79
    v_cvt_pk_bf16_f32 v101, v74, v75
    v_cvt_pk_bf16_f32 v102, v76, v77
    v_cvt_pk_bf16_f32 v103, v78, v79
    v_mfma_f32_32x32x16_bf16 v[64:79], a[96:99], a[16:19], 0
    buffer_load_dwordx4 a[144:147], v19, s[40:43], s84 offen offset:0 sc1
    v_exp_f32 v80, v80
    v_exp_f32 v81, v81
    v_exp_f32 v82, v82
    v_exp_f32 v83, v83
    v_mfma_f32_32x32x16_bf16 v[64:79], a[100:103], a[20:23], v[64:79]
    buffer_load_dwordx4 a[148:151], v19, s[40:43], s84 offen offset:1024 sc1
    v_exp_f32 v84, v84
    v_exp_f32 v85, v85
    v_cvt_pk_bf16_f32 v104, v80, v81
    v_exp_f32 v86, v86
    v_exp_f32 v87, v87
    v_cvt_pk_bf16_f32 v105, v82, v83
    v_mfma_f32_32x32x16_bf16 a[32:47], a[104:107], v[96:99], 0
    buffer_load_dwordx4 a[152:155], v19, s[40:43], s84 offen offset:2048 sc1
    v_exp_f32 v88, v88
    v_exp_f32 v89, v89
    v_cvt_pk_bf16_f32 v106, v84, v85
    v_exp_f32 v90, v90
    v_exp_f32 v91, v91
    v_cvt_pk_bf16_f32 v107, v86, v87
    v_exp_f32 v92, v92
    v_mfma_f32_32x32x16_bf16 a[32:47], a[108:111], v[100:103], a[32:47]
    buffer_load_dwordx4 a[156:159], v19, s[40:43], s84 offen offset:3072 sc1
    v_exp_f32 v93, v93
    v_cvt_pk_bf16_f32 v108, v88, v89
    v_exp_f32 v94, v94
    v_exp_f32 v95, v95
    v_cvt_pk_bf16_f32 v109, v90, v91
    v_cvt_pk_bf16_f32 v110, v92, v93
    v_cvt_pk_bf16_f32 v111, v94, v95
    v_mfma_f32_32x32x16_bf16 v[80:95], a[96:99], a[24:27], 0
    v_exp_f32 v64, v64
    v_exp_f32 v65, v65
    v_exp_f32 v66, v66
    v_exp_f32 v67, v67
    v_mfma_f32_32x32x16_bf16 v[80:95], a[100:103], a[28:31], v[80:95]
    v_exp_f32 v68, v68
    v_exp_f32 v69, v69
    v_cvt_pk_bf16_f32 v96, v64, v65
    v_exp_f32 v70, v70
    v_exp_f32 v71, v71
    v_cvt_pk_bf16_f32 v97, v66, v67
    v_mfma_f32_32x32x16_bf16 a[48:63], a[104:107], v[104:107], 0
    v_exp_f32 v72, v72
    v_exp_f32 v73, v73
    v_cvt_pk_bf16_f32 v98, v68, v69
    v_exp_f32 v74, v74
    v_exp_f32 v75, v75
    v_cvt_pk_bf16_f32 v99, v70, v71
    v_exp_f32 v76, v76
    v_mfma_f32_32x32x16_bf16 a[48:63], a[108:111], v[108:111], a[48:63]
    s_waitcnt vmcnt(10)
    v_exp_f32 v77, v77
    v_cvt_pk_bf16_f32 v100, v72, v73
    v_exp_f32 v78, v78
    v_exp_f32 v79, v79
    v_cvt_pk_bf16_f32 v101, v74, v75
    v_cvt_pk_bf16_f32 v102, v76, v77
    v_cvt_pk_bf16_f32 v103, v78, v79
    v_mfma_f32_32x32x16_bf16 v[64:79], a[112:115], a[0:3], 0
    v_exp_f32 v80, v80
    v_exp_f32 v81, v81
    v_exp_f32 v82, v82
    v_exp_f32 v83, v83
    v_mfma_f32_32x32x16_bf16 v[64:79], a[116:119], a[4:7], v[64:79]
    v_exp_f32 v84, v84
    v_exp_f32 v85, v85
    v_cvt_pk_bf16_f32 v104, v80, v81
    v_exp_f32 v86, v86
    v_exp_f32 v87, v87
    v_cvt_pk_bf16_f32 v105, v82, v83
    v_mfma_f32_32x32x16_bf16 a[64:79], a[104:107], v[96:99], 0
    v_exp_f32 v88, v88
    v_exp_f32 v89, v89
    v_cvt_pk_bf16_f32 v106, v84, v85
    v_exp_f32 v90, v90
    v_exp_f32 v91, v91
    v_cvt_pk_bf16_f32 v107, v86, v87
    v_exp_f32 v92, v92
    v_mfma_f32_32x32x16_bf16 a[64:79], a[108:111], v[100:103], a[64:79]
    v_exp_f32 v93, v93
    v_cvt_pk_bf16_f32 v108, v88, v89
    v_exp_f32 v94, v94
    v_exp_f32 v95, v95
    v_cvt_pk_bf16_f32 v109, v90, v91
    v_cvt_pk_bf16_f32 v110, v92, v93
    v_cvt_pk_bf16_f32 v111, v94, v95
    v_mfma_f32_32x32x16_bf16 v[80:95], a[112:115], a[8:11], 0
    s_cmp_lg_u32 s7, 0
    s_cbranch_scc1 L_NOPACK
    s_mov_b64 exec, 0x1111
    buffer_store_dwordx4 v[160:163], v16, s[40:43], s74 offen sc1
    s_mov_b64 exec, -1
    s_cmp_ge_u32 s2, 245
    s_cbranch_scc1 L_PS2
    s_cmp_lt_u32 s2, 196
    s_cbranch_scc1 L_PSG
    buffer_store_dwordx4 v[128:131], v15, s[40:43], s75 offen offset:0 sc1
    buffer_store_dwordx4 v[132:135], v15, s[40:43], s75 offen offset:1024 sc1
    buffer_store_dwordx4 v[136:139], v15, s[40:43], s75 offen offset:2048 sc1
    buffer_store_dwordx4 v[140:143], v15, s[40:43], s75 offen offset:3072 sc1
    s_add_u32 s75, s75, 114688
    buffer_store_dwordx4 v[144:147], v15, s[40:43], s75 offen offset:0 sc1
    buffer_store_dwordx4 v[148:151], v15, s[40:43], s75 offen offset:1024 sc1
    buffer_store_dwordx4 v[152:155], v15, s[40:43], s75 offen offset:2048 sc1
    buffer_store_dwordx4 v[156:159], v15, s[40:43], s75 offen offset:3072 sc1
    s_branch L_PS2
L_PSG:
    buffer_store_dwordx4 v[128:131], v15, s[40:43], s75 offen sc1
    s_add_u32 s75, s75, 28672
    buffer_store_dwordx4 v[132:135], v15, s[40:43], s75 offen sc1
    s_add_u32 s75, s75, 28672
    buffer_store_dwordx4 v[136:139], v15, s[40:43], s75 offen sc1
    s_add_u32 s75, s75, 28672
    buffer_store_dwordx4 v[140:143], v15, s[40:43], s75 offen sc1
L_PS2:
L_NOPACK:
    v_exp_f32 v64, v64
    v_exp_f32 v65, v65
    v_exp_f32 v66, v66
    v_exp_f32 v67, v67
    v_mfma_f32_32x32x16_bf16 v[80:95], a[116:119], a[12:15], v[80:95]
    v_exp_f32 v68, v68
    v_exp_f32 v69, v69
    v_cvt_pk_bf16_f32 v96, v64, v65
    v_exp_f32 v70, v70
    v_exp_f32 v71, v71
    v_cvt_pk_bf16_f32 v97, v66, v67
    v_mfma_f32_32x32x16_bf16 a[80:95], a[104:107], v[104:107], 0
    v_exp_f32 v72, v72
    v_exp_f32 v73, v73
    v_cvt_pk_bf16_f32 v98, v68, v69
    v_exp_f32 v74, v74
    v_exp_f32 v75, v75
    v_cvt_pk_bf16_f32 v99, v70, v71
    v_exp_f32 v76, v76
    v_mfma_f32_32x32x16_bf16 a[80:95], a[108:111], v[108:111], a[80:95]
    v_exp_f32 v77, v77
    v_cvt_pk_bf16_f32 v100, v72, v73
    v_exp_f32 v78, v78
    v_exp_f32 v79, v79
    v_cvt_pk_bf16_f32 v101, v74, v75
    v_cvt_pk_bf16_f32 v102, v76, v77
    v_cvt_pk_bf16_f32 v103, v78, v79
    v_mfma_f32_32x32x16_bf16 v[64:79], a[112:115], a[16:19], 0
    s_waitcnt vmcnt(8)
    buffer_load_dwordx4 a[96:99], v13, s[40:43], s85 offen offset:0 sc1
    v_exp_f32 v80, v80
    v_exp_f32 v81, v81
    v_exp_f32 v82, v82
    v_exp_f32 v83, v83
    v_mfma_f32_32x32x16_bf16 v[64:79], a[116:119], a[20:23], v[64:79]
    buffer_load_dwordx4 a[100:103], v13, s[40:43], s85 offen offset:1024 sc1
    v_exp_f32 v84, v84
    v_exp_f32 v85, v85
    v_cvt_pk_bf16_f32 v104, v80, v81
    v_exp_f32 v86, v86
    v_exp_f32 v87, v87
    v_cvt_pk_bf16_f32 v105, v82, v83
    v_mfma_f32_32x32x16_bf16 a[32:47], a[120:123], v[96:99], a[32:47]
    buffer_load_dwordx4 a[104:107], v13, s[40:43], s85 offen offset:2048 sc1
    v_exp_f32 v88, v88
    v_exp_f32 v89, v89
    v_cvt_pk_bf16_f32 v106, v84, v85
    v_exp_f32 v90, v90
    v_exp_f32 v91, v91
    v_cvt_pk_bf16_f32 v107, v86, v87
    v_exp_f32 v92, v92
    v_mfma_f32_32x32x16_bf16 a[32:47], a[124:127], v[100:103], a[32:47]
    buffer_load_dwordx4 a[108:111], v13, s[40:43], s85 offen offset:3072 sc1
    v_exp_f32 v93, v93
    v_cvt_pk_bf16_f32 v108, v88, v89
    v_exp_f32 v94, v94
    v_exp_f32 v95, v95
    v_cvt_pk_bf16_f32 v109, v90, v91
    v_cvt_pk_bf16_f32 v110, v92, v93
    v_cvt_pk_bf16_f32 v111, v94, v95
    v_mfma_f32_32x32x16_bf16 v[80:95], a[112:115], a[24:27], 0
    v_exp_f32 v64, v64
    v_exp_f32 v65, v65
    v_exp_f32 v66, v66
    v_exp_f32 v67, v67
    v_mfma_f32_32x32x16_bf16 v[80:95], a[116:119], a[28:31], v[80:95]
    v_exp_f32 v68, v68
    v_exp_f32 v69, v69
    v_cvt_pk_bf16_f32 v96, v64, v65
    v_exp_f32 v70, v70
    v_exp_f32 v71, v71
    v_cvt_pk_bf16_f32 v97, v66, v67
    v_mfma_f32_32x32x16_bf16 a[48:63], a[120:123], v[104:107], a[48:63]
    v_exp_f32 v72, v72
    v_exp_f32 v73, v73
    v_cvt_pk_bf16_f32 v98, v68, v69
    v_exp_f32 v74, v74
    v_exp_f32 v75, v75
    v_cvt_pk_bf16_f32 v99, v70, v71
    v_exp_f32 v76, v76
    v_mfma_f32_32x32x16_bf16 a[48:63], a[124:127], v[108:111], a[48:63]
    s_waitcnt vmcnt(8)
    v_exp_f32 v77, v77
    v_cvt_pk_bf16_f32 v100, v72, v73
    v_exp_f32 v78, v78
    v_exp_f32 v79, v79
    v_cvt_pk_bf16_f32 v101, v74, v75
    v_cvt_pk_bf16_f32 v102, v76, v77
    v_cvt_pk_bf16_f32 v103, v78, v79
    v_mfma_f32_32x32x16_bf16 v[64:79], a[128:131], a[0:3], 0
    v_exp_f32 v80, v80
    v_exp_f32 v81, v81
    v_exp_f32 v82, v82
    v_exp_f32 v83, v83
    v_mfma_f32_32x32x16_bf16 v[64:79], a[132:135], a[4:7], v[64:79]
    v_exp_f32 v84, v84
    v_exp_f32 v85, v85
    v_cvt_pk_bf16_f32 v104, v80, v81
    v_exp_f32 v86, v86
    v_exp_f32 v87, v87
    v_cvt_pk_bf16_f32 v105, v82, v83
    v_mfma_f32_32x32x16_bf16 a[64:79], a[120:123], v[96:99], a[64:79]
    v_exp_f32 v88, v88
    v_exp_f32 v89, v89
    v_cvt_pk_bf16_f32 v106, v84, v85
    v_exp_f32 v90, v90
    v_exp_f32 v91, v91
    v_cvt_pk_bf16_f32 v107, v86, v87
    v_exp_f32 v92, v92
    v_mfma_f32_32x32x16_bf16 a[64:79], a[124:127], v[100:103], a[64:79]
    v_exp_f32 v93, v93
    v_cvt_pk_bf16_f32 v108, v88, v89
    v_exp_f32 v94, v94
    v_exp_f32 v95, v95
    v_cvt_pk_bf16_f32 v109, v90, v91
    v_cvt_pk_bf16_f32 v110, v92, v93
    v_cvt_pk_bf16_f32 v111, v94, v95
    v_mfma_f32_32x32x16_bf16 v[80:95], a[128:131], a[8:11], 0
    s_add_u32 m0, s63, 0
    s_add_u32 s64, s69, 0
    buffer_load_dwordx4 v41, s[52:55], s64 offen lds
    v_exp_f32 v64, v64
    v_exp_f32 v65, v65
    v_exp_f32 v66, v66
    v_exp_f32 v67, v67
    v_mfma_f32_32x32x16_bf16 v[80:95], a[132:135], a[12:15], v[80:95]
    v_exp_f32 v68, v68
    v_exp_f32 v69, v69
    v_cvt_pk_bf16_f32 v96, v64, v65
    v_exp_f32 v70, v70
    v_exp_f32 v71, v71
    v_cvt_pk_bf16_f32 v97, v66, v67
    v_mfma_f32_32x32x16_bf16 a[80:95], a[120:123], v[104:107], a[80:95]
    v_exp_f32 v72, v72
    v_exp_f32 v73, v73
    v_cvt_pk_bf16_f32 v98, v68, v69
    v_exp_f32 v74, v74
    v_exp_f32 v75, v75
    v_cvt_pk_bf16_f32 v99, v70, v71
    v_exp_f32 v76, v76
    v_mfma_f32_32x32x16_bf16 a[80:95], a[124:127], v[108:111], a[80:95]
    v_exp_f32 v77, v77
    v_cvt_pk_bf16_f32 v100, v72, v73
    v_exp_f32 v78, v78
    v_exp_f32 v79, v79
    v_cvt_pk_bf16_f32 v101, v74, v75
    v_cvt_pk_bf16_f32 v102, v76, v77
    v_cvt_pk_bf16_f32 v103, v78, v79
    v_mfma_f32_32x32x16_bf16 v[64:79], a[128:131], a[16:19], 0
    buffer_load_dwordx4 a[112:115], v17, s[40:43], s85 offen offset:0 sc1
    v_exp_f32 v80, v80
    v_exp_f32 v81, v81
    v_exp_f32 v82, v82
    v_exp_f32 v83, v83
    v_mfma_f32_32x32x16_bf16 v[64:79], a[132:135], a[20:23], v[64:79]
    buffer_load_dwordx4 a[116:119], v17, s[40:43], s85 offen offset:1024 sc1
    v_exp_f32 v84, v84
    v_exp_f32 v85, v85
    v_cvt_pk_bf16_f32 v104, v80, v81
    v_exp_f32 v86, v86
    v_exp_f32 v87, v87
    v_cvt_pk_bf16_f32 v105, v82, v83
    v_mfma_f32_32x32x16_bf16 a[32:47], a[136:139], v[96:99], a[32:47]
    buffer_load_dwordx4 a[120:123], v17, s[40:43], s85 offen offset:2048 sc1
    v_exp_f32 v88, v88
    v_exp_f32 v89, v89
    v_cvt_pk_bf16_f32 v106, v84, v85
    v_exp_f32 v90, v90
    v_exp_f32 v91, v91
    v_cvt_pk_bf16_f32 v107, v86, v87
    v_exp_f32 v92, v92
    v_mfma_f32_32x32x16_bf16 a[32:47], a[140:143], v[100:103], a[32:47]
    buffer_load_dwordx4 a[124:127], v17, s[40:43], s85 offen offset:3072 sc1
    v_exp_f32 v93, v93
    v_cvt_pk_bf16_f32 v108, v88, v89
    v_exp_f32 v94, v94
    v_exp_f32 v95, v95
    v_cvt_pk_bf16_f32 v109, v90, v91
    v_cvt_pk_bf16_f32 v110, v92, v93
    v_cvt_pk_bf16_f32 v111, v94, v95
    v_mfma_f32_32x32x16_bf16 v[80:95], a[128:131], a[24:27], 0
    s_waitcnt vmcnt(8)
    s_mov_b64 exec, 1
    buffer_store_dword v22, v21, s[40:43], s79 offen sc1
    s_mov_b64 exec, -1
    v_exp_f32 v64, v64
    v_exp_f32 v65, v65
    v_exp_f32 v66, v66
    v_exp_f32 v67, v67
    v_mfma_f32_32x32x16_bf16 v[80:95], a[132:135], a[28:31], v[80:95]
    v_exp_f32 v68, v68
    v_exp_f32 v69, v69
    v_cvt_pk_bf16_f32 v96, v64, v65
    v_exp_f32 v70, v70
    v_exp_f32 v71, v71
    v_cvt_pk_bf16_f32 v97, v66, v67
    v_mfma_f32_32x32x16_bf16 a[48:63], a[136:139], v[104:107], a[48:63]
    s_add_u32 m0, s63, 1024
    s_add_u32 s64, s69, 14336
    buffer_load_dwordx4 v41, s[52:55], s64 offen lds
    v_exp_f32 v72, v72
    v_exp_f32 v73, v73
    v_cvt_pk_bf16_f32 v98, v68, v69
    v_exp_f32 v74, v74
    v_exp_f32 v75, v75
    v_cvt_pk_bf16_f32 v99, v70, v71
    v_exp_f32 v76, v76
    v_mfma_f32_32x32x16_bf16 a[48:63], a[140:143], v[108:111], a[48:63]
    v_exp_f32 v77, v77
    v_cvt_pk_bf16_f32 v100, v72, v73
    v_exp_f32 v78, v78
    v_exp_f32 v79, v79
    v_cvt_pk_bf16_f32 v101, v74, v75
    v_cvt_pk_bf16_f32 v102, v76, v77
    v_cvt_pk_bf16_f32 v103, v78, v79
    v_mfma_f32_32x32x16_bf16 v[64:79], a[144:147], a[0:3], 0
    v_exp_f32 v80, v80
    v_exp_f32 v81, v81
    v_exp_f32 v82, v82
    v_exp_f32 v83, v83
    v_mfma_f32_32x32x16_bf16 v[64:79], a[148:151], a[4:7], v[64:79]
    v_exp_f32 v84, v84
    v_exp_f32 v85, v85
    v_cvt_pk_bf16_f32 v104, v80, v81
    v_exp_f32 v86, v86
    v_exp_f32 v87, v87
    v_cvt_pk_bf16_f32 v105, v82, v83
    v_mfma_f32_32x32x16_bf16 a[64:79], a[136:139], v[96:99], a[64:79]
    v_exp_f32 v88, v88
    v_exp_f32 v89, v89
    v_cvt_pk_bf16_f32 v106, v84, v85
    v_exp_f32 v90, v90
    v_exp_f32 v91, v91
    v_cvt_pk_bf16_f32 v107, v86, v87
    v_exp_f32 v92, v92
    v_mfma_f32_32x32x16_bf16 a[64:79], a[140:143], v[100:103], a[64:79]
    v_exp_f32 v93, v93
    v_cvt_pk_bf16_f32 v108, v88, v89
    v_exp_f32 v94, v94
    v_exp_f32 v95, v95
    v_cvt_pk_bf16_f32 v109, v90, v91
    v_cvt_pk_bf16_f32 v110, v92, v93
    v_cvt_pk_bf16_f32 v111, v94, v95
    v_mfma_f32_32x32x16_bf16 v[80:95], a[144:147], a[8:11], 0
    v_exp_f32 v64, v64
    v_exp_f32 v65, v65
    v_exp_f32 v66, v66
    v_exp_f32 v67, v67
    v_mfma_f32_32x32x16_bf16 v[80:95], a[148:151], a[12:15], v[80:95]
    s_add_u32 m0, s63, 2048
    s_add_u32 s64, s69, 28672
    buffer_load_dwordx4 v41, s[52:55], s64 offen lds
    v_exp_f32 v68, v68
    v_exp_f32 v69, v69
    v_cvt_pk_bf16_f32 v96, v64, v65
    v_exp_f32 v70, v70
    v_exp_f32 v71, v71
    v_cvt_pk_bf16_f32 v97, v66, v67
    v_mfma_f32_32x32x16_bf16 a[80:95], a[136:139], v[104:107], a[80:95]
    v_exp_f32 v72, v72
    v_exp_f32 v73, v73
    v_cvt_pk_bf16_f32 v98, v68, v69
    v_exp_f32 v74, v74
    v_exp_f32 v75, v75
    v_cvt_pk_bf16_f32 v99, v70, v71
    v_exp_f32 v76, v76
    v_mfma_f32_32x32x16_bf16 a[80:95], a[140:143], v[108:111], a[80:95]
    v_exp_f32 v77, v77
    v_cvt_pk_bf16_f32 v100, v72, v73
    v_exp_f32 v78, v78
    v_exp_f32 v79, v79
    v_cvt_pk_bf16_f32 v101, v74, v75
    v_cvt_pk_bf16_f32 v102, v76, v77
    v_cvt_pk_bf16_f32 v103, v78, v79
    v_mfma_f32_32x32x16_bf16 v[64:79], a[144:147], a[16:19], 0
    buffer_load_dwordx4 a[128:131], v18, s[40:43], s85 offen offset:0 sc1
    v_exp_f32 v80, v80
    v_exp_f32 v81, v81
    v_exp_f32 v82, v82
    v_exp_f32 v83, v83
    v_mfma_f32_32x32x16_bf16 v[64:79], a[148:151], a[20:23], v[64:79]
    buffer_load_dwordx4 a[132:135], v18, s[40:43], s85 offen offset:1024 sc1
    v_exp_f32 v84, v84
    v_exp_f32 v85, v85
    v_cvt_pk_bf16_f32 v104, v80, v81
    v_exp_f32 v86, v86
    v_exp_f32 v87, v87
    v_cvt_pk_bf16_f32 v105, v82, v83
    v_mfma_f32_32x32x16_bf16 a[32:47], a[152:155], v[96:99], a[32:47]
    buffer_load_dwordx4 a[136:139], v18, s[40:43], s85 offen offset:2048 sc1
    v_exp_f32 v88, v88
    v_exp_f32 v89, v89
    v_cvt_pk_bf16_f32 v106, v84, v85
    v_exp_f32 v90, v90
    v_exp_f32 v91, v91
    v_cvt_pk_bf16_f32 v107, v86, v87
    v_exp_f32 v92, v92
    v_mfma_f32_32x32x16_bf16 a[32:47], a[156:159], v[100:103], a[32:47]
    buffer_load_dwordx4 a[140:143], v18, s[40:43], s85 offen offset:3072 sc1
    v_exp_f32 v93, v93
    v_cvt_pk_bf16_f32 v108, v88, v89
    v_exp_f32 v94, v94
    v_exp_f32 v95, v95
    v_cvt_pk_bf16_f32 v109, v90, v91
    v_cvt_pk_bf16_f32 v110, v92, v93
    v_cvt_pk_bf16_f32 v111, v94, v95
    v_mfma_f32_32x32x16_bf16 v[80:95], a[144:147], a[24:27], 0
    v_exp_f32 v64, v64
    v_exp_f32 v65, v65
    v_exp_f32 v66, v66
    v_exp_f32 v67, v67
    v_mfma_f32_32x32x16_bf16 v[80:95], a[148:151], a[28:31], v[80:95]
    v_exp_f32 v68, v68
    v_exp_f32 v69, v69
    v_cvt_pk_bf16_f32 v96, v64, v65
    v_exp_f32 v70, v70
    v_exp_f32 v71, v71
    v_cvt_pk_bf16_f32 v97, v66, v67
    v_mfma_f32_32x32x16_bf16 a[48:63], a[152:155], v[104:107], a[48:63]
    v_exp_f32 v72, v72
    v_exp_f32 v73, v73
    v_cvt_pk_bf16_f32 v98, v68, v69
    v_exp_f32 v74, v74
    v_exp_f32 v75, v75
    v_cvt_pk_bf16_f32 v99, v70, v71
    v_exp_f32 v76, v76
    v_mfma_f32_32x32x16_bf16 a[48:63], a[156:159], v[108:111], a[48:63]
    s_waitcnt vmcnt(12)
    v_exp_f32 v77, v77
    v_cvt_pk_bf16_f32 v100, v72, v73
    v_exp_f32 v78, v78
    v_exp_f32 v79, v79
    v_cvt_pk_bf16_f32 v101, v74, v75
    v_cvt_pk_bf16_f32 v102, v76, v77
    v_cvt_pk_bf16_f32 v103, v78, v79
    v_mfma_f32_32x32x16_bf16 v[64:79], a[96:99], a[0:3], 0
    s_add_u32 m0, s63, 3072
    s_add_u32 s64, s69, 43008
    buffer_load_dwordx4 v41, s[52:55], s64 offen lds
    v_exp_f32 v80, v80
    v_exp_f32 v81, v81
    v_exp_f32 v82, v82
    v_exp_f32 v83, v83
    v_mfma_f32_32x32x16_bf16 v[64:79], a[100:103], a[4:7], v[64:79]
    v_exp_f32 v84, v84
    v_exp_f32 v85, v85
    v_cvt_pk_bf16_f32 v104, v80, v81
    v_exp_f32 v86, v86
    v_exp_f32 v87, v87
    v_cvt_pk_bf16_f32 v105, v82, v83
    v_mfma_f32_32x32x16_bf16 a[64:79], a[152:155], v[96:99], a[64:79]
    v_exp_f32 v88, v88
    v_exp_f32 v89, v89
    v_cvt_pk_bf16_f32 v106, v84, v85
    v_exp_f32 v90, v90
    v_exp_f32 v91, v91
    v_cvt_pk_bf16_f32 v107, v86, v87
    v_exp_f32 v92, v92
    v_mfma_f32_32x32x16_bf16 a[64:79], a[156:159], v[100:103], a[64:79]
    v_exp_f32 v93, v93
    v_cvt_pk_bf16_f32 v108, v88, v89
    v_exp_f32 v94, v94
    v_exp_f32 v95, v95
    v_cvt_pk_bf16_f32 v109, v90, v91
    v_cvt_pk_bf16_f32 v110, v92, v93
    v_cvt_pk_bf16_f32 v111, v94, v95
    v_mfma_f32_32x32x16_bf16 v[80:95], a[96:99], a[8:11], 0
    v_exp_f32 v64, v64
    v_exp_f32 v65, v65
    v_exp_f32 v66, v66
    v_exp_f32 v67, v67
    v_mfma_f32_32x32x16_bf16 v[80:95], a[100:103], a[12:15], v[80:95]
    v_exp_f32 v68, v68
    v_exp_f32 v69, v69
    v_cvt_pk_bf16_f32 v96, v64, v65
    v_exp_f32 v70, v70
    v_exp_f32 v71, v71
    v_cvt_pk_bf16_f32 v97, v66, v67
    v_mfma_f32_32x32x16_bf16 a[80:95], a[152:155], v[104:107], a[80:95]
    s_add_u32 m0, s63, 4096
    s_add_u32 s64, s69, 57344
    buffer_load_dwordx4 v41, s[52:55], s64 offen lds
    v_exp_f32 v72, v72
    v_exp_f32 v73, v73
    v_cvt_pk_bf16_f32 v98, v68, v69
    v_exp_f32 v74, v74
    v_exp_f32 v75, v75
    v_cvt_pk_bf16_f32 v99, v70, v71
    v_exp_f32 v76, v76
    v_mfma_f32_32x32x16_bf16 a[80:95], a[156:159], v[108:111], a[80:95]
    v_exp_f32 v77, v77
    v_cvt_pk_bf16_f32 v100, v72, v73
    v_exp_f32 v78, v78
    v_exp_f32 v79, v79
    v_cvt_pk_bf16_f32 v101, v74, v75
    v_cvt_pk_bf16_f32 v102, v76, v77
    v_cvt_pk_bf16_f32 v103, v78, v79
    v_mfma_f32_32x32x16_bf16 v[64:79], a[96:99], a[16:19], 0
    buffer_load_dwordx4 a[144:147], v19, s[40:43], s85 offen offset:0 sc1
    v_exp_f32 v80, v80
    v_exp_f32 v81, v81
    v_exp_f32 v82, v82
    v_exp_f32 v83, v83
    v_mfma_f32_32x32x16_bf16 v[64:79], a[100:103], a[20:23], v[64:79]
    buffer_load_dwordx4 a[148:151], v19, s[40:43], s85 offen offset:1024 sc1
    v_exp_f32 v84, v84
    v_exp_f32 v85, v85
    v_cvt_pk_bf16_f32 v104, v80, v81
    v_exp_f32 v86, v86
    v_exp_f32 v87, v87
    v_cvt_pk_bf16_f32 v105, v82, v83
    v_mfma_f32_32x32x16_bf16 a[32:47], a[104:107], v[96:99], a[32:47]
    buffer_load_dwordx4 a[152:155], v19, s[40:43], s85 offen offset:2048 sc1
    v_exp_f32 v88, v88
    v_exp_f32 v89, v89
    v_cvt_pk_bf16_f32 v106, v84, v85
    v_exp_f32 v90, v90
    v_exp_f32 v91, v91
    v_cvt_pk_bf16_f32 v107, v86, v87
    v_exp_f32 v92, v92
    v_mfma_f32_32x32x16_bf16 a[32:47], a[108:111], v[100:103], a[32:47]
    buffer_load_dwordx4 a[156:159], v19, s[40:43], s85 offen offset:3072 sc1
    v_exp_f32 v93, v93
    v_cvt_pk_bf16_f32 v108, v88, v89
    v_exp_f32 v94, v94
    v_exp_f32 v95, v95
    v_cvt_pk_bf16_f32 v109, v90, v91
    v_cvt_pk_bf16_f32 v110, v92, v93
    v_cvt_pk_bf16_f32 v111, v94, v95
    v_mfma_f32_32x32x16_bf16 v[80:95], a[96:99], a[24:27], 0
    v_exp_f32 v64, v64
    v_exp_f32 v65, v65
    v_exp_f32 v66, v66
    v_exp_f32 v67, v67
    v_mfma_f32_32x32x16_bf16 v[80:95], a[100:103], a[28:31], v[80:95]
    v_exp_f32 v68, v68
    v_exp_f32 v69, v69
    v_cvt_pk_bf16_f32 v96, v64, v65
    v_exp_f32 v70, v70
    v_exp_f32 v71, v71
    v_cvt_pk_bf16_f32 v97, v66, v67
    v_mfma_f32_32x32x16_bf16 a[48:63], a[104:107], v[104:107], a[48:63]
    v_exp_f32 v72, v72
    v_exp_f32 v73, v73
    v_cvt_pk_bf16_f32 v98, v68, v69
    v_exp_f32 v74, v74
    v_exp_f32 v75, v75
    v_cvt_pk_bf16_f32 v99, v70, v71
    v_exp_f32 v76, v76
    v_mfma_f32_32x32x16_bf16 a[48:63], a[108:111], v[108:111], a[48:63]
    s_waitcnt vmcnt(13)
    v_exp_f32 v77, v77
    v_cvt_pk_bf16_f32 v100, v72, v73
    v_exp_f32 v78, v78
    v_exp_f32 v79, v79
    v_cvt_pk_bf16_f32 v101, v74, v75
    v_cvt_pk_bf16_f32 v102, v76, v77
    v_cvt_pk_bf16_f32 v103, v78, v79
    v_mfma_f32_32x32x16_bf16 v[64:79], a[112:115], a[0:3], 0
    v_exp_f32 v80, v80
    v_exp_f32 v81, v81
    v_exp_f32 v82, v82
    v_exp_f32 v83, v83
    v_mfma_f32_32x32x16_bf16 v[64:79], a[116:119], a[4:7], v[64:79]
    s_add_u32 m0, s63, 5120
    s_add_u32 s64, s69, 71680
    buffer_load_dwordx4 v41, s[52:55], s64 offen lds
    v_exp_f32 v84, v84
    v_exp_f32 v85, v85
    v_cvt_pk_bf16_f32 v104, v80, v81
    v_exp_f32 v86, v86
    v_exp_f32 v87, v87
    v_cvt_pk_bf16_f32 v105, v82, v83
    v_mfma_f32_32x32x16_bf16 a[64:79], a[104:107], v[96:99], a[64:79]
    v_exp_f32 v88, v88
    v_exp_f32 v89, v89
    v_cvt_pk_bf16_f32 v106, v84, v85
    v_exp_f32 v90, v90
    v_exp_f32 v91, v91
    v_cvt_pk_bf16_f32 v107, v86, v87
    v_exp_f32 v92, v92
    v_mfma_f32_32x32x16_bf16 a[64:79], a[108:111], v[100:103], a[64:79]
    v_exp_f32 v93, v93
    v_cvt_pk_bf16_f32 v108, v88, v89
    v_exp_f32 v94, v94
    v_exp_f32 v95, v95
    v_cvt_pk_bf16_f32 v109, v90, v91
    v_cvt_pk_bf16_f32 v110, v92, v93
    v_cvt_pk_bf16_f32 v111, v94, v95
    v_mfma_f32_32x32x16_bf16 v[80:95], a[112:115], a[8:11], 0
    v_exp_f32 v64, v64
    v_exp_f32 v65, v65
    v_exp_f32 v66, v66
    v_exp_f32 v67, v67
    v_mfma_f32_32x32x16_bf16 v[80:95], a[116:119], a[12:15], v[80:95]
    v_exp_f32 v68, v68
    v_exp_f32 v69, v69
    v_cvt_pk_bf16_f32 v96, v64, v65
    v_exp_f32 v70, v70
    v_exp_f32 v71, v71
    v_cvt_pk_bf16_f32 v97, v66, v67
    v_mfma_f32_32x32x16_bf16 a[80:95], a[104:107], v[104:107], a[80:95]
    v_exp_f32 v72, v72
    v_exp_f32 v73, v73
    v_cvt_pk_bf16_f32 v98, v68, v69
    v_exp_f32 v74, v74
    v_exp_f32 v75, v75
    v_cvt_pk_bf16_f32 v99, v70, v71
    v_exp_f32 v76, v76
    v_mfma_f32_32x32x16_bf16 a[80:95], a[108:111], v[108:111], a[80:95]
    s_add_u32 m0, s63, 6144
    s_add_u32 s64, s69, 86016
    buffer_load_dwordx4 v41, s[52:55], s64 offen lds
    v_exp_f32 v77, v77
    v_cvt_pk_bf16_f32 v100, v72, v73
    v_exp_f32 v78, v78
    v_exp_f32 v79, v79
    v_cvt_pk_bf16_f32 v101, v74, v75
    v_cvt_pk_bf16_f32 v102, v76, v77
    v_cvt_pk_bf16_f32 v103, v78, v79
    v_mfma_f32_32x32x16_bf16 v[64:79], a[112:115], a[16:19], 0
    buffer_load_dwordx4 a[96:99], v13, s[40:43], s86 offen offset:0 sc1
    v_exp_f32 v80, v80
    v_exp_f32 v81, v81
    v_exp_f32 v82, v82
    v_exp_f32 v83, v83
    v_mfma_f32_32x32x16_bf16 v[64:79], a[116:119], a[20:23], v[64:79]
    buffer_load_dwordx4 a[100:103], v13, s[40:43], s86 offen offset:1024 sc1
    v_exp_f32 v84, v84
    v_exp_f32 v85, v85
    v_cvt_pk_bf16_f32 v104, v80, v81
    v_exp_f32 v86, v86
    v_exp_f32 v87, v87
    v_cvt_pk_bf16_f32 v105, v82, v83
    v_mfma_f32_32x32x16_bf16 a[32:47], a[120:123], v[96:99], a[32:47]
    buffer_load_dwordx4 a[104:107], v13, s[40:43], s86 offen offset:2048 sc1
    v_exp_f32 v88, v88
    v_exp_f32 v89, v89
    v_cvt_pk_bf16_f32 v106, v84, v85
    v_exp_f32 v90, v90
    v_exp_f32 v91, v91
    v_cvt_pk_bf16_f32 v107, v86, v87
    v_exp_f32 v92, v92
    v_mfma_f32_32x32x16_bf16 a[32:47], a[124:127], v[100:103], a[32:47]
    buffer_load_dwordx4 a[108:111], v13, s[40:43], s86 offen offset:3072 sc1
    v_exp_f32 v93, v93
    v_cvt_pk_bf16_f32 v108, v88, v89
    v_exp_f32 v94, v94
    v_exp_f32 v95, v95
    v_cvt_pk_bf16_f32 v109, v90, v91
    v_cvt_pk_bf16_f32 v110, v92, v93
    v_cvt_pk_bf16_f32 v111, v94, v95
    v_mfma_f32_32x32x16_bf16 v[80:95], a[112:115], a[24:27], 0
    v_exp_f32 v64, v64
    v_exp_f32 v65, v65
    v_exp_f32 v66, v66
    v_exp_f32 v67, v67
    v_mfma_f32_32x32x16_bf16 v[80:95], a[116:119], a[28:31], v[80:95]
    v_exp_f32 v68, v68
    v_exp_f32 v69, v69
    v_cvt_pk_bf16_f32 v96, v64, v65
    v_exp_f32 v70, v70
    v_exp_f32 v71, v71
    v_cvt_pk_bf16_f32 v97, v66, v67
    v_mfma_f32_32x32x16_bf16 a[48:63], a[120:123], v[104:107], a[48:63]
    v_exp_f32 v72, v72
    v_exp_f32 v73, v73
    v_cvt_pk_bf16_f32 v98, v68, v69
    v_exp_f32 v74, v74
    v_exp_f32 v75, v75
    v_cvt_pk_bf16_f32 v99, v70, v71
    v_exp_f32 v76, v76
    v_mfma_f32_32x32x16_bf16 a[48:63], a[124:127], v[108:111], a[48:63]
    s_waitcnt vmcnt(12)
    v_exp_f32 v77, v77
    v_cvt_pk_bf16_f32 v100, v72, v73
    v_exp_f32 v78, v78
    v_exp_f32 v79, v79
    v_cvt_pk_bf16_f32 v101, v74, v75
    v_cvt_pk_bf16_f32 v102, v76, v77
    v_cvt_pk_bf16_f32 v103, v78, v79
    v_mfma_f32_32x32x16_bf16 v[64:79], a[128:131], a[0:3], 0
    v_exp_f32 v80, v80
    v_exp_f32 v81, v81
    v_exp_f32 v82, v82
    v_exp_f32 v83, v83
    v_mfma_f32_32x32x16_bf16 v[64:79], a[132:135], a[4:7], v[64:79]
    v_exp_f32 v84, v84
    v_exp_f32 v85, v85
    v_cvt_pk_bf16_f32 v104, v80, v81
    v_exp_f32 v86, v86
    v_exp_f32 v87, v87
    v_cvt_pk_bf16_f32 v105, v82, v83
    v_mfma_f32_32x32x16_bf16 a[64:79], a[120:123], v[96:99], a[64:79]
    s_add_u32 m0, s63, 7168
    s_add_u32 s64, s69, 100352
    buffer_load_dwordx4 v41, s[52:55], s64 offen lds
    v_exp_f32 v88, v88
    v_exp_f32 v89, v89
    v_cvt_pk_bf16_f32 v106, v84, v85
    v_exp_f32 v90, v90
    v_exp_f32 v91, v91
    v_cvt_pk_bf16_f32 v107, v86, v87
    v_exp_f32 v92, v92
    v_mfma_f32_32x32x16_bf16 a[64:79], a[124:127], v[100:103], a[64:79]
    v_exp_f32 v93, v93
    v_cvt_pk_bf16_f32 v108, v88, v89
    v_exp_f32 v94, v94
    v_exp_f32 v95, v95
    v_cvt_pk_bf16_f32 v109, v90, v91
    v_cvt_pk_bf16_f32 v110, v92, v93
    v_cvt_pk_bf16_f32 v111, v94, v95
    v_mfma_f32_32x32x16_bf16 v[80:95], a[128:131], a[8:11], 0
    v_exp_f32 v64, v64
    v_exp_f32 v65, v65
    v_exp_f32 v66, v66
    v_exp_f32 v67, v67
    v_mfma_f32_32x32x16_bf16 v[80:95], a[132:135], a[12:15], v[80:95]
    v_exp_f32 v68, v68
    v_exp_f32 v69, v69
    v_cvt_pk_bf16_f32 v96, v64, v65
    v_exp_f32 v70, v70
    v_exp_f32 v71, v71
    v_cvt_pk_bf16_f32 v97, v66, v67
    v_mfma_f32_32x32x16_bf16 a[80:95], a[120:123], v[104:107], a[80:95]
    v_exp_f32 v72, v72
    v_exp_f32 v73, v73
    v_cvt_pk_bf16_f32 v98, v68, v69
    v_exp_f32 v74, v74
    v_exp_f32 v75, v75
    v_cvt_pk_bf16_f32 v99, v70, v71
    v_exp_f32 v76, v76
    v_mfma_f32_32x32x16_bf16 a[80:95], a[124:127], v[108:111], a[80:95]
    v_exp_f32 v77, v77
    v_cvt_pk_bf16_f32 v100, v72, v73
    v_exp_f32 v78, v78
    v_exp_f32 v79, v79
    v_cvt_pk_bf16_f32 v101, v74, v75
    v_cvt_pk_bf16_f32 v102, v76, v77
    v_cvt_pk_bf16_f32 v103, v78, v79
    v_mfma_f32_32x32x16_bf16 v[64:79], a[128:131], a[16:19], 0
    buffer_load_dwordx4 a[112:115], v17, s[40:43], s86 offen offset:0 sc1
    v_exp_f32 v80, v80
    v_exp_f32 v81, v81
    v_exp_f32 v82, v82
    v_exp_f32 v83, v83
    v_mfma_f32_32x32x16_bf16 v[64:79], a[132:135], a[20:23], v[64:79]
    buffer_load_dwordx4 a[116:119], v17, s[40:43], s86 offen offset:1024 sc1
    v_exp_f32 v84, v84
    v_exp_f32 v85, v85
    v_cvt_pk_bf16_f32 v104, v80, v81
    v_exp_f32 v86, v86
    v_exp_f32 v87, v87
    v_cvt_pk_bf16_f32 v105, v82, v83
    v_mfma_f32_32x32x16_bf16 a[32:47], a[136:139], v[96:99], a[32:47]
    buffer_load_dwordx4 a[120:123], v17, s[40:43], s86 offen offset:2048 sc1
    v_exp_f32 v88, v88
    v_exp_f32 v89, v89
    v_cvt_pk_bf16_f32 v106, v84, v85
    v_exp_f32 v90, v90
    v_exp_f32 v91, v91
    v_cvt_pk_bf16_f32 v107, v86, v87
    v_exp_f32 v92, v92
    v_mfma_f32_32x32x16_bf16 a[32:47], a[140:143], v[100:103], a[32:47]
    buffer_load_dwordx4 a[124:127], v17, s[40:43], s86 offen offset:3072 sc1
    v_exp_f32 v93, v93
    v_cvt_pk_bf16_f32 v108, v88, v89
    v_exp_f32 v94, v94
    v_exp_f32 v95, v95
    v_cvt_pk_bf16_f32 v109, v90, v91
    v_cvt_pk_bf16_f32 v110, v92, v93
    v_cvt_pk_bf16_f32 v111, v94, v95
    v_mfma_f32_32x32x16_bf16 v[80:95], a[128:131], a[24:27], 0
    v_exp_f32 v64, v64
    v_exp_f32 v65, v65
    v_exp_f32 v66, v66
    v_exp_f32 v67, v67
    v_mfma_f32_32x32x16_bf16 v[80:95], a[132:135], a[28:31], v[80:95]
    v_exp_f32 v68, v68
    v_exp_f32 v69, v69
    v_cvt_pk_bf16_f32 v96, v64, v65
    v_exp_f32 v70, v70
    v_exp_f32 v71, v71
    v_cvt_pk_bf16_f32 v97, v66, v67
    v_mfma_f32_32x32x16_bf16 a[48:63], a[136:139], v[104:107], a[48:63]
    v_exp_f32 v72, v72
    v_exp_f32 v73, v73
    v_cvt_pk_bf16_f32 v98, v68, v69
    v_exp_f32 v74, v74
    v_exp_f32 v75, v75
    v_cvt_pk_bf16_f32 v99, v70, v71
    v_exp_f32 v76, v76
    v_mfma_f32_32x32x16_bf16 a[48:63], a[140:143], v[108:111], a[48:63]
    s_waitcnt vmcnt(11)
    v_exp_f32 v77, v77
    v_cvt_pk_bf16_f32 v100, v72, v73
    v_exp_f32 v78, v78
    v_exp_f32 v79, v79
    v_cvt_pk_bf16_f32 v101, v74, v75
    v_cvt_pk_bf16_f32 v102, v76, v77
    v_cvt_pk_bf16_f32 v103, v78, v79
    v_mfma_f32_32x32x16_bf16 v[64:79], a[144:147], a[0:3], 0
    v_exp_f32 v80, v80
    v_exp_f32 v81, v81
    v_exp_f32 v82, v82
    v_exp_f32 v83, v83
    v_mfma_f32_32x32x16_bf16 v[64:79], a[148:151], a[4:7], v[64:79]
    v_exp_f32 v84, v84
    v_exp_f32 v85, v85
    v_cvt_pk_bf16_f32 v104, v80, v81
    v_exp_f32 v86, v86
    v_exp_f32 v87, v87
    v_cvt_pk_bf16_f32 v105, v82, v83
    v_mfma_f32_32x32x16_bf16 a[64:79], a[136:139], v[96:99], a[64:79]
    v_exp_f32 v88, v88
    v_exp_f32 v89, v89
    v_cvt_pk_bf16_f32 v106, v84, v85
    v_exp_f32 v90, v90
    v_exp_f32 v91, v91
    v_cvt_pk_bf16_f32 v107, v86, v87
    v_exp_f32 v92, v92
    v_mfma_f32_32x32x16_bf16 a[64:79], a[140:143], v[100:103], a[64:79]
    v_exp_f32 v93, v93
    v_cvt_pk_bf16_f32 v108, v88, v89
    v_exp_f32 v94, v94
    v_exp_f32 v95, v95
    v_cvt_pk_bf16_f32 v109, v90, v91
    v_cvt_pk_bf16_f32 v110, v92, v93
    v_cvt_pk_bf16_f32 v111, v94, v95
    v_mfma_f32_32x32x16_bf16 v[80:95], a[144:147], a[8:11], 0
    buffer_load_dword v20, v40, s[40:43], 0 offen sc1
    v_exp_f32 v64, v64
    v_exp_f32 v65, v65
    v_exp_f32 v66, v66
    v_exp_f32 v67, v67
    v_mfma_f32_32x32x16_bf16 v[80:95], a[148:151], a[12:15], v[80:95]
    v_exp_f32 v68, v68
    v_exp_f32 v69, v69
    v_cvt_pk_bf16_f32 v96, v64, v65
    v_exp_f32 v70, v70
    v_exp_f32 v71, v71
    v_cvt_pk_bf16_f32 v97, v66, v67
    v_mfma_f32_32x32x16_bf16 a[80:95], a[136:139], v[104:107], a[80:95]
    v_exp_f32 v72, v72
    v_exp_f32 v73, v73
    v_cvt_pk_bf16_f32 v98, v68, v69
    v_exp_f32 v74, v74
    v_exp_f32 v75, v75
    v_cvt_pk_bf16_f32 v99, v70, v71
    v_exp_f32 v76, v76
    v_mfma_f32_32x32x16_bf16 a[80:95], a[140:143], v[108:111], a[80:95]
    v_exp_f32 v77, v77
    v_cvt_pk_bf16_f32 v100, v72, v73
    v_exp_f32 v78, v78
    v_exp_f32 v79, v79
    v_cvt_pk_bf16_f32 v101, v74, v75
    v_cvt_pk_bf16_f32 v102, v76, v77
    v_cvt_pk_bf16_f32 v103, v78, v79
    v_mfma_f32_32x32x16_bf16 v[64:79], a[144:147], a[16:19], 0
    buffer_load_dwordx4 a[128:131], v18, s[40:43], s86 offen offset:0 sc1
    v_exp_f32 v80, v80
    v_exp_f32 v81, v81
    v_exp_f32 v82, v82
    v_exp_f32 v83, v83
    v_mfma_f32_32x32x16_bf16 v[64:79], a[148:151], a[20:23], v[64:79]
    buffer_load_dwordx4 a[132:135], v18, s[40:43], s86 offen offset:1024 sc1
    v_exp_f32 v84, v84
    v_exp_f32 v85, v85
    v_cvt_pk_bf16_f32 v104, v80, v81
    v_exp_f32 v86, v86
    v_exp_f32 v87, v87
    v_cvt_pk_bf16_f32 v105, v82, v83
    v_mfma_f32_32x32x16_bf16 a[32:47], a[152:155], v[96:99], a[32:47]
    buffer_load_dwordx4 a[136:139], v18, s[40:43], s86 offen offset:2048 sc1
    v_exp_f32 v88, v88
    v_exp_f32 v89, v89
    v_cvt_pk_bf16_f32 v106, v84, v85
    v_exp_f32 v90, v90
    v_exp_f32 v91, v91
    v_cvt_pk_bf16_f32 v107, v86, v87
    v_exp_f32 v92, v92
    v_mfma_f32_32x32x16_bf16 a[32:47], a[156:159], v[100:103], a[32:47]
    buffer_load_dwordx4 a[140:143], v18, s[40:43], s86 offen offset:3072 sc1
    v_exp_f32 v93, v93
    v_cvt_pk_bf16_f32 v108, v88, v89
    v_exp_f32 v94, v94
    v_exp_f32 v95, v95
    v_cvt_pk_bf16_f32 v109, v90, v91
    v_cvt_pk_bf16_f32 v110, v92, v93
    v_cvt_pk_bf16_f32 v111, v94, v95
    v_mfma_f32_32x32x16_bf16 v[80:95], a[144:147], a[24:27], 0
    v_exp_f32 v64, v64
    v_exp_f32 v65, v65
    v_exp_f32 v66, v66
    v_exp_f32 v67, v67
    v_mfma_f32_32x32x16_bf16 v[80:95], a[148:151], a[28:31], v[80:95]
    v_exp_f32 v68, v68
    v_exp_f32 v69, v69
    v_cvt_pk_bf16_f32 v96, v64, v65
    v_exp_f32 v70, v70
    v_exp_f32 v71, v71
    v_cvt_pk_bf16_f32 v97, v66, v67
    v_mfma_f32_32x32x16_bf16 a[48:63], a[152:155], v[104:107], a[48:63]
    v_exp_f32 v72, v72
    v_exp_f32 v73, v73
    v_cvt_pk_bf16_f32 v98, v68, v69
    v_exp_f32 v74, v74
    v_exp_f32 v75, v75
    v_cvt_pk_bf16_f32 v99, v70, v71
    v_exp_f32 v76, v76
    v_mfma_f32_32x32x16_bf16 a[48:63], a[156:159], v[108:111], a[48:63]
    s_waitcnt vmcnt(10)
    v_exp_f32 v77, v77
    v_cvt_pk_bf16_f32 v100, v72, v73
    v_exp_f32 v78, v78
    v_exp_f32 v79, v79
    v_cvt_pk_bf16_f32 v101, v74, v75
    v_cvt_pk_bf16_f32 v102, v76, v77
    v_cvt_pk_bf16_f32 v103, v78, v79
    v_mfma_f32_32x32x16_bf16 v[64:79], a[96:99], a[0:3], 0
    v_exp_f32 v80, v80
    v_exp_f32 v81, v81
    v_exp_f32 v82, v82
    v_exp_f32 v83, v83
    v_mfma_f32_32x32x16_bf16 v[64:79], a[100:103], a[4:7], v[64:79]
    v_exp_f32 v84, v84
    v_exp_f32 v85, v85
    v_cvt_pk_bf16_f32 v104, v80, v81
    v_exp_f32 v86, v86
    v_exp_f32 v87, v87
    v_cvt_pk_bf16_f32 v105, v82, v83
    v_mfma_f32_32x32x16_bf16 a[64:79], a[152:155], v[96:99], a[64:79]
    v_exp_f32 v88, v88
    v_exp_f32 v89, v89
    v_cvt_pk_bf16_f32 v106, v84, v85
    v_exp_f32 v90, v90
    v_exp_f32 v91, v91
    v_cvt_pk_bf16_f32 v107, v86, v87
    v_exp_f32 v92, v92
    v_mfma_f32_32x32x16_bf16 a[64:79], a[156:159], v[100:103], a[64:79]
    v_exp_f32 v93, v93
    v_cvt_pk_bf16_f32 v108, v88, v89
    v_exp_f32 v94, v94
    v_exp_f32 v95, v95
    v_cvt_pk_bf16_f32 v109, v90, v91
    v_cvt_pk_bf16_f32 v110, v92, v93
    v_cvt_pk_bf16_f32 v111, v94, v95
    v_mfma_f32_32x32x16_bf16 v[80:95], a[96:99], a[8:11], 0
    s_waitcnt vmcnt(4)
    v_cmp_ne_u32 vcc, s3, v20
    s_cbranch_vccnz LCHK_3
LCHKD_4:
    v_exp_f32 v64, v64
    v_exp_f32 v65, v65
    v_exp_f32 v66, v66
    v_exp_f32 v67, v67
    v_mfma_f32_32x32x16_bf16 v[80:95], a[100:103], a[12:15], v[80:95]
    v_exp_f32 v68, v68
    v_exp_f32 v69, v69
    v_cvt_pk_bf16_f32 v96, v64, v65
    v_exp_f32 v70, v70
    v_exp_f32 v71, v71
    v_cvt_pk_bf16_f32 v97, v66, v67
    v_mfma_f32_32x32x16_bf16 a[80:95], a[152:155], v[104:107], a[80:95]
    v_exp_f32 v72, v72
    v_exp_f32 v73, v73
    v_cvt_pk_bf16_f32 v98, v68, v69
    v_exp_f32 v74, v74
    v_exp_f32 v75, v75
    v_cvt_pk_bf16_f32 v99, v70, v71
    v_exp_f32 v76, v76
    v_mfma_f32_32x32x16_bf16 a[80:95], a[156:159], v[108:111], a[80:95]
    v_exp_f32 v77, v77
    v_cvt_pk_bf16_f32 v100, v72, v73
    v_exp_f32 v78, v78
    v_exp_f32 v79, v79
    v_cvt_pk_bf16_f32 v101, v74, v75
    v_cvt_pk_bf16_f32 v102, v76, v77
    v_cvt_pk_bf16_f32 v103, v78, v79
    v_mfma_f32_32x32x16_bf16 v[64:79], a[96:99], a[16:19], 0
    buffer_load_dwordx4 a[144:147], v19, s[40:43], s86 offen offset:0 sc1
    v_exp_f32 v80, v80
    v_exp_f32 v81, v81
    v_exp_f32 v82, v82
    v_exp_f32 v83, v83
    v_mfma_f32_32x32x16_bf16 v[64:79], a[100:103], a[20:23], v[64:79]
    buffer_load_dwordx4 a[148:151], v19, s[40:43], s86 offen offset:1024 sc1
    v_exp_f32 v84, v84
    v_exp_f32 v85, v85
    v_cvt_pk_bf16_f32 v104, v80, v81
    v_exp_f32 v86, v86
    v_exp_f32 v87, v87
    v_cvt_pk_bf16_f32 v105, v82, v83
    v_mfma_f32_32x32x16_bf16 a[32:47], a[104:107], v[96:99], a[32:47]
    buffer_load_dwordx4 a[152:155], v19, s[40:43], s86 offen offset:2048 sc1
    v_exp_f32 v88, v88
    v_exp_f32 v89, v89
    v_cvt_pk_bf16_f32 v106, v84, v85
    v_exp_f32 v90, v90
    v_exp_f32 v91, v91
    v_cvt_pk_bf16_f32 v107, v86, v87
    v_exp_f32 v92, v92
    v_mfma_f32_32x32x16_bf16 a[32:47], a[108:111], v[100:103], a[32:47]
    buffer_load_dwordx4 a[156:159], v19, s[40:43], s86 offen offset:3072 sc1
    v_exp_f32 v93, v93
    v_cvt_pk_bf16_f32 v108, v88, v89
    v_exp_f32 v94, v94
    v_exp_f32 v95, v95
    v_cvt_pk_bf16_f32 v109, v90, v91
    v_cvt_pk_bf16_f32 v110, v92, v93
    v_cvt_pk_bf16_f32 v111, v94, v95
    v_mfma_f32_32x32x16_bf16 v[80:95], a[96:99], a[24:27], 0
    buffer_load_dwordx4 a[160:163], v24, s[40:43], s88 offen offset:0 sc1
    v_exp_f32 v64, v64
    v_exp_f32 v65, v65
    v_exp_f32 v66, v66
    v_exp_f32 v67, v67
    v_mfma_f32_32x32x16_bf16 v[80:95], a[100:103], a[28:31], v[80:95]
    buffer_load_dwordx4 a[164:167], v24, s[40:43], s89 offen offset:0 sc1
    v_exp_f32 v68, v68
    v_exp_f32 v69, v69
    v_cvt_pk_bf16_f32 v96, v64, v65
    v_exp_f32 v70, v70
    v_exp_f32 v71, v71
    v_cvt_pk_bf16_f32 v97, v66, v67
    v_mfma_f32_32x32x16_bf16 a[48:63], a[104:107], v[104:107], a[48:63]
    buffer_load_dwordx4 a[168:171], v24, s[40:43], s88 offen offset:1024 sc1
    v_exp_f32 v72, v72
    v_exp_f32 v73, v73
    v_cvt_pk_bf16_f32 v98, v68, v69
    v_exp_f32 v74, v74
    v_exp_f32 v75, v75
    v_cvt_pk_bf16_f32 v99, v70, v71
    v_exp_f32 v76, v76
    v_mfma_f32_32x32x16_bf16 a[48:63], a[108:111], v[108:111], a[48:63]
    v_exp_f32 v77, v77
    v_cvt_pk_bf16_f32 v100, v72, v73
    v_exp_f32 v78, v78
    v_exp_f32 v79, v79
    v_cvt_pk_bf16_f32 v101, v74, v75
    v_cvt_pk_bf16_f32 v102, v76, v77
    v_cvt_pk_bf16_f32 v103, v78, v79
    v_mfma_f32_32x32x16_bf16 v[64:79], a[112:115], a[0:3], 0
    buffer_load_dwordx4 a[172:175], v24, s[40:43], s89 offen offset:1024 sc1
    v_exp_f32 v80, v80
    v_exp_f32 v81, v81
    v_exp_f32 v82, v82
    v_exp_f32 v83, v83
    v_mfma_f32_32x32x16_bf16 v[64:79], a[116:119], a[4:7], v[64:79]
    v_exp_f32 v84, v84
    v_exp_f32 v85, v85
    v_cvt_pk_bf16_f32 v104, v80, v81
    v_exp_f32 v86, v86
    v_exp_f32 v87, v87
    v_cvt_pk_bf16_f32 v105, v82, v83
    v_mfma_f32_32x32x16_bf16 a[64:79], a[104:107], v[96:99], a[64:79]
    buffer_load_dwordx4 a[176:179], v24, s[40:43], s88 offen offset:2048 sc1
    v_exp_f32 v88, v88
    v_exp_f32 v89, v89
    v_cvt_pk_bf16_f32 v106, v84, v85
    v_exp_f32 v90, v90
    v_exp_f32 v91, v91
    v_cvt_pk_bf16_f32 v107, v86, v87
    v_exp_f32 v92, v92
    v_mfma_f32_32x32x16_bf16 a[64:79], a[108:111], v[100:103], a[64:79]
    buffer_load_dwordx4 a[180:183], v24, s[40:43], s89 offen offset:2048 sc1
    v_exp_f32 v93, v93
    v_cvt_pk_bf16_f32 v108, v88, v89
    v_exp_f32 v94, v94
    v_exp_f32 v95, v95
    v_cvt_pk_bf16_f32 v109, v90, v91
    v_cvt_pk_bf16_f32 v110, v92, v93
    v_cvt_pk_bf16_f32 v111, v94, v95
    v_mfma_f32_32x32x16_bf16 v[80:95], a[112:115], a[8:11], 0
    buffer_load_dwordx4 a[184:187], v24, s[40:43], s88 offen offset:3072 sc1
    v_exp_f32 v64, v64
    v_exp_f32 v65, v65
    v_exp_f32 v66, v66
    v_exp_f32 v67, v67
    v_mfma_f32_32x32x16_bf16 v[80:95], a[116:119], a[12:15], v[80:95]
    v_exp_f32 v68, v68
    v_exp_f32 v69, v69
    v_cvt_pk_bf16_f32 v96, v64, v65
    v_exp_f32 v70, v70
    v_exp_f32 v71, v71
    v_cvt_pk_bf16_f32 v97, v66, v67
    v_mfma_f32_32x32x16_bf16 a[80:95], a[104:107], v[104:107], a[80:95]
    buffer_load_dwordx4 a[188:191], v24, s[40:43], s89 offen offset:3072 sc1
    v_exp_f32 v72, v72
    v_exp_f32 v73, v73
    v_cvt_pk_bf16_f32 v98, v68, v69
    v_exp_f32 v74, v74
    v_exp_f32 v75, v75
    v_cvt_pk_bf16_f32 v99, v70, v71
    v_exp_f32 v76, v76
    v_mfma_f32_32x32x16_bf16 a[80:95], a[108:111], v[108:111], a[80:95]
    buffer_load_dwordx4 a[192:195], v25, s[40:43], s88 offen offset:0 sc1
    v_exp_f32 v77, v77
    v_cvt_pk_bf16_f32 v100, v72, v73
    v_exp_f32 v78, v78
    v_exp_f32 v79, v79
    v_cvt_pk_bf16_f32 v101, v74, v75
    v_cvt_pk_bf16_f32 v102, v76, v77
    v_cvt_pk_bf16_f32 v103, v78, v79
    v_mfma_f32_32x32x16_bf16 v[64:79], a[112:115], a[16:19], 0
    buffer_load_dwordx4 a[96:99], v13, s[40:43], s87 offen offset:0 sc1
    v_exp_f32 v80, v80
    v_exp_f32 v81, v81
    v_exp_f32 v82, v82
    v_exp_f32 v83, v83
    v_mfma_f32_32x32x16_bf16 v[64:79], a[116:119], a[20:23], v[64:79]
    buffer_load_dwordx4 a[100:103], v13, s[40:43], s87 offen offset:1024 sc1
    v_exp_f32 v84, v84
    v_exp_f32 v85, v85
    v_cvt_pk_bf16_f32 v104, v80, v81
    v_exp_f32 v86, v86
    v_exp_f32 v87, v87
    v_cvt_pk_bf16_f32 v105, v82, v83
    v_mfma_f32_32x32x16_bf16 a[32:47], a[120:123], v[96:99], a[32:47]
    buffer_load_dwordx4 a[104:107], v13, s[40:43], s87 offen offset:2048 sc1
    v_exp_f32 v88, v88
    v_exp_f32 v89, v89
    v_cvt_pk_bf16_f32 v106, v84, v85
    v_exp_f32 v90, v90
    v_exp_f32 v91, v91
    v_cvt_pk_bf16_f32 v107, v86, v87
    v_exp_f32 v92, v92
    v_mfma_f32_32x32x16_bf16 a[32:47], a[124:127], v[100:103], a[32:47]
    buffer_load_dwordx4 a[108:111], v13, s[40:43], s87 offen offset:3072 sc1
    v_exp_f32 v93, v93
    v_cvt_pk_bf16_f32 v108, v88, v89
    v_exp_f32 v94, v94
    v_exp_f32 v95, v95
    v_cvt_pk_bf16_f32 v109, v90, v91
    v_cvt_pk_bf16_f32 v110, v92, v93
    v_cvt_pk_bf16_f32 v111, v94, v95
    v_mfma_f32_32x32x16_bf16 v[80:95], a[112:115], a[24:27], 0
    buffer_load_dwordx4 a[196:199], v25, s[40:43], s89 offen offset:0 sc1
    v_exp_f32 v64, v64
    v_exp_f32 v65, v65
    v_exp_f32 v66, v66
    v_exp_f32 v67, v67
    v_mfma_f32_32x32x16_bf16 v[80:95], a[116:119], a[28:31], v[80:95]
    v_exp_f32 v68, v68
    v_exp_f32 v69, v69
    v_cvt_pk_bf16_f32 v96, v64, v65
    v_exp_f32 v70, v70
    v_exp_f32 v71, v71
    v_cvt_pk_bf16_f32 v97, v66, v67
    v_mfma_f32_32x32x16_bf16 a[48:63], a[120:123], v[104:107], a[48:63]
    buffer_load_dwordx4 a[200:203], v25, s[40:43], s88 offen offset:1024 sc1
    v_exp_f32 v72, v72
    v_exp_f32 v73, v73
    v_cvt_pk_bf16_f32 v98, v68, v69
    v_exp_f32 v74, v74
    v_exp_f32 v75, v75
    v_cvt_pk_bf16_f32 v99, v70, v71
    v_exp_f32 v76, v76
    v_mfma_f32_32x32x16_bf16 a[48:63], a[124:127], v[108:111], a[48:63]
    s_waitcnt vmcnt(19)
    v_exp_f32 v77, v77
    v_cvt_pk_bf16_f32 v100, v72, v73
    v_exp_f32 v78, v78
    v_exp_f32 v79, v79
    v_cvt_pk_bf16_f32 v101, v74, v75
    v_cvt_pk_bf16_f32 v102, v76, v77
    v_cvt_pk_bf16_f32 v103, v78, v79
    v_mfma_f32_32x32x16_bf16 v[64:79], a[128:131], a[0:3], 0
    buffer_load_dwordx4 a[204:207], v25, s[40:43], s89 offen offset:1024 sc1
    v_exp_f32 v80, v80
    v_exp_f32 v81, v81
    v_exp_f32 v82, v82
    v_exp_f32 v83, v83
    v_mfma_f32_32x32x16_bf16 v[64:79], a[132:135], a[4:7], v[64:79]
    buffer_load_dwordx4 a[208:211], v25, s[40:43], s88 offen offset:2048 sc1
    v_exp_f32 v84, v84
    v_exp_f32 v85, v85
    v_cvt_pk_bf16_f32 v104, v80, v81
    v_exp_f32 v86, v86
    v_exp_f32 v87, v87
    v_cvt_pk_bf16_f32 v105, v82, v83
    v_mfma_f32_32x32x16_bf16 a[64:79], a[120:123], v[96:99], a[64:79]
    buffer_load_dwordx4 a[212:215], v25, s[40:43], s89 offen offset:2048 sc1
    v_exp_f32 v88, v88
    v_exp_f32 v89, v89
    v_cvt_pk_bf16_f32 v106, v84, v85
    v_exp_f32 v90, v90
    v_exp_f32 v91, v91
    v_cvt_pk_bf16_f32 v107, v86, v87
    v_exp_f32 v92, v92
    v_mfma_f32_32x32x16_bf16 a[64:79], a[124:127], v[100:103], a[64:79]
    v_exp_f32 v93, v93
    v_cvt_pk_bf16_f32 v108, v88, v89
    v_exp_f32 v94, v94
    v_exp_f32 v95, v95
    v_cvt_pk_bf16_f32 v109, v90, v91
    v_cvt_pk_bf16_f32 v110, v92, v93
    v_cvt_pk_bf16_f32 v111, v94, v95
    v_mfma_f32_32x32x16_bf16 v[80:95], a[128:131], a[8:11], 0
    buffer_load_dwordx4 a[216:219], v25, s[40:43], s88 offen offset:3072 sc1
    v_exp_f32 v64, v64
    v_exp_f32 v65, v65
    v_exp_f32 v66, v66
    v_exp_f32 v67, v67
    v_mfma_f32_32x32x16_bf16 v[80:95], a[132:135], a[12:15], v[80:95]
    buffer_load_dwordx4 a[220:223], v25, s[40:43], s89 offen offset:3072 sc1
    v_exp_f32 v68, v68
    v_exp_f32 v69, v69
    v_cvt_pk_bf16_f32 v96, v64, v65
    v_exp_f32 v70, v70
    v_exp_f32 v71, v71
    v_cvt_pk_bf16_f32 v97, v66, v67
    v_mfma_f32_32x32x16_bf16 a[80:95], a[120:123], v[104:107], a[80:95]
    buffer_load_dwordx4 a[224:227], v26, s[40:43], s88 offen offset:0 sc1
    v_exp_f32 v72, v72
    v_exp_f32 v73, v73
    v_cvt_pk_bf16_f32 v98, v68, v69
    v_exp_f32 v74, v74
    v_exp_f32 v75, v75
    v_cvt_pk_bf16_f32 v99, v70, v71
    v_exp_f32 v76, v76
    v_mfma_f32_32x32x16_bf16 a[80:95], a[124:127], v[108:111], a[80:95]
    v_exp_f32 v77, v77
    v_cvt_pk_bf16_f32 v100, v72, v73
    v_exp_f32 v78, v78
    v_exp_f32 v79, v79
    v_cvt_pk_bf16_f32 v101, v74, v75
    v_cvt_pk_bf16_f32 v102, v76, v77
    v_cvt_pk_bf16_f32 v103, v78, v79
    v_mfma_f32_32x32x16_bf16 v[64:79], a[128:131], a[16:19], 0
    buffer_load_dwordx4 a[112:115], v17, s[40:43], s87 offen offset:0 sc1
    v_exp_f32 v80, v80
    v_exp_f32 v81, v81
    v_exp_f32 v82, v82
    v_exp_f32 v83, v83
    v_mfma_f32_32x32x16_bf16 v[64:79], a[132:135], a[20:23], v[64:79]
    buffer_load_dwordx4 a[116:119], v17, s[40:43], s87 offen offset:1024 sc1
    v_exp_f32 v84, v84
    v_exp_f32 v85, v85
    v_cvt_pk_bf16_f32 v104, v80, v81
    v_exp_f32 v86, v86
    v_exp_f32 v87, v87
    v_cvt_pk_bf16_f32 v105, v82, v83
    v_mfma_f32_32x32x16_bf16 a[32:47], a[136:139], v[96:99], a[32:47]
    buffer_load_dwordx4 a[120:123], v17, s[40:43], s87 offen offset:2048 sc1
    v_exp_f32 v88, v88
    v_exp_f32 v89, v89
    v_cvt_pk_bf16_f32 v106, v84, v85
    v_exp_f32 v90, v90
    v_exp_f32 v91, v91
    v_cvt_pk_bf16_f32 v107, v86, v87
    v_exp_f32 v92, v92
    v_mfma_f32_32x32x16_bf16 a[32:47], a[140:143], v[100:103], a[32:47]
    buffer_load_dwordx4 a[124:127], v17, s[40:43], s87 offen offset:3072 sc1
    v_exp_f32 v93, v93
    v_cvt_pk_bf16_f32 v108, v88, v89
    v_exp_f32 v94, v94
    v_exp_f32 v95, v95
    v_cvt_pk_bf16_f32 v109, v90, v91
    v_cvt_pk_bf16_f32 v110, v92, v93
    v_cvt_pk_bf16_f32 v111, v94, v95
    v_mfma_f32_32x32x16_bf16 v[80:95], a[128:131], a[24:27], 0
    buffer_load_dwordx4 a[228:231], v26, s[40:43], s89 offen offset:0 sc1
    v_exp_f32 v64, v64
    v_exp_f32 v65, v65
    v_exp_f32 v66, v66
    v_exp_f32 v67, v67
    v_mfma_f32_32x32x16_bf16 v[80:95], a[132:135], a[28:31], v[80:95]
    buffer_load_dwordx4 a[232:235], v26, s[40:43], s88 offen offset:1024 sc1
    v_exp_f32 v68, v68
    v_exp_f32 v69, v69
    v_cvt_pk_bf16_f32 v96, v64, v65
    v_exp_f32 v70, v70
    v_exp_f32 v71, v71
    v_cvt_pk_bf16_f32 v97, v66, v67
    v_mfma_f32_32x32x16_bf16 a[48:63], a[136:139], v[104:107], a[48:63]
    buffer_load_dwordx4 a[236:239], v26, s[40:43], s89 offen offset:1024 sc1
    v_exp_f32 v72, v72
    v_exp_f32 v73, v73
    v_cvt_pk_bf16_f32 v98, v68, v69
    v_exp_f32 v74, v74
    v_exp_f32 v75, v75
    v_cvt_pk_bf16_f32 v99, v70, v71
    v_exp_f32 v76, v76
    v_mfma_f32_32x32x16_bf16 a[48:63], a[140:143], v[108:111], a[48:63]
    s_waitcnt vmcnt(28)
    v_exp_f32 v77, v77
    v_cvt_pk_bf16_f32 v100, v72, v73
    v_exp_f32 v78, v78
    v_exp_f32 v79, v79
    v_cvt_pk_bf16_f32 v101, v74, v75
    v_cvt_pk_bf16_f32 v102, v76, v77
    v_cvt_pk_bf16_f32 v103, v78, v79
    v_mfma_f32_32x32x16_bf16 v[64:79], a[144:147], a[0:3], 0
    v_exp_f32 v80, v80
    v_exp_f32 v81, v81
    v_exp_f32 v82, v82
    v_exp_f32 v83, v83
    v_mfma_f32_32x32x16_bf16 v[64:79], a[148:151], a[4:7], v[64:79]
    buffer_load_dwordx4 a[240:243], v26, s[40:43], s88 offen offset:2048 sc1
    v_exp_f32 v84, v84
    v_exp_f32 v85, v85
    v_cvt_pk_bf16_f32 v104, v80, v81
    v_exp_f32 v86, v86
    v_exp_f32 v87, v87
    v_cvt_pk_bf16_f32 v105, v82, v83
    v_mfma_f32_32x32x16_bf16 a[64:79], a[136:139], v[96:99], a[64:79]
    buffer_load_dwordx4 a[244:247], v26, s[40:43], s89 offen offset:2048 sc1
    v_exp_f32 v88, v88
    v_exp_f32 v89, v89
    v_cvt_pk_bf16_f32 v106, v84, v85
    v_exp_f32 v90, v90
    v_exp_f32 v91, v91
    v_cvt_pk_bf16_f32 v107, v86, v87
    v_exp_f32 v92, v92
    v_mfma_f32_32x32x16_bf16 a[64:79], a[140:143], v[100:103], a[64:79]
    buffer_load_dwordx4 a[248:251], v26, s[40:43], s88 offen offset:3072 sc1
    v_exp_f32 v93, v93
    v_cvt_pk_bf16_f32 v108, v88, v89
    v_exp_f32 v94, v94
    v_exp_f32 v95, v95
    v_cvt_pk_bf16_f32 v109, v90, v91
    v_cvt_pk_bf16_f32 v110, v92, v93
    v_cvt_pk_bf16_f32 v111, v94, v95
    v_mfma_f32_32x32x16_bf16 v[80:95], a[144:147], a[8:11], 0
    buffer_load_dwordx4 a[252:255], v26, s[40:43], s89 offen offset:3072 sc1
    v_exp_f32 v64, v64
    v_exp_f32 v65, v65
    v_exp_f32 v66, v66
    v_exp_f32 v67, v67
    v_mfma_f32_32x32x16_bf16 v[80:95], a[148:151], a[12:15], v[80:95]
    v_exp_f32 v68, v68
    v_exp_f32 v69, v69
    v_cvt_pk_bf16_f32 v96, v64, v65
    v_exp_f32 v70, v70
    v_exp_f32 v71, v71
    v_cvt_pk_bf16_f32 v97, v66, v67
    v_mfma_f32_32x32x16_bf16 a[80:95], a[136:139], v[104:107], a[80:95]
    buffer_load_dwordx4 v[128:131], v27, s[40:43], s88 offen offset:0 sc1
    v_exp_f32 v72, v72
    v_exp_f32 v73, v73
    v_cvt_pk_bf16_f32 v98, v68, v69
    v_exp_f32 v74, v74
    v_exp_f32 v75, v75
    v_cvt_pk_bf16_f32 v99, v70, v71
    v_exp_f32 v76, v76
    v_mfma_f32_32x32x16_bf16 a[80:95], a[140:143], v[108:111], a[80:95]
    buffer_load_dwordx4 v[132:135], v27, s[40:43], s89 offen offset:0 sc1
    v_exp_f32 v77, v77
    v_cvt_pk_bf16_f32 v100, v72, v73
    v_exp_f32 v78, v78
    v_exp_f32 v79, v79
    v_cvt_pk_bf16_f32 v101, v74, v75
    v_cvt_pk_bf16_f32 v102, v76, v77
    v_cvt_pk_bf16_f32 v103, v78, v79
    v_mfma_f32_32x32x16_bf16 v[64:79], a[144:147], a[16:19], 0
    buffer_load_dwordx4 a[128:131], v18, s[40:43], s87 offen offset:0 sc1
    v_exp_f32 v80, v80
    v_exp_f32 v81, v81
    v_exp_f32 v82, v82
    v_exp_f32 v83, v83
    v_mfma_f32_32x32x16_bf16 v[64:79], a[148:151], a[20:23], v[64:79]
    buffer_load_dwordx4 a[132:135], v18, s[40:43], s87 offen offset:1024 sc1
    v_exp_f32 v84, v84
    v_exp_f32 v85, v85
    v_cvt_pk_bf16_f32 v104, v80, v81
    v_exp_f32 v86, v86
    v_exp_f32 v87, v87
    v_cvt_pk_bf16_f32 v105, v82, v83
    v_mfma_f32_32x32x16_bf16 a[32:47], a[152:155], v[96:99], a[32:47]
    buffer_load_dwordx4 a[136:139], v18, s[40:43], s87 offen offset:2048 sc1
    v_exp_f32 v88, v88
    v_exp_f32 v89, v89
    v_cvt_pk_bf16_f32 v106, v84, v85
    v_exp_f32 v90, v90
    v_exp_f32 v91, v91
    v_cvt_pk_bf16_f32 v107, v86, v87
    v_exp_f32 v92, v92
    v_mfma_f32_32x32x16_bf16 a[32:47], a[156:159], v[100:103], a[32:47]
    buffer_load_dwordx4 a[140:143], v18, s[40:43], s87 offen offset:3072 sc1
    v_exp_f32 v93, v93
    v_cvt_pk_bf16_f32 v108, v88, v89
    v_exp_f32 v94, v94
    v_exp_f32 v95, v95
    v_cvt_pk_bf16_f32 v109, v90, v91
    v_cvt_pk_bf16_f32 v110, v92, v93
    v_cvt_pk_bf16_f32 v111, v94, v95
    v_mfma_f32_32x32x16_bf16 v[80:95], a[144:147], a[24:27], 0
    buffer_load_dwordx4 v[136:139], v27, s[40:43], s88 offen offset:1024 sc1
    v_exp_f32 v64, v64
    v_exp_f32 v65, v65
    v_exp_f32 v66, v66
    v_exp_f32 v67, v67
    v_mfma_f32_32x32x16_bf16 v[80:95], a[148:151], a[28:31], v[80:95]
    v_exp_f32 v68, v68
    v_exp_f32 v69, v69
    v_cvt_pk_bf16_f32 v96, v64, v65
    v_exp_f32 v70, v70
    v_exp_f32 v71, v71
    v_cvt_pk_bf16_f32 v97, v66, v67
    v_mfma_f32_32x32x16_bf16 a[48:63], a[152:155], v[104:107], a[48:63]
    buffer_load_dwordx4 v[140:143], v27, s[40:43], s89 offen offset:1024 sc1
    v_exp_f32 v72, v72
    v_exp_f32 v73, v73
    v_cvt_pk_bf16_f32 v98, v68, v69
    v_exp_f32 v74, v74
    v_exp_f32 v75, v75
    v_cvt_pk_bf16_f32 v99, v70, v71
    v_exp_f32 v76, v76
    v_mfma_f32_32x32x16_bf16 a[48:63], a[156:159], v[108:111], a[48:63]
    s_waitcnt vmcnt(27)
    v_exp_f32 v77, v77
    v_cvt_pk_bf16_f32 v100, v72, v73
    v_exp_f32 v78, v78
    v_exp_f32 v79, v79
    v_cvt_pk_bf16_f32 v101, v74, v75
    v_cvt_pk_bf16_f32 v102, v76, v77
    v_cvt_pk_bf16_f32 v103, v78, v79
    v_mfma_f32_32x32x16_bf16 v[64:79], a[96:99], a[0:3], 0
    buffer_load_dwordx4 v[144:147], v27, s[40:43], s88 offen offset:2048 sc1
    v_exp_f32 v80, v80
    v_exp_f32 v81, v81
    v_exp_f32 v82, v82
    v_exp_f32 v83, v83
    v_mfma_f32_32x32x16_bf16 v[64:79], a[100:103], a[4:7], v[64:79]
    buffer_load_dwordx4 v[148:151], v27, s[40:43], s89 offen offset:2048 sc1
    v_exp_f32 v84, v84
    v_exp_f32 v85, v85
    v_cvt_pk_bf16_f32 v104, v80, v81
    v_exp_f32 v86, v86
    v_exp_f32 v87, v87
    v_cvt_pk_bf16_f32 v105, v82, v83
    v_mfma_f32_32x32x16_bf16 a[64:79], a[152:155], v[96:99], a[64:79]
    v_exp_f32 v88, v88
    v_exp_f32 v89, v89
    v_cvt_pk_bf16_f32 v106, v84, v85
    v_exp_f32 v90, v90
    v_exp_f32 v91, v91
    v_cvt_pk_bf16_f32 v107, v86, v87
    v_exp_f32 v92, v92
    v_mfma_f32_32x32x16_bf16 a[64:79], a[156:159], v[100:103], a[64:79]
    buffer_load_dwordx4 v[152:155], v27, s[40:43], s88 offen offset:3072 sc1
    v_exp_f32 v93, v93
    v_cvt_pk_bf16_f32 v108, v88, v89
    v_exp_f32 v94, v94
    v_exp_f32 v95, v95
    v_cvt_pk_bf16_f32 v109, v90, v91
    v_cvt_pk_bf16_f32 v110, v92, v93
    v_cvt_pk_bf16_f32 v111, v94, v95
    v_mfma_f32_32x32x16_bf16 v[80:95], a[96:99], a[8:11], 0
    buffer_load_dwordx4 v[156:159], v27, s[40:43], s89 offen offset:3072 sc1
    v_exp_f32 v64, v64
    v_exp_f32 v65, v65
    v_exp_f32 v66, v66
    v_exp_f32 v67, v67
    v_mfma_f32_32x32x16_bf16 v[80:95], a[100:103], a[12:15], v[80:95]
    buffer_load_dwordx4 v[160:163], v28, s[40:43], s88 offen offset:0 sc1
    v_exp_f32 v68, v68
    v_exp_f32 v69, v69
    v_cvt_pk_bf16_f32 v96, v64, v65
    v_exp_f32 v70, v70
    v_exp_f32 v71, v71
    v_cvt_pk_bf16_f32 v97, v66, v67
    v_mfma_f32_32x32x16_bf16 a[80:95], a[152:155], v[104:107], a[80:95]
    v_exp_f32 v72, v72
    v_exp_f32 v73, v73
    v_cvt_pk_bf16_f32 v98, v68, v69
    v_exp_f32 v74, v74
    v_exp_f32 v75, v75
    v_cvt_pk_bf16_f32 v99, v70, v71
    v_exp_f32 v76, v76
    v_mfma_f32_32x32x16_bf16 a[80:95], a[156:159], v[108:111], a[80:95]
    buffer_load_dwordx4 v[164:167], v28, s[40:43], s89 offen offset:0 sc1
    v_exp_f32 v77, v77
    v_cvt_pk_bf16_f32 v100, v72, v73
    v_exp_f32 v78, v78
    v_exp_f32 v79, v79
    v_cvt_pk_bf16_f32 v101, v74, v75
    v_cvt_pk_bf16_f32 v102, v76, v77
    v_cvt_pk_bf16_f32 v103, v78, v79
    v_mfma_f32_32x32x16_bf16 v[64:79], a[96:99], a[16:19], 0
    buffer_load_dwordx4 a[144:147], v19, s[40:43], s87 offen offset:0 sc1
    v_exp_f32 v80, v80
    v_exp_f32 v81, v81
    v_exp_f32 v82, v82
    v_exp_f32 v83, v83
    v_mfma_f32_32x32x16_bf16 v[64:79], a[100:103], a[20:23], v[64:79]
    buffer_load_dwordx4 a[148:151], v19, s[40:43], s87 offen offset:1024 sc1
    v_exp_f32 v84, v84
    v_exp_f32 v85, v85
    v_cvt_pk_bf16_f32 v104, v80, v81
    v_exp_f32 v86, v86
    v_exp_f32 v87, v87
    v_cvt_pk_bf16_f32 v105, v82, v83
    v_mfma_f32_32x32x16_bf16 a[32:47], a[104:107], v[96:99], a[32:47]
    buffer_load_dwordx4 a[152:155], v19, s[40:43], s87 offen offset:2048 sc1
    v_exp_f32 v88, v88
    v_exp_f32 v89, v89
    v_cvt_pk_bf16_f32 v106, v84, v85
    v_exp_f32 v90, v90
    v_exp_f32 v91, v91
    v_cvt_pk_bf16_f32 v107, v86, v87
    v_exp_f32 v92, v92
    v_mfma_f32_32x32x16_bf16 a[32:47], a[108:111], v[100:103], a[32:47]
    buffer_load_dwordx4 a[156:159], v19, s[40:43], s87 offen offset:3072 sc1
    v_exp_f32 v93, v93
    v_cvt_pk_bf16_f32 v108, v88, v89
    v_exp_f32 v94, v94
    v_exp_f32 v95, v95
    v_cvt_pk_bf16_f32 v109, v90, v91
    v_cvt_pk_bf16_f32 v110, v92, v93
    v_cvt_pk_bf16_f32 v111, v94, v95
    v_mfma_f32_32x32x16_bf16 v[80:95], a[96:99], a[24:27], 0
    buffer_load_dwordx4 v[168:171], v28, s[40:43], s88 offen offset:1024 sc1
    v_exp_f32 v64, v64
    v_exp_f32 v65, v65
    v_exp_f32 v66, v66
    v_exp_f32 v67, v67
    v_mfma_f32_32x32x16_bf16 v[80:95], a[100:103], a[28:31], v[80:95]
    buffer_load_dwordx4 v[172:175], v28, s[40:43], s89 offen offset:1024 sc1
    v_exp_f32 v68, v68
    v_exp_f32 v69, v69
    v_cvt_pk_bf16_f32 v96, v64, v65
    v_exp_f32 v70, v70
    v_exp_f32 v71, v71
    v_cvt_pk_bf16_f32 v97, v66, v67
    v_mfma_f32_32x32x16_bf16 a[48:63], a[104:107], v[104:107], a[48:63]
    buffer_load_dwordx4 v[176:179], v28, s[40:43], s88 offen offset:2048 sc1
    v_exp_f32 v72, v72
    v_exp_f32 v73, v73
    v_cvt_pk_bf16_f32 v98, v68, v69
    v_exp_f32 v74, v74
    v_exp_f32 v75, v75
    v_cvt_pk_bf16_f32 v99, v70, v71
    v_exp_f32 v76, v76
    v_mfma_f32_32x32x16_bf16 a[48:63], a[108:111], v[108:111], a[48:63]
    s_waitcnt vmcnt(28)
    v_exp_f32 v77, v77
    v_cvt_pk_bf16_f32 v100, v72, v73
    v_exp_f32 v78, v78
    v_exp_f32 v79, v79
    v_cvt_pk_bf16_f32 v101, v74, v75
    v_cvt_pk_bf16_f32 v102, v76, v77
    v_cvt_pk_bf16_f32 v103, v78, v79
    v_mfma_f32_32x32x16_bf16 v[64:79], a[112:115], a[0:3], 0
    v_exp_f32 v80, v80
    v_exp_f32 v81, v81
    v_exp_f32 v82, v82
    v_exp_f32 v83, v83
    v_mfma_f32_32x32x16_bf16 v[64:79], a[116:119], a[4:7], v[64:79]
    buffer_load_dwordx4 v[180:183], v28, s[40:43], s89 offen offset:2048 sc1
    v_exp_f32 v84, v84
    v_exp_f32 v85, v85
    v_cvt_pk_bf16_f32 v104, v80, v81
    v_exp_f32 v86, v86
    v_exp_f32 v87, v87
    v_cvt_pk_bf16_f32 v105, v82, v83
    v_mfma_f32_32x32x16_bf16 a[64:79], a[104:107], v[96:99], a[64:79]
    buffer_load_dwordx4 v[184:187], v28, s[40:43], s88 offen offset:3072 sc1
    v_exp_f32 v88, v88
    v_exp_f32 v89, v89
    v_cvt_pk_bf16_f32 v106, v84, v85
    v_exp_f32 v90, v90
    v_exp_f32 v91, v91
    v_cvt_pk_bf16_f32 v107, v86, v87
    v_exp_f32 v92, v92
    v_mfma_f32_32x32x16_bf16 a[64:79], a[108:111], v[100:103], a[64:79]
    buffer_load_dwordx4 v[188:191], v28, s[40:43], s89 offen offset:3072 sc1
    v_exp_f32 v93, v93
    v_cvt_pk_bf16_f32 v108, v88, v89
    v_exp_f32 v94, v94
    v_exp_f32 v95, v95
    v_cvt_pk_bf16_f32 v109, v90, v91
    v_cvt_pk_bf16_f32 v110, v92, v93
    v_cvt_pk_bf16_f32 v111, v94, v95
    v_mfma_f32_32x32x16_bf16 v[80:95], a[112:115], a[8:11], 0
    s_lshl_b32 s9, s13, 2
    s_add_u32 s9, s9, s4
    s_lshl_b32 s9, s9, 13
    v_lshl_add_u32 v7, v1, 7, s9
    v_min_u32 v7, L_CODE_END-L_PC2-4, v7
    global_load_dword v7, v7, s[100:101]
    v_exp_f32 v64, v64
    v_exp_f32 v65, v65
    v_exp_f32 v66, v66
    v_exp_f32 v67, v67
    v_mfma_f32_32x32x16_bf16 v[80:95], a[116:119], a[12:15], v[80:95]
    buffer_load_dwordx4 v[192:195], v29, s[40:43], s88 offen offset:0 sc1
    v_exp_f32 v68, v68
    v_exp_f32 v69, v69
    v_cvt_pk_bf16_f32 v96, v64, v65
    v_exp_f32 v70, v70
    v_exp_f32 v71, v71
    v_cvt_pk_bf16_f32 v97, v66, v67
    v_mfma_f32_32x32x16_bf16 a[80:95], a[104:107], v[104:107], a[80:95]
    buffer_load_dwordx4 v[196:199], v29, s[40:43], s89 offen offset:0 sc1
    v_exp_f32 v72, v72
    v_exp_f32 v73, v73
    v_cvt_pk_bf16_f32 v98, v68, v69
    v_exp_f32 v74, v74
    v_exp_f32 v75, v75
    v_cvt_pk_bf16_f32 v99, v70, v71
    v_exp_f32 v76, v76
    v_mfma_f32_32x32x16_bf16 a[80:95], a[108:111], v[108:111], a[80:95]
    buffer_load_dwordx4 v[200:203], v29, s[40:43], s88 offen offset:1024 sc1
    v_exp_f32 v77, v77
    v_cvt_pk_bf16_f32 v100, v72, v73
    v_exp_f32 v78, v78
    v_exp_f32 v79, v79
    v_cvt_pk_bf16_f32 v101, v74, v75
    v_cvt_pk_bf16_f32 v102, v76, v77
    v_cvt_pk_bf16_f32 v103, v78, v79
    v_mfma_f32_32x32x16_bf16 v[64:79], a[112:115], a[16:19], 0
    v_exp_f32 v80, v80
    v_exp_f32 v81, v81
    v_exp_f32 v82, v82
    v_exp_f32 v83, v83
    v_mfma_f32_32x32x16_bf16 v[64:79], a[116:119], a[20:23], v[64:79]
    v_exp_f32 v84, v84
    v_exp_f32 v85, v85
    v_cvt_pk_bf16_f32 v104, v80, v81
    v_exp_f32 v86, v86
    v_exp_f32 v87, v87
    v_cvt_pk_bf16_f32 v105, v82, v83
    v_mfma_f32_32x32x16_bf16 a[32:47], a[120:123], v[96:99], a[32:47]
    v_exp_f32 v88, v88
    v_exp_f32 v89, v89
    v_cvt_pk_bf16_f32 v106, v84, v85
    v_exp_f32 v90, v90
    v_exp_f32 v91, v91
    v_cvt_pk_bf16_f32 v107, v86, v87
    v_exp_f32 v92, v92
    v_mfma_f32_32x32x16_bf16 a[32:47], a[124:127], v[100:103], a[32:47]
    v_exp_f32 v93, v93
    v_cvt_pk_bf16_f32 v108, v88, v89
    v_exp_f32 v94, v94
    v_exp_f32 v95, v95
    v_cvt_pk_bf16_f32 v109, v90, v91
    v_cvt_pk_bf16_f32 v110, v92, v93
    v_cvt_pk_bf16_f32 v111, v94, v95
    v_mfma_f32_32x32x16_bf16 v[80:95], a[112:115], a[24:27], 0
    v_exp_f32 v64, v64
    v_exp_f32 v65, v65
    v_exp_f32 v66, v66
    v_exp_f32 v67, v67
    v_mfma_f32_32x32x16_bf16 v[80:95], a[116:119], a[28:31], v[80:95]
    buffer_load_dwordx4 v[204:207], v29, s[40:43], s89 offen offset:1024 sc1
    v_exp_f32 v68, v68
    v_exp_f32 v69, v69
    v_cvt_pk_bf16_f32 v96, v64, v65
    v_exp_f32 v70, v70
    v_exp_f32 v71, v71
    v_cvt_pk_bf16_f32 v97, v66, v67
    v_mfma_f32_32x32x16_bf16 a[48:63], a[120:123], v[104:107], a[48:63]
    buffer_load_dwordx4 v[208:211], v29, s[40:43], s88 offen offset:2048 sc1
    v_exp_f32 v72, v72
    v_exp_f32 v73, v73
    v_cvt_pk_bf16_f32 v98, v68, v69
    v_exp_f32 v74, v74
    v_exp_f32 v75, v75
    v_cvt_pk_bf16_f32 v99, v70, v71
    v_exp_f32 v76, v76
    v_mfma_f32_32x32x16_bf16 a[48:63], a[124:127], v[108:111], a[48:63]
    s_waitcnt vmcnt(24)
    v_exp_f32 v77, v77
    v_cvt_pk_bf16_f32 v100, v72, v73
    v_exp_f32 v78, v78
    v_exp_f32 v79, v79
    v_cvt_pk_bf16_f32 v101, v74, v75
    v_cvt_pk_bf16_f32 v102, v76, v77
    v_cvt_pk_bf16_f32 v103, v78, v79
    v_mfma_f32_32x32x16_bf16 v[64:79], a[128:131], a[0:3], 0
    buffer_load_dwordx4 v[212:215], v29, s[40:43], s89 offen offset:2048 sc1
    v_exp_f32 v80, v80
    v_exp_f32 v81, v81
    v_exp_f32 v82, v82
    v_exp_f32 v83, v83
    v_mfma_f32_32x32x16_bf16 v[64:79], a[132:135], a[4:7], v[64:79]
    buffer_load_dwordx4 v[216:219], v29, s[40:43], s88 offen offset:3072 sc1
    v_exp_f32 v84, v84
    v_exp_f32 v85, v85
    v_cvt_pk_bf16_f32 v104, v80, v81
    v_exp_f32 v86, v86
    v_exp_f32 v87, v87
    v_cvt_pk_bf16_f32 v105, v82, v83
    v_mfma_f32_32x32x16_bf16 a[64:79], a[120:123], v[96:99], a[64:79]
    v_exp_f32 v88, v88
    v_exp_f32 v89, v89
    v_cvt_pk_bf16_f32 v106, v84, v85
    v_exp_f32 v90, v90
    v_exp_f32 v91, v91
    v_cvt_pk_bf16_f32 v107, v86, v87
    v_exp_f32 v92, v92
    v_mfma_f32_32x32x16_bf16 a[64:79], a[124:127], v[100:103], a[64:79]
    buffer_load_dwordx4 v[220:223], v29, s[40:43], s89 offen offset:3072 sc1
    v_exp_f32 v93, v93
    v_cvt_pk_bf16_f32 v108, v88, v89
    v_exp_f32 v94, v94
    v_exp_f32 v95, v95
    v_cvt_pk_bf16_f32 v109, v90, v91
    v_cvt_pk_bf16_f32 v110, v92, v93
    v_cvt_pk_bf16_f32 v111, v94, v95
    v_mfma_f32_32x32x16_bf16 v[80:95], a[128:131], a[8:11], 0
    buffer_load_dwordx4 v[224:227], v30, s[40:43], s88 offen offset:0 sc1
    v_exp_f32 v64, v64
    v_exp_f32 v65, v65
    v_exp_f32 v66, v66
    v_exp_f32 v67, v67
    v_mfma_f32_32x32x16_bf16 v[80:95], a[132:135], a[12:15], v[80:95]
    buffer_load_dwordx4 v[228:231], v30, s[40:43], s89 offen offset:0 sc1
    s_add_u32 s9, s4, 1
    s_and_b32 s9, s9, 3
    s_mul_i32 s9, s9, 28672
    v_add_u32 v60, s9, v15
    v_exp_f32 v68, v68
    v_exp_f32 v69, v69
    v_cvt_pk_bf16_f32 v96, v64, v65
    v_exp_f32 v70, v70
    v_exp_f32 v71, v71
    v_cvt_pk_bf16_f32 v97, v66, v67
    v_mfma_f32_32x32x16_bf16 a[80:95], a[120:123], v[104:107], a[80:95]
    v_exp_f32 v72, v72
    v_exp_f32 v73, v73
    v_cvt_pk_bf16_f32 v98, v68, v69
    v_exp_f32 v74, v74
    v_exp_f32 v75, v75
    v_cvt_pk_bf16_f32 v99, v70, v71
    v_exp_f32 v76, v76
    v_mfma_f32_32x32x16_bf16 a[80:95], a[124:127], v[108:111], a[80:95]
    buffer_load_dwordx4 v[232:235], v30, s[40:43], s88 offen offset:1024 sc1
    v_exp_f32 v77, v77
    v_cvt_pk_bf16_f32 v100, v72, v73
    v_exp_f32 v78, v78
    v_exp_f32 v79, v79
    v_cvt_pk_bf16_f32 v101, v74, v75
    v_cvt_pk_bf16_f32 v102, v76, v77
    v_cvt_pk_bf16_f32 v103, v78, v79
    v_mfma_f32_32x32x16_bf16 v[64:79], a[128:131], a[16:19], 0
    v_exp_f32 v80, v80
    v_exp_f32 v81, v81
    v_exp_f32 v82, v82
    v_exp_f32 v83, v83
    v_mfma_f32_32x32x16_bf16 v[64:79], a[132:135], a[20:23], v[64:79]
    v_exp_f32 v84, v84
    v_exp_f32 v85, v85
    v_cvt_pk_bf16_f32 v104, v80, v81
    v_exp_f32 v86, v86
    v_exp_f32 v87, v87
    v_cvt_pk_bf16_f32 v105, v82, v83
    v_mfma_f32_32x32x16_bf16 a[32:47], a[136:139], v[96:99], a[32:47]
    v_exp_f32 v88, v88
    v_exp_f32 v89, v89
    v_cvt_pk_bf16_f32 v106, v84, v85
    v_exp_f32 v90, v90
    v_exp_f32 v91, v91
    v_cvt_pk_bf16_f32 v107, v86, v87
    v_exp_f32 v92, v92
    v_mfma_f32_32x32x16_bf16 a[32:47], a[140:143], v[100:103], a[32:47]
    v_exp_f32 v93, v93
    v_cvt_pk_bf16_f32 v108, v88, v89
    v_exp_f32 v94, v94
    v_exp_f32 v95, v95
    v_cvt_pk_bf16_f32 v109, v90, v91
    v_cvt_pk_bf16_f32 v110, v92, v93
    v_cvt_pk_bf16_f32 v111, v94, v95
    v_mfma_f32_32x32x16_bf16 v[80:95], a[128:131], a[24:27], 0
    buffer_load_dwordx4 v[236:239], v30, s[40:43], s89 offen offset:1024 sc1
    v_exp_f32 v64, v64
    v_exp_f32 v65, v65
    v_exp_f32 v66, v66
    v_exp_f32 v67, v67
    v_mfma_f32_32x32x16_bf16 v[80:95], a[132:135], a[28:31], v[80:95]
    buffer_load_dwordx4 v[240:243], v30, s[40:43], s88 offen offset:2048 sc1
    s_add_u32 s9, s4, 2
    s_and_b32 s9, s9, 3
    s_mul_i32 s9, s9, 28672
    v_add_u32 v61, s9, v15
    v_exp_f32 v68, v68
    v_exp_f32 v69, v69
    v_cvt_pk_bf16_f32 v96, v64, v65
    v_exp_f32 v70, v70
    v_exp_f32 v71, v71
    v_cvt_pk_bf16_f32 v97, v66, v67
    v_mfma_f32_32x32x16_bf16 a[48:63], a[136:139], v[104:107], a[48:63]
    v_exp_f32 v72, v72
    v_exp_f32 v73, v73
    v_cvt_pk_bf16_f32 v98, v68, v69
    v_exp_f32 v74, v74
    v_exp_f32 v75, v75
    v_cvt_pk_bf16_f32 v99, v70, v71
    v_exp_f32 v76, v76
    v_mfma_f32_32x32x16_bf16 a[48:63], a[140:143], v[108:111], a[48:63]
    s_waitcnt vmcnt(20)
    v_exp_f32 v77, v77
    v_cvt_pk_bf16_f32 v100, v72, v73
    v_exp_f32 v78, v78
    v_exp_f32 v79, v79
    v_cvt_pk_bf16_f32 v101, v74, v75
    v_cvt_pk_bf16_f32 v102, v76, v77
    v_cvt_pk_bf16_f32 v103, v78, v79
    v_mfma_f32_32x32x16_bf16 v[64:79], a[144:147], a[0:3], 0
    buffer_load_dwordx4 v[244:247], v30, s[40:43], s89 offen offset:2048 sc1
    v_exp_f32 v80, v80
    v_exp_f32 v81, v81
    v_exp_f32 v82, v82
    v_exp_f32 v83, v83
    v_mfma_f32_32x32x16_bf16 v[64:79], a[148:151], a[4:7], v[64:79]
    buffer_load_dwordx4 v[248:251], v30, s[40:43], s88 offen offset:3072 sc1
    v_exp_f32 v84, v84
    v_exp_f32 v85, v85
    v_cvt_pk_bf16_f32 v104, v80, v81
    v_exp_f32 v86, v86
    v_exp_f32 v87, v87
    v_cvt_pk_bf16_f32 v105, v82, v83
    v_mfma_f32_32x32x16_bf16 a[64:79], a[136:139], v[96:99], a[64:79]
    buffer_load_dwordx4 v[252:255], v30, s[40:43], s89 offen offset:3072 sc1
    v_exp_f32 v88, v88
    v_exp_f32 v89, v89
    v_cvt_pk_bf16_f32 v106, v84, v85
    v_exp_f32 v90, v90
    v_exp_f32 v91, v91
    v_cvt_pk_bf16_f32 v107, v86, v87
    v_exp_f32 v92, v92
    v_mfma_f32_32x32x16_bf16 a[64:79], a[140:143], v[100:103], a[64:79]
    v_exp_f32 v93, v93
    v_cvt_pk_bf16_f32 v108, v88, v89
    v_exp_f32 v94, v94
    v_exp_f32 v95, v95
    v_cvt_pk_bf16_f32 v109, v90, v91
    v_cvt_pk_bf16_f32 v110, v92, v93
    v_cvt_pk_bf16_f32 v111, v94, v95
    v_mfma_f32_32x32x16_bf16 v[80:95], a[144:147], a[8:11], 0
    buffer_load_dwordx4 v[24:27], v43, s[40:43], s72 offen offset:0 sc1
    v_exp_f32 v64, v64
    v_exp_f32 v65, v65
    v_exp_f32 v66, v66
    v_exp_f32 v67, v67
    v_mfma_f32_32x32x16_bf16 v[80:95], a[148:151], a[12:15], v[80:95]
    buffer_load_dwordx4 v[28:31], v43, s[40:43], s72 offen offset:3584 sc1
    s_add_u32 s9, s4, 3
    s_and_b32 s9, s9, 3
    s_mul_i32 s9, s9, 28672
    v_add_u32 v62, s9, v15
    v_exp_f32 v68, v68
    v_exp_f32 v69, v69
    v_cvt_pk_bf16_f32 v96, v64, v65
    v_exp_f32 v70, v70
    v_exp_f32 v71, v71
    v_cvt_pk_bf16_f32 v97, v66, v67
    v_mfma_f32_32x32x16_bf16 a[80:95], a[136:139], v[104:107], a[80:95]
    buffer_load_dwordx4 v[32:35], v43, s[40:43], s73 offen offset:0 sc1
    v_exp_f32 v72, v72
    v_exp_f32 v73, v73
    v_cvt_pk_bf16_f32 v98, v68, v69
    v_exp_f32 v74, v74
    v_exp_f32 v75, v75
    v_cvt_pk_bf16_f32 v99, v70, v71
    v_exp_f32 v76, v76
    v_mfma_f32_32x32x16_bf16 a[80:95], a[140:143], v[108:111], a[80:95]
    buffer_load_dwordx4 v[36:39], v43, s[40:43], s73 offen offset:3584 sc1
    v_exp_f32 v77, v77
    v_cvt_pk_bf16_f32 v100, v72, v73
    v_exp_f32 v78, v78
    v_exp_f32 v79, v79
    v_cvt_pk_bf16_f32 v101, v74, v75
    v_cvt_pk_bf16_f32 v102, v76, v77
    v_cvt_pk_bf16_f32 v103, v78, v79
    v_mfma_f32_32x32x16_bf16 v[64:79], a[144:147], a[16:19], 0
    v_exp_f32 v80, v80
    v_exp_f32 v81, v81
    v_exp_f32 v82, v82
    v_exp_f32 v83, v83
    v_mfma_f32_32x32x16_bf16 v[64:79], a[148:151], a[20:23], v[64:79]
    v_exp_f32 v84, v84
    v_exp_f32 v85, v85
    v_cvt_pk_bf16_f32 v104, v80, v81
    v_exp_f32 v86, v86
    v_exp_f32 v87, v87
    v_cvt_pk_bf16_f32 v105, v82, v83
    v_mfma_f32_32x32x16_bf16 a[32:47], a[152:155], v[96:99], a[32:47]
    v_exp_f32 v88, v88
    v_exp_f32 v89, v89
    v_cvt_pk_bf16_f32 v106, v84, v85
    v_exp_f32 v90, v90
    v_exp_f32 v91, v91
    v_cvt_pk_bf16_f32 v107, v86, v87
    v_exp_f32 v92, v92
    v_mfma_f32_32x32x16_bf16 a[32:47], a[156:159], v[100:103], a[32:47]
    v_exp_f32 v93, v93
    v_cvt_pk_bf16_f32 v108, v88, v89
    v_exp_f32 v94, v94
    v_exp_f32 v95, v95
    v_cvt_pk_bf16_f32 v109, v90, v91
    v_cvt_pk_bf16_f32 v110, v92, v93
    v_cvt_pk_bf16_f32 v111, v94, v95
    v_mfma_f32_32x32x16_bf16 v[80:95], a[144:147], a[24:27], 0
    s_add_u32 s72, s72, 14336
    s_add_u32 s73, s73, 14336
    v_exp_f32 v64, v64
    v_exp_f32 v65, v65
    v_exp_f32 v66, v66
    v_exp_f32 v67, v67
    v_mfma_f32_32x32x16_bf16 v[80:95], a[148:151], a[28:31], v[80:95]
    v_exp_f32 v68, v68
    v_exp_f32 v69, v69
    v_cvt_pk_bf16_f32 v96, v64, v65
    v_exp_f32 v70, v70
    v_exp_f32 v71, v71
    v_cvt_pk_bf16_f32 v97, v66, v67
    v_mfma_f32_32x32x16_bf16 a[48:63], a[152:155], v[104:107], a[48:63]
    buffer_load_dwordx4 v[44:47], v43, s[40:43], s72 offen offset:0 sc1
    ds_write_b128 v60, a[32:35] offset:0
    ds_write_b128 v60, a[36:39] offset:1024
    v_exp_f32 v72, v72
    v_exp_f32 v73, v73
    v_cvt_pk_bf16_f32 v98, v68, v69
    v_exp_f32 v74, v74
    v_exp_f32 v75, v75
    v_cvt_pk_bf16_f32 v99, v70, v71
    v_exp_f32 v76, v76
    v_mfma_f32_32x32x16_bf16 a[48:63], a[156:159], v[108:111], a[48:63]
    buffer_load_dwordx4 v[48:51], v43, s[40:43], s72 offen offset:3584 sc1
    ds_write_b128 v60, a[40:43] offset:2048
    ds_write_b128 v60, a[44:47] offset:3072
    v_exp_f32 v77, v77
    v_cvt_pk_bf16_f32 v100, v72, v73
    v_exp_f32 v78, v78
    v_exp_f32 v79, v79
    v_cvt_pk_bf16_f32 v101, v74, v75
    v_cvt_pk_bf16_f32 v102, v76, v77
    v_cvt_pk_bf16_f32 v103, v78, v79
    v_mfma_f32_32x32x16_bf16 a[64:79], a[152:155], v[96:99], a[64:79]
    buffer_load_dwordx4 v[52:55], v43, s[40:43], s73 offen offset:0 sc1
    v_exp_f32 v80, v80
    v_exp_f32 v81, v81
    v_exp_f32 v82, v82
    v_exp_f32 v83, v83
    buffer_load_dwordx4 v[56:59], v43, s[40:43], s73 offen offset:3584 sc1
    v_exp_f32 v84, v84
    v_exp_f32 v85, v85
    v_cvt_pk_bf16_f32 v104, v80, v81
    v_exp_f32 v86, v86
    v_exp_f32 v87, v87
    v_cvt_pk_bf16_f32 v105, v82, v83
    v_mfma_f32_32x32x16_bf16 a[64:79], a[156:159], v[100:103], a[64:79]
    s_sub_u32 s72, s72, 14336
    s_sub_u32 s73, s73, 14336
    ds_write_b128 v61, a[48:51] offset:4096
    ds_write_b128 v61, a[52:55] offset:5120
    v_exp_f32 v88, v88
    v_exp_f32 v89, v89
    v_cvt_pk_bf16_f32 v106, v84, v85
    v_exp_f32 v90, v90
    v_exp_f32 v91, v91
    v_cvt_pk_bf16_f32 v107, v86, v87
    v_exp_f32 v92, v92
    ds_write_b128 v61, a[56:59] offset:6144
    ds_write_b128 v61, a[60:63] offset:7168
    v_exp_f32 v93, v93
    v_cvt_pk_bf16_f32 v108, v88, v89
    v_exp_f32 v94, v94
    v_exp_f32 v95, v95
    v_cvt_pk_bf16_f32 v109, v90, v91
    v_cvt_pk_bf16_f32 v110, v92, v93
    v_cvt_pk_bf16_f32 v111, v94, v95
    v_mfma_f32_32x32x16_bf16 a[80:95], a[152:155], v[104:107], a[80:95]
    s_nop 0
    v_mfma_f32_32x32x16_bf16 a[80:95], a[156:159], v[108:111], a[80:95]
    buffer_load_dwordx2 a[0:1], v42, s[44:47], s68 offen offset:0
    buffer_load_dwordx2 a[2:3], v42, s[44:47], s68 offen offset:16
    buffer_load_dwordx2 a[4:5], v42, s[44:47], s68 offen offset:32
    buffer_load_dwordx2 a[6:7], v42, s[44:47], s68 offen offset:48
    v_accvgpr_read_b32 v64, a44
    v_accvgpr_read_b32 v65, a60
    v_accvgpr_read_b32 v66, a76
    s_nop 4
    v_accvgpr_read_b32 v67, a92
    v_add_f32 v64, v64, v65
    v_add_f32 v66, v66, v67
    v_add_f32 v64, v64, v66
    v_mov_b32 v2, 152576
    v_mov_b32 v3, 1
    s_mov_b32 exec_lo, 0
    v_cmp_ngt_f32 vcc, 1602224128, v64
    s_nop 0
    s_mov_b64 exec, vcc
    s_cbranch_execz L_NOBAD
    ds_write_b32 v2, v3
L_NOBAD:
    s_mov_b64 exec, -1
    ds_write_b128 v62, a[64:67] offset:8192
    ds_write_b128 v62, a[68:71] offset:9216
    ds_write_b128 v62, a[72:75] offset:10240
    ds_write_b128 v62, a[76:79] offset:11264
    v_add_u32 v3, s61, v15
    s_lshl_b32 s60, s78, 4
    s_add_u32 s60, s60, s6
    s_lshl_b32 s64, s60, 11
    s_add_u32 s64, s64, 8388608
    s_lshl_b32 s60, s60, 2
    s_lshl_b32 s60, s60, 4
    s_add_u32 s60, s60, 1179648
    s_waitcnt lgkmcnt(0)
    s_barrier
    ds_read_b32 v4, v2
    ds_read_b128 v[64:67], v3 offset:0
    ds_read_b128 v[68:71], v3 offset:1024
    ds_read_b128 v[72:75], v3 offset:2048
    ds_read_b128 v[76:79], v3 offset:3072
    ds_read_b128 v[80:83], v3 offset:4096
    ds_read_b128 v[84:87], v3 offset:5120
    ds_read_b128 v[88:91], v3 offset:6144
    ds_read_b128 v[92:95], v3 offset:7168
    ds_read_b128 v[96:99], v3 offset:8192
    ds_read_b128 v[100:103], v3 offset:9216
    ds_read_b128 v[104:107], v3 offset:10240
    ds_read_b128 v[108:111], v3 offset:11264
    v_accvgpr_read_b32 v9, a80
    v_accvgpr_read_b32 v10, a81
    v_accvgpr_read_b32 v11, a82
    v_accvgpr_read_b32 v12, a83
    v_accvgpr_read_b32 v114, a84
    v_accvgpr_read_b32 v113, a85
    v_accvgpr_read_b32 v5, a86
    v_accvgpr_read_b32 v6, a87
    v_accvgpr_read_b32 v7, a88
    v_accvgpr_read_b32 v60, a89
    v_accvgpr_read_b32 v61, a90
    v_accvgpr_read_b32 v62, a91
    v_accvgpr_read_b32 v63, a92
    v_accvgpr_read_b32 v112, a93
    v_accvgpr_read_b32 v118, a94
    v_accvgpr_read_b32 v2, a95
    s_waitcnt lgkmcnt(12)
    v_readfirstlane_b32 s9, v4
    s_nop 0
    s_andn2_b32 s9, s9, s7
    s_cmp_lg_u32 s9, 0
    s_cbranch_scc1 L_RETRY
    s_waitcnt lgkmcnt(8)
    v_add_f32 v64, v64, v9
    v_add_f32 v65, v65, v10
    v_add_f32 v66, v66, v11
    v_add_f32 v67, v67, v12
    v_add_f32 v68, v68, v114
    v_add_f32 v69, v69, v113
    v_add_f32 v70, v70, v5
    v_add_f32 v71, v71, v6
    v_add_f32 v72, v72, v7
    v_add_f32 v73, v73, v60
    v_add_f32 v74, v74, v61
    v_add_f32 v75, v75, v62
    v_add_f32 v76, v76, v63
    v_add_f32 v77, v77, v112
    v_add_f32 v78, v78, v118
    v_add_f32 v79, v79, v2
    s_waitcnt lgkmcnt(4)
    v_add_f32 v64, v64, v80
    v_add_f32 v65, v65, v81
    v_add_f32 v66, v66, v82
    v_add_f32 v67, v67, v83
    v_add_f32 v68, v68, v84
    v_add_f32 v69, v69, v85
    v_add_f32 v70, v70, v86
    v_add_f32 v71, v71, v87
    v_add_f32 v72, v72, v88
    v_add_f32 v73, v73, v89
    v_add_f32 v74, v74, v90
    v_add_f32 v75, v75, v91
    v_add_f32 v76, v76, v92
    v_add_f32 v77, v77, v93
    v_add_f32 v78, v78, v94
    v_add_f32 v79, v79, v95
    s_waitcnt lgkmcnt(0)
    v_add_f32 v64, v64, v96
    v_add_f32 v65, v65, v97
    v_add_f32 v66, v66, v98
    v_add_f32 v67, v67, v99
    v_add_f32 v68, v68, v100
    v_add_f32 v69, v69, v101
    v_add_f32 v70, v70, v102
    v_add_f32 v71, v71, v103
    v_add_f32 v72, v72, v104
    v_add_f32 v73, v73, v105
    v_add_f32 v74, v74, v106
    v_add_f32 v75, v75, v107
    v_add_f32 v76, v76, v108
    v_add_f32 v77, v77, v109
    v_add_f32 v78, v78, v110
    v_add_f32 v79, v79, v111
    v_mov_b32 v80, v76
    v_mov_b32 v81, v76
    s_nop 1
    v_permlane32_swap_b32 v80, v81
    v_rcp_f32 v81, v81
    s_nop 0
    v_mul_f32 v64, v64, v81
    v_mul_f32 v65, v65, v81
    v_mul_f32 v66, v66, v81
    v_mul_f32 v67, v67, v81
    v_mul_f32 v68, v68, v81
    v_mul_f32 v69, v69, v81
    v_mul_f32 v70, v70, v81
    v_mul_f32 v71, v71, v81
    v_mul_f32 v72, v72, v81
    v_mul_f32 v73, v73, v81
    v_mul_f32 v74, v74, v81
    v_mul_f32 v75, v75, v81
    v_mul_f32 v76, v76, v81
    v_mul_f32 v77, v77, v81
    v_mul_f32 v78, v78, v81
    v_mul_f32 v79, v79, v81
    v_cvt_pk_bf16_f32 v96, v64, v65
    v_cvt_pk_bf16_f32 v97, v66, v67
    v_cvt_pk_bf16_f32 v98, v68, v69
    v_cvt_pk_bf16_f32 v99, v70, v71
    v_cvt_pk_bf16_f32 v100, v72, v73
    v_cvt_pk_bf16_f32 v101, v74, v75
    v_cvt_pk_bf16_f32 v102, v76, v77
    v_cvt_pk_bf16_f32 v103, v78, v79
    v_and_b32 v102, v102, v8
    v_and_b32 v103, v103, v8
    buffer_store_dwordx4 v[96:99], v15, s[40:43], s64 offen sc1
    buffer_store_dwordx4 v[100:103], v15, s[40:43], s64 offen offset:1024 sc1
    s_branch L_ATT_DONE
LCHK_3:
    s_mov_b32 s9, 0
L_PKSPIN:
    buffer_load_dword v20, v40, s[40:43], 0 offen sc1
    s_add_u32 s9, s9, 1
    s_cmp_gt_u32 s9, 0x8000
    s_cbranch_scc1 L_ABORT
    s_waitcnt vmcnt(0)
    v_cmp_ne_u32 vcc, s3, v20
    s_cbranch_vccnz L_PKSPIN
    s_nop 15
    s_branch LCHKD_4
L_RETRY:
    s_waitcnt vmcnt(0) lgkmcnt(0)
    s_mov_b32 s7, 1
    s_mov_b32 s66, 0
    s_add_u32 s9, s4, 1
    s_and_b32 s9, s9, 3
    s_mul_i32 s9, s9, 28672
    v_add_u32 v3, s9, v15
    ds_read_b128 a[0:3], v3 offset:24576
    ds_read_b128 a[4:7], v3 offset:25600
    s_add_u32 s9, s4, 2
    s_and_b32 s9, s9, 3
    s_mul_i32 s9, s9, 28672
    v_add_u32 v3, s9, v15
    ds_read_b128 a[8:11], v3 offset:24576
    ds_read_b128 a[12:15], v3 offset:25600
    s_add_u32 s9, s4, 3
    s_and_b32 s9, s9, 3
    s_mul_i32 s9, s9, 28672
    v_add_u32 v3, s9, v15
    ds_read_b128 a[16:19], v3 offset:24576
    ds_read_b128 a[20:23], v3 offset:25600
    s_add_u32 s9, s4, 4
    s_and_b32 s9, s9, 3
    s_mul_i32 s9, s9, 28672
    v_add_u32 v3, s9, v15
    ds_read_b128 a[24:27], v3 offset:24576
    ds_read_b128 a[28:31], v3 offset:25600
    v_mov_b32 v96, 0xff800000
    v_mov_b32 v97, 0xff800000
    v_mov_b32 v98, 0xff800000
    v_mov_b32 v99, 0xff800000
L_RMAX:
    s_lshl_b32 s64, s66, 14
    s_add_u32 s64, s64, s70
    buffer_load_dwordx4 a[96:99], v15, s[40:43], s64 offen sc1
    buffer_load_dwordx4 a[100:103], v15, s[40:43], s64 offen offset:1024 sc1
    s_add_u32 s66, s66, 1
    s_waitcnt vmcnt(0) lgkmcnt(0)
    v_mfma_f32_32x32x16_bf16 v[64:79], a[96:99], a[0:3], 0
    v_mfma_f32_32x32x16_bf16 v[64:79], a[100:103], a[4:7], v[64:79]
    s_nop 11
    v_max3_f32 v96, v96, v64, v65
    v_max3_f32 v96, v96, v66, v67
    v_max3_f32 v96, v96, v68, v69
    v_max3_f32 v96, v96, v70, v71
    v_max3_f32 v96, v96, v72, v73
    v_max3_f32 v96, v96, v74, v75
    v_max3_f32 v96, v96, v76, v77
    v_max3_f32 v96, v96, v78, v79
    v_mfma_f32_32x32x16_bf16 v[64:79], a[96:99], a[8:11], 0
    v_mfma_f32_32x32x16_bf16 v[64:79], a[100:103], a[12:15], v[64:79]
    s_nop 11
    v_max3_f32 v97, v97, v64, v65
    v_max3_f32 v97, v97, v66, v67
    v_max3_f32 v97, v97, v68, v69
    v_max3_f32 v97, v97, v70, v71
    v_max3_f32 v97, v97, v72, v73
    v_max3_f32 v97, v97, v74, v75
    v_max3_f32 v97, v97, v76, v77
    v_max3_f32 v97, v97, v78, v79
    v_mfma_f32_32x32x16_bf16 v[64:79], a[96:99], a[16:19], 0
    v_mfma_f32_32x32x16_bf16 v[64:79], a[100:103], a[20:23], v[64:79]
    s_nop 11
    v_max3_f32 v98, v98, v64, v65
    v_max3_f32 v98, v98, v66, v67
    v_max3_f32 v98, v98, v68, v69
    v_max3_f32 v98, v98, v70, v71
    v_max3_f32 v98, v98, v72, v73
    v_max3_f32 v98, v98, v74, v75
    v_max3_f32 v98, v98, v76, v77
    v_max3_f32 v98, v98, v78, v79
    v_mfma_f32_32x32x16_bf16 v[64:79], a[96:99], a[24:27], 0
    v_mfma_f32_32x32x16_bf16 v[64:79], a[100:103], a[28:31], v[64:79]
    s_nop 11
    v_max3_f32 v99, v99, v64, v65
    v_max3_f32 v99, v99, v66, v67
    v_max3_f32 v99, v99, v68, v69
    v_max3_f32 v99, v99, v70, v71
    v_max3_f32 v99, v99, v72, v73
    v_max3_f32 v99, v99, v74, v75
    v_max3_f32 v99, v99, v76, v77
    v_max3_f32 v99, v99, v78, v79
    s_cmp_lt_u32 s66, 16
    s_cbranch_scc1 L_RMAX
    s_barrier
    s_add_u32 s9, s4, 1
    s_and_b32 s9, s9, 3
    s_lshl_b32 s9, s9, 10
    s_lshl_b32 s10, s4, 8
    s_add_u32 s9, s9, s10
    v_add_u32 v3, s9, v16
    ds_write_b32 v3, v96 offset:14336
    s_add_u32 s9, s4, 2
    s_and_b32 s9, s9, 3
    s_lshl_b32 s9, s9, 10
    s_lshl_b32 s10, s4, 8
    s_add_u32 s9, s9, s10
    v_add_u32 v3, s9, v16
    ds_write_b32 v3, v97 offset:14336
    s_add_u32 s9, s4, 3
    s_and_b32 s9, s9, 3
    s_lshl_b32 s9, s9, 10
    s_lshl_b32 s10, s4, 8
    s_add_u32 s9, s9, s10
    v_add_u32 v3, s9, v16
    ds_write_b32 v3, v98 offset:14336
    s_add_u32 s9, s4, 4
    s_and_b32 s9, s9, 3
    s_lshl_b32 s9, s9, 10
    s_lshl_b32 s10, s4, 8
    s_add_u32 s9, s9, s10
    v_add_u32 v3, s9, v16
    ds_write_b32 v3, v99 offset:14336
    s_lshl_b32 s9, s4, 10
    v_add_u32 v3, s9, v16
    s_waitcnt lgkmcnt(0)
    s_barrier
    ds_read_b32 v96, v3 offset:14336
    ds_read_b32 v97, v3 offset:14592
    ds_read_b32 v98, v3 offset:14848
    ds_read_b32 v99, v3 offset:15104
    s_waitcnt lgkmcnt(0)
    v_max3_f32 v96, v96, v97, v98
    v_max_f32 v96, v96, v99
    v_mov_b32 v97, v96
    s_nop 1
    v_permlane32_swap_b32 v96, v97
    v_max_f32 v96, v96, v97
    v_add_f32 v119, v119, v96
    v_sub_f32 v113, 0, v119
    v_cvt_pk_bf16_f32 v114, v113, v113
    v_and_b32 v114, s56, v114
    v_sub_f32 v113, v113, v114
    v_cvt_pk_bf16_f32 v115, v113, v113
    v_and_b32 v115, s56, v115
    v_sub_f32 v113, v113, v115
    v_cvt_pk_bf16_f32 v116, v114, v115
    v_cvt_pk_bf16_f32 v117, v113, 0
    v_bfi_b32 v126, v8, v126, v116
    v_bfi_b32 v127, v8, v127, v117
    v_add_u32 v2, s61, v15
    ds_write_b128 v2, v[120:123] offset:24576
    ds_write_b128 v2, v[124:127] offset:25600
    s_lshl_b32 s60, s6, 8
    s_lshl_b32 s9, s4, 2
    s_add_u32 s60, s60, s9
    s_lshl_b32 s60, s60, 4
    s_add_u32 s60, s60, 1048576
    buffer_load_dwordx4 a[96:99], v13, s[40:43], s84 offen sc1
    buffer_load_dwordx4 a[100:103], v13, s[40:43], s84 offen offset:1024 sc1
    buffer_load_dwordx4 a[104:107], v13, s[40:43], s84 offen offset:2048 sc1
    buffer_load_dwordx4 a[108:111], v13, s[40:43], s84 offen offset:3072 sc1
    s_waitcnt vmcnt(0) lgkmcnt(0)
    s_barrier
    s_branch L_ATT_START
L_ATT_DONE:
    s_mov_b32 s6, s71
    s_waitcnt vmcnt(2)
    s_mov_b32 s9, 0
    s_branch L_MP2C
L_MP2:
    s_mov_b32 s10, 342016
    buffer_load_dwordx4 v[24:27], v43, s[40:43], s10 offen sc1
    s_mov_b32 s10, 345600
    buffer_load_dwordx4 v[28:31], v43, s[40:43], s10 offen sc1
    s_mov_b32 s10, 349184
    buffer_load_dwordx4 v[32:35], v43, s[40:43], s10 offen sc1
    s_mov_b32 s10, 352768
    buffer_load_dwordx4 v[36:39], v43, s[40:43], s10 offen sc1
    s_mov_b32 s10, 356352
    buffer_load_dwordx4 v[44:47], v43, s[40:43], s10 offen sc1
    s_mov_b32 s10, 359936
    buffer_load_dwordx4 v[48:51], v43, s[40:43], s10 offen sc1
    s_mov_b32 s10, 363520
    buffer_load_dwordx4 v[52:55], v43, s[40:43], s10 offen sc1
    s_mov_b32 s10, 367104
    buffer_load_dwordx4 v[56:59], v43, s[40:43], s10 offen sc1
    s_add_u32 s9, s9, 1
    s_cmp_gt_u32 s9, 0x8000
    s_cbranch_scc1 L_ABORT
    s_waitcnt vmcnt(0)
L_MP2C:
    v_xor_b32 v27, s3, v27
    v_xor_b32 v31, s3, v31
    v_xor_b32 v35, s3, v35
    v_xor_b32 v39, s3, v39
    v_xor_b32 v47, s3, v47
    v_xor_b32 v51, s3, v51
    v_xor_b32 v55, s3, v55
    v_xor_b32 v59, s3, v59
    v_or3_b32 v27, v27, v31, v35
    v_or3_b32 v39, v39, v47, v51
    v_or3_b32 v55, v55, v59, v27
    v_or_b32 v55, v55, v39
    v_cmp_ne_u32 vcc, 0, v55
    s_cbranch_vccz L_MP2D
    s_waitcnt vmcnt(0)
    s_mov_b64 exec, 1
    buffer_store_dword v22, v21, s[40:43], s60 offen sc1
    s_mov_b64 exec, -1
    s_branch L_MP2
L_MP2D:
    v_cmp_gt_u32 vcc, 112, v0
    s_nop 1
    v_cndmask_b32_e64 v20, 0, 1.0, vcc
    v_perm_b32 v27, v25, v24, s76
    v_perm_b32 v27, v26, v27, s77
    v_perm_b32 v31, v29, v28, s76
    v_perm_b32 v31, v30, v31, s77
    v_perm_b32 v35, v33, v32, s76
    v_perm_b32 v35, v34, v35, s77
    v_perm_b32 v39, v37, v36, s76
    v_perm_b32 v39, v38, v39, s77
    v_add_f32 v24, v24, v28
    v_add_f32 v32, v32, v36
    v_add_f32 v25, v25, v29
    v_add_f32 v33, v33, v37
    v_add_f32 v26, v26, v30
    v_add_f32 v34, v34, v38
    v_add_f32 v27, v27, v31
    v_add_f32 v35, v35, v39
    v_add_f32 v24, v24, v32
    v_add_f32 v25, v25, v33
    v_add_f32 v26, v26, v34
    v_add_f32 v27, v27, v35
    v_cvt_pk_bf16_f32 v24, v24, v25
    v_cvt_pk_bf16_f32 v25, v26, v27
    v_lshlrev_b32 v64, 16, v24
    v_and_b32 v65, s56, v24
    v_lshlrev_b32 v66, 16, v25
    v_and_b32 v67, s56, v25
    v_add_f32 v64, v64, 0
    v_add_f32 v65, v65, 0
    v_add_f32 v66, v66, 0
    v_add_f32 v67, v67, 0
    v_cvt_pk_bf16_f32 v24, v64, v65
    v_cvt_pk_bf16_f32 v25, v66, v67
    v_lshlrev_b32 v64, 16, v24
    v_and_b32 v65, s56, v24
    v_lshlrev_b32 v66, 16, v25
    v_and_b32 v67, s56, v25
    v_perm_b32 v47, v45, v44, s76
    v_perm_b32 v47, v46, v47, s77
    v_perm_b32 v51, v49, v48, s76
    v_perm_b32 v51, v50, v51, s77
    v_perm_b32 v55, v53, v52, s76
    v_perm_b32 v55, v54, v55, s77
    v_perm_b32 v59, v57, v56, s76
    v_perm_b32 v59, v58, v59, s77
    v_add_f32 v44, v44, v48
    v_add_f32 v52, v52, v56
    v_add_f32 v45, v45, v49
    v_add_f32 v53, v53, v57
    v_add_f32 v46, v46, v50
    v_add_f32 v54, v54, v58
    v_add_f32 v47, v47, v51
    v_add_f32 v55, v55, v59
    v_add_f32 v44, v44, v52
    v_add_f32 v45, v45, v53
    v_add_f32 v46, v46, v54
    v_add_f32 v47, v47, v55
    v_cvt_pk_bf16_f32 v44, v44, v45
    v_cvt_pk_bf16_f32 v45, v46, v47
    v_lshlrev_b32 v68, 16, v44
    v_and_b32 v69, s56, v44
    v_lshlrev_b32 v70, 16, v45
    v_and_b32 v71, s56, v45
    v_add_f32 v68, v68, v20
    v_add_f32 v69, v69, v20
    v_add_f32 v70, v70, v20
    v_add_f32 v71, v71, v20
    v_cvt_pk_bf16_f32 v44, v68, v69
    v_cvt_pk_bf16_f32 v45, v70, v71
    v_lshlrev_b32 v68, 16, v44
    v_and_b32 v69, s56, v44
    v_lshlrev_b32 v70, 16, v45
    v_and_b32 v71, s56, v45
    s_waitcnt vmcnt(0)
    s_mov_b64 exec, 1
    buffer_store_dword v22, v21, s[40:43], s60 offen sc1
    s_mov_b64 exec, -1
    v_add_u32 v2, 156672, v43
    ds_write_b128 v2, v[64:67]
    ds_write_b128 v2, v[68:71] offset:3584
    v_lshrrev_b32 v3, 1, v43
    v_add_u32 v3, 25728, v3
    v_cndmask_b32 v24, v24, v44, vcc
    v_cndmask_b32 v25, v25, v45, vcc
    v_add_u32 v4, 1792, v3
    v_cndmask_b32 v3, v3, v4, vcc
    ds_write_b64 v3, v[24:25]
    s_cmp_lt_u32 s6, 14
    s_cbranch_scc1 L_WO
    v_and_b32 v5, 1, v1
    v_xor_b32 v5, 1, v5
    v_mul_u32_u24 v5, 896, v5
    v_lshrrev_b32 v6, 5, v1
    v_lshl_add_u32 v5, v6, 3, v5
    v_add_u32 v5, 26624, v5
    s_lshl_b32 s60, s15, 10
    s_add_u32 s60, s60, 1835008
    s_lshl_b32 s62, s15, 6
    s_add_u32 s62, s62, 1703936
    s_waitcnt lgkmcnt(0)
    s_barrier
    ds_read_b64 a[16:17], v5 offset:0
    ds_read_b64 a[18:19], v5 offset:16
    ds_read_b64 a[20:21], v5 offset:32
    ds_read_b64 a[22:23], v5 offset:48
    ds_read_b64 a[24:25], v5 offset:64
    ds_read_b64 a[26:27], v5 offset:80
    ds_read_b64 a[28:29], v5 offset:96
    ds_read_b64 a[30:31], v5 offset:112
    ds_read_b64 a[32:33], v5 offset:128
    ds_read_b64 a[34:35], v5 offset:144
    ds_read_b64 a[36:37], v5 offset:160
    ds_read_b64 a[38:39], v5 offset:176
    ds_read_b64 a[40:41], v5 offset:192
    ds_read_b64 a[42:43], v5 offset:208
    ds_read_b64 a[44:45], v5 offset:224
    ds_read_b64 a[46:47], v5 offset:240
    ds_read_b64 a[48:49], v5 offset:256
    ds_read_b64 a[50:51], v5 offset:272
    ds_read_b64 a[52:53], v5 offset:288
    ds_read_b64 a[54:55], v5 offset:304
    ds_read_b64 a[56:57], v5 offset:320
    ds_read_b64 a[58:59], v5 offset:336
    ds_read_b64 a[60:61], v5 offset:352
    ds_read_b64 a[62:63], v5 offset:368
    ds_read_b64 a[64:65], v5 offset:384
    ds_read_b64 a[66:67], v5 offset:400
    ds_read_b64 a[68:69], v5 offset:416
    ds_read_b64 a[70:71], v5 offset:432
    ds_read_b64 a[72:73], v5 offset:448
    ds_read_b64 a[74:75], v5 offset:464
    ds_read_b64 a[76:77], v5 offset:480
    ds_read_b64 a[78:79], v5 offset:496
    ds_read_b64 a[80:81], v5 offset:512
    ds_read_b64 a[82:83], v5 offset:528
    ds_read_b64 a[84:85], v5 offset:544
    ds_read_b64 a[86:87], v5 offset:560
    ds_read_b64 a[88:89], v5 offset:576
    ds_read_b64 a[90:91], v5 offset:592
    ds_read_b64 a[92:93], v5 offset:608
    ds_read_b64 a[94:95], v5 offset:624
    ds_read_b64 a[96:97], v5 offset:640
    ds_read_b64 a[98:99], v5 offset:656
    ds_read_b64 a[100:101], v5 offset:672
    ds_read_b64 a[102:103], v5 offset:688
    ds_read_b64 a[104:105], v5 offset:704
    ds_read_b64 a[106:107], v5 offset:720
    ds_read_b64 a[108:109], v5 offset:736
    ds_read_b64 a[110:111], v5 offset:752
    ds_read_b64 a[112:113], v5 offset:768
    ds_read_b64 a[114:115], v5 offset:784
    ds_read_b64 a[116:117], v5 offset:800
    ds_read_b64 a[118:119], v5 offset:816
    ds_read_b64 a[120:121], v5 offset:832
    ds_read_b64 a[122:123], v5 offset:848
    ds_read_b64 a[124:125], v5 offset:864
    ds_read_b64 a[126:127], v5 offset:880
    s_waitcnt lgkmcnt(15)
    v_mfma_f32_32x32x16_bf16 v[64:79], a[16:19], a[160:163], 0
    v_mfma_f32_32x32x16_bf16 v[64:79], a[20:23], a[168:171], v[64:79]
    v_mfma_f32_32x32x16_bf16 v[64:79], a[24:27], a[176:179], v[64:79]
    v_mfma_f32_32x32x16_bf16 v[64:79], a[28:31], a[184:187], v[64:79]
    s_waitcnt lgkmcnt(15)
    v_mfma_f32_32x32x16_bf16 v[64:79], a[32:35], a[192:195], v[64:79]
    v_mfma_f32_32x32x16_bf16 v[64:79], a[36:39], a[200:203], v[64:79]
    v_mfma_f32_32x32x16_bf16 v[64:79], a[40:43], a[208:211], v[64:79]
    v_mfma_f32_32x32x16_bf16 v[64:79], a[44:47], a[216:219], v[64:79]
    s_waitcnt lgkmcnt(15)
    v_mfma_f32_32x32x16_bf16 v[64:79], a[48:51], a[224:227], v[64:79]
    v_mfma_f32_32x32x16_bf16 v[64:79], a[52:55], a[232:235], v[64:79]
    v_mfma_f32_32x32x16_bf16 v[64:79], a[56:59], a[240:243], v[64:79]
    v_mfma_f32_32x32x16_bf16 v[64:79], a[60:63], a[248:251], v[64:79]
    s_waitcnt lgkmcnt(15)
    v_mfma_f32_32x32x16_bf16 v[64:79], a[64:67], v[128:131], v[64:79]
    v_mfma_f32_32x32x16_bf16 v[64:79], a[68:71], v[136:139], v[64:79]
    v_mfma_f32_32x32x16_bf16 v[64:79], a[72:75], v[144:147], v[64:79]
    v_mfma_f32_32x32x16_bf16 v[64:79], a[76:79], v[152:155], v[64:79]
    s_waitcnt lgkmcnt(15)
    v_mfma_f32_32x32x16_bf16 v[64:79], a[80:83], v[160:163], v[64:79]
    v_mfma_f32_32x32x16_bf16 v[64:79], a[84:87], v[168:171], v[64:79]
    v_mfma_f32_32x32x16_bf16 v[64:79], a[88:91], v[176:179], v[64:79]
    v_mfma_f32_32x32x16_bf16 v[64:79], a[92:95], v[184:187], v[64:79]
    s_waitcnt lgkmcnt(8)
    v_mfma_f32_32x32x16_bf16 v[64:79], a[96:99], v[192:195], v[64:79]
    v_mfma_f32_32x32x16_bf16 v[64:79], a[100:103], v[200:203], v[64:79]
    v_mfma_f32_32x32x16_bf16 v[64:79], a[104:107], v[208:211], v[64:79]
    v_mfma_f32_32x32x16_bf16 v[64:79], a[108:111], v[216:219], v[64:79]
    s_waitcnt lgkmcnt(0)
    v_mfma_f32_32x32x16_bf16 v[64:79], a[112:115], v[224:227], v[64:79]
    v_mfma_f32_32x32x16_bf16 v[64:79], a[116:119], v[232:235], v[64:79]
    v_mfma_f32_32x32x16_bf16 v[64:79], a[120:123], v[240:243], v[64:79]
    v_mfma_f32_32x32x16_bf16 v[64:79], a[124:127], v[248:251], v[64:79]
    s_nop 11
    v_cvt_pk_bf16_f32 v56, v64, v64
    v_cvt_pk_bf16_f32 v58, v65, v65
    v_and_b32 v66, s56, v56
    v_and_b32 v67, s56, v58
    v_sub_f32 v66, v64, v66
    v_sub_f32 v67, v65, v67
    v_cvt_pk_bf16_f32 v57, v66, v65
    v_cvt_pk_bf16_f32 v58, v65, v67
    v_mov_b32 v59, 0
    v_and_b32 v56, v56, v8
    v_and_b32 v57, v57, v8
    v_and_b32 v58, v58, v8
    buffer_store_dwordx4 v[56:59], v15, s[40:43], s60 offen sc1
    s_waitcnt vmcnt(0)
    s_mov_b64 exec, 1
    buffer_store_dword v22, v21, s[40:43], s62 offen sc1
    s_mov_b64 exec, -1
    s_branch L_END
L_WO:
    v_lshrrev_b32 v3, 5, v1
    v_bfe_u32 v4, v1, 2, 2
    v_lshl_add_u32 v4, v3, 2, v4
    v_lshlrev_b32 v36, 6, v4
    v_bfe_u32 v5, v1, 4, 1
    v_lshl_add_u32 v36, v5, 5, v36
    v_and_b32 v6, 3, v1
    v_lshl_add_u32 v36, v6, 3, v36
    v_add_u32 v36, 118784, v36
    s_lshl_b32 s9, s6, 7
    s_add_u32 s9, s9, 153088
    v_lshl_add_u32 v37, v3, 4, s9
    s_lshl_b32 s60, s78, 6
    s_lshl_b32 s60, s60, 4
    s_add_u32 s60, s60, 1179648
    s_waitcnt lgkmcnt(0)
    s_barrier
    s_add_u32 s9, s90, 0
    s_and_b32 s9, s9, 7
    s_mul_i32 s9, s9, 3584
    v_add_u32 v64, s9, v36
    ds_read_b64_tr_b16 a[16:17], v64 offset:0
    ds_read_b64_tr_b16 a[18:19], v64 offset:512
    ds_read_b64_tr_b16 a[20:21], v64 offset:1024
    ds_read_b64_tr_b16 a[22:23], v64 offset:1536
    ds_read_b64_tr_b16 a[24:25], v64 offset:1792
    ds_read_b64_tr_b16 a[26:27], v64 offset:2304
    ds_read_b64_tr_b16 a[28:29], v64 offset:2816
    ds_read_b64_tr_b16 a[30:31], v64 offset:3328
    s_add_u32 s9, s90, 1
    s_and_b32 s9, s9, 7
    s_mul_i32 s9, s9, 3584
    v_add_u32 v65, s9, v36
    ds_read_b64_tr_b16 a[32:33], v65 offset:0
    ds_read_b64_tr_b16 a[34:35], v65 offset:512
    ds_read_b64_tr_b16 a[36:37], v65 offset:1024
    ds_read_b64_tr_b16 a[38:39], v65 offset:1536
    ds_read_b64_tr_b16 a[40:41], v65 offset:1792
    ds_read_b64_tr_b16 a[42:43], v65 offset:2304
    ds_read_b64_tr_b16 a[44:45], v65 offset:2816
    ds_read_b64_tr_b16 a[46:47], v65 offset:3328
    s_add_u32 s9, s90, 2
    s_and_b32 s9, s9, 7
    s_mul_i32 s9, s9, 3584
    v_add_u32 v66, s9, v36
    ds_read_b64_tr_b16 a[48:49], v66 offset:0
    ds_read_b64_tr_b16 a[50:51], v66 offset:512
    ds_read_b64_tr_b16 a[52:53], v66 offset:1024
    ds_read_b64_tr_b16 a[54:55], v66 offset:1536
    ds_read_b64_tr_b16 a[56:57], v66 offset:1792
    ds_read_b64_tr_b16 a[58:59], v66 offset:2304
    ds_read_b64_tr_b16 a[60:61], v66 offset:2816
    ds_read_b64_tr_b16 a[62:63], v66 offset:3328
    s_add_u32 s9, s90, 3
    s_and_b32 s9, s9, 7
    s_mul_i32 s9, s9, 3584
    v_add_u32 v67, s9, v36
    ds_read_b64_tr_b16 a[64:65], v67 offset:0
    ds_read_b64_tr_b16 a[66:67], v67 offset:512
    ds_read_b64_tr_b16 a[68:69], v67 offset:1024
    ds_read_b64_tr_b16 a[70:71], v67 offset:1536
    ds_read_b64_tr_b16 a[72:73], v67 offset:1792
    ds_read_b64_tr_b16 a[74:75], v67 offset:2304
    ds_read_b64_tr_b16 a[76:77], v67 offset:2816
    ds_read_b64_tr_b16 a[78:79], v67 offset:3328
    s_add_u32 s9, s90, 4
    s_and_b32 s9, s9, 7
    s_mul_i32 s9, s9, 3584
    v_add_u32 v68, s9, v36
    ds_read_b64_tr_b16 a[80:81], v68 offset:0
    ds_read_b64_tr_b16 a[82:83], v68 offset:512
    ds_read_b64_tr_b16 a[84:85], v68 offset:1024
    ds_read_b64_tr_b16 a[86:87], v68 offset:1536
    ds_read_b64_tr_b16 a[88:89], v68 offset:1792
    ds_read_b64_tr_b16 a[90:91], v68 offset:2304
    ds_read_b64_tr_b16 a[92:93], v68 offset:2816
    ds_read_b64_tr_b16 a[94:95], v68 offset:3328
    s_add_u32 s9, s90, 5
    s_and_b32 s9, s9, 7
    s_mul_i32 s9, s9, 3584
    v_add_u32 v69, s9, v36
    ds_read_b64_tr_b16 a[96:97], v69 offset:0
    ds_read_b64_tr_b16 a[98:99], v69 offset:512
    ds_read_b64_tr_b16 a[100:101], v69 offset:1024
    ds_read_b64_tr_b16 a[102:103], v69 offset:1536
    ds_read_b64_tr_b16 a[104:105], v69 offset:1792
    ds_read_b64_tr_b16 a[106:107], v69 offset:2304
    ds_read_b64_tr_b16 a[108:109], v69 offset:2816
    ds_read_b64_tr_b16 a[110:111], v69 offset:3328
    s_add_u32 s9, s90, 6
    s_and_b32 s9, s9, 7
    s_mul_i32 s9, s9, 3584
    v_add_u32 v70, s9, v36
    ds_read_b64_tr_b16 a[112:113], v70 offset:0
    ds_read_b64_tr_b16 a[114:115], v70 offset:512
    ds_read_b64_tr_b16 a[116:117], v70 offset:1024
    ds_read_b64_tr_b16 a[118:119], v70 offset:1536
    ds_read_b64_tr_b16 a[120:121], v70 offset:1792
    ds_read_b64_tr_b16 a[122:123], v70 offset:2304
    ds_read_b64_tr_b16 a[124:125], v70 offset:2816
    ds_read_b64_tr_b16 a[126:127], v70 offset:3328
    s_add_u32 s9, s90, 7
    s_and_b32 s9, s9, 7
    s_mul_i32 s9, s9, 3584
    v_add_u32 v71, s9, v36
    ds_read_b64_tr_b16 a[128:129], v71 offset:0
    ds_read_b64_tr_b16 a[130:131], v71 offset:512
    ds_read_b64_tr_b16 a[132:133], v71 offset:1024
    ds_read_b64_tr_b16 a[134:135], v71 offset:1536
    ds_read_b64_tr_b16 a[136:137], v71 offset:1792
    ds_read_b64_tr_b16 a[138:139], v71 offset:2304
    ds_read_b64_tr_b16 a[140:141], v71 offset:2816
    ds_read_b64_tr_b16 a[142:143], v71 offset:3328
    ds_read_b128 v[40:43], v37 offset:3584
    ds_read_b128 v[112:115], v37 offset:7168
    ds_read_b128 v[44:47], v37 offset:3616
    ds_read_b128 v[116:119], v37 offset:7200
    ds_read_b128 v[48:51], v37 offset:3648
    ds_read_b128 v[120:123], v37 offset:7232
    ds_read_b128 v[52:55], v37 offset:3680
    ds_read_b128 v[124:127], v37 offset:7264
    v_accvgpr_read_b32 v56, a0
    v_accvgpr_read_b32 v57, a1
    v_accvgpr_read_b32 v58, a2
    v_accvgpr_read_b32 v59, a3
    v_accvgpr_read_b32 v60, a4
    v_accvgpr_read_b32 v61, a5
    v_accvgpr_read_b32 v62, a6
    v_accvgpr_read_b32 v63, a7
    v_lshlrev_b32 v24, 16, v56
    v_and_b32 v25, s56, v56
    v_lshlrev_b32 v26, 16, v57
    v_and_b32 v27, s56, v57
    v_lshlrev_b32 v28, 16, v58
    v_and_b32 v29, s56, v58
    v_lshlrev_b32 v30, 16, v59
    v_and_b32 v31, s56, v59
    v_lshlrev_b32 v32, 16, v60
    v_and_b32 v33, s56, v60
    v_lshlrev_b32 v34, 16, v61
    v_and_b32 v35, s56, v61
    v_lshlrev_b32 v36, 16, v62
    v_and_b32 v37, s56, v62
    v_lshlrev_b32 v38, 16, v63
    v_and_b32 v39, s56, v63
    s_lshl_b32 s62, s78, 15
    s_add_u32 s62, s62, 8388608
    s_lshl_b32 s9, s90, 12
    v_add_u32 v56, s9, v15
    v_add_u32 v57, 4096, v56
    v_subrev_u32 v2, 32768, v57
    v_min_u32 v57, v57, v2
    v_add_u32 v58, 4096, v57
    v_subrev_u32 v2, 32768, v58
    v_min_u32 v58, v58, v2
    v_add_u32 v59, 4096, v58
    v_subrev_u32 v2, 32768, v59
    v_min_u32 v59, v59, v2
    v_add_u32 v60, 4096, v59
    v_subrev_u32 v2, 32768, v60
    v_min_u32 v60, v60, v2
    v_add_u32 v61, 4096, v60
    v_subrev_u32 v2, 32768, v61
    v_min_u32 v61, v61, v2
    v_add_u32 v62, 4096, v61
    v_subrev_u32 v2, 32768, v62
    v_min_u32 v62, v62, v2
    v_add_u32 v63, 4096, v62
    v_subrev_u32 v2, 32768, v63
    v_min_u32 v63, v63, v2
    s_lshl_b32 s9, s91, 12
    v_add_u32 v14, s9, v15
    v_add_u32 v17, 4096, v14
    v_subrev_u32 v2, 28672, v17
    v_min_u32 v17, v17, v2
    v_add_u32 v18, 4096, v17
    v_subrev_u32 v2, 28672, v18
    v_min_u32 v18, v18, v2
    v_add_u32 v19, 4096, v18
    v_subrev_u32 v2, 28672, v19
    v_min_u32 v19, v19, v2
    v_add_u32 v20, 4096, v19
    v_subrev_u32 v2, 28672, v20
    v_min_u32 v20, v20, v2
    v_add_u32 v3, 4096, v20
    v_subrev_u32 v2, 28672, v3
    v_min_u32 v3, v3, v2
    v_add_u32 v4, 4096, v3
    v_subrev_u32 v2, 28672, v4
    v_min_u32 v4, v4, v2
    v_lshlrev_b32 v13, 6, v1
    s_mov_b64 exec, 0xffff
    s_mov_b32 s9, 0
LP_5:
    buffer_load_dword v2, v13, s[40:43], s60 offen sc1
    s_add_u32 s9, s9, 1
    s_cmp_gt_u32 s9, 0x4000
    s_cbranch_scc1 L_ABORT
    s_waitcnt vmcnt(0)
    v_cmp_ne_u32 vcc, s3, v2
    s_cbranch_vccz LD_6
    s_sleep 4
    s_branch LP_5
LD_6:
    s_mov_b64 exec, -1
    buffer_load_dwordx4 v[64:67], v56, s[40:43], s62 offen offset:0 sc1
    buffer_load_dwordx4 v[68:71], v56, s[40:43], s62 offen offset:1024 sc1
    buffer_load_dwordx4 v[72:75], v56, s[40:43], s62 offen offset:2048 sc1
    buffer_load_dwordx4 v[76:79], v56, s[40:43], s62 offen offset:3072 sc1
    buffer_load_dwordx4 v[80:83], v57, s[40:43], s62 offen offset:0 sc1
    buffer_load_dwordx4 v[84:87], v57, s[40:43], s62 offen offset:1024 sc1
    buffer_load_dwordx4 v[88:91], v57, s[40:43], s62 offen offset:2048 sc1
    buffer_load_dwordx4 v[92:95], v57, s[40:43], s62 offen offset:3072 sc1
    buffer_load_dwordx4 a[144:147], v58, s[40:43], s62 offen offset:0 sc1
    buffer_load_dwordx4 a[148:151], v58, s[40:43], s62 offen offset:1024 sc1
    buffer_load_dwordx4 a[152:155], v58, s[40:43], s62 offen offset:2048 sc1
    buffer_load_dwordx4 a[156:159], v58, s[40:43], s62 offen offset:3072 sc1
    buffer_load_dwordx4 a[0:3], v59, s[40:43], s62 offen offset:0 sc1
    buffer_load_dwordx4 a[4:7], v59, s[40:43], s62 offen offset:1024 sc1
    buffer_load_dwordx4 a[8:11], v59, s[40:43], s62 offen offset:2048 sc1
    buffer_load_dwordx4 a[12:15], v59, s[40:43], s62 offen offset:3072 sc1
    s_mul_i32 s60, s78, 28
    s_lshl_b32 s9, s6, 1
    s_add_u32 s60, s60, s9
    s_lshl_b32 s60, s60, 10
    s_add_u32 s64, s60, 12582912
    s_add_u32 s60, s60, 10485760
    s_mul_i32 s66, s78, 14
    s_add_u32 s66, s66, s6
    s_lshl_b32 s66, s66, 8
    s_add_u32 s66, s66, 73728
    s_lshl_b32 s67, s78, 4
    s_add_u32 s67, s67, s6
    s_lshl_b32 s67, s67, 2
    s_lshl_b32 s67, s67, 4
    s_add_u32 s67, s67, 1310720
    v_lshlrev_b32 v7, 3, v1
    s_waitcnt lgkmcnt(0)
    s_waitcnt vmcnt(15)
    v_mfma_f32_32x32x16_bf16 v[96:111], a[16:19], v[64:67], 0
    buffer_load_dwordx4 v[64:67], v60, s[40:43], s62 offen offset:0 sc1
    s_waitcnt vmcnt(15)
    v_mfma_f32_32x32x16_bf16 v[96:111], a[20:23], v[68:71], v[96:111]
    buffer_load_dwordx4 v[68:71], v60, s[40:43], s62 offen offset:1024 sc1
    s_waitcnt vmcnt(15)
    v_mfma_f32_32x32x16_bf16 v[96:111], a[24:27], v[72:75], v[96:111]
    buffer_load_dwordx4 v[72:75], v60, s[40:43], s62 offen offset:2048 sc1
    s_waitcnt vmcnt(15)
    v_mfma_f32_32x32x16_bf16 v[96:111], a[28:31], v[76:79], v[96:111]
    buffer_load_dwordx4 v[76:79], v60, s[40:43], s62 offen offset:3072 sc1
    s_waitcnt vmcnt(15)
    v_mfma_f32_32x32x16_bf16 v[96:111], a[32:35], v[80:83], v[96:111]
    buffer_load_dwordx4 v[80:83], v61, s[40:43], s62 offen offset:0 sc1
    s_waitcnt vmcnt(15)
    v_mfma_f32_32x32x16_bf16 v[96:111], a[36:39], v[84:87], v[96:111]
    buffer_load_dwordx4 v[84:87], v61, s[40:43], s62 offen offset:1024 sc1
    s_waitcnt vmcnt(15)
    v_mfma_f32_32x32x16_bf16 v[96:111], a[40:43], v[88:91], v[96:111]
    buffer_load_dwordx4 v[88:91], v61, s[40:43], s62 offen offset:2048 sc1
    s_waitcnt vmcnt(15)
    v_mfma_f32_32x32x16_bf16 v[96:111], a[44:47], v[92:95], v[96:111]
    buffer_load_dwordx4 v[92:95], v61, s[40:43], s62 offen offset:3072 sc1
    s_waitcnt vmcnt(15)
    v_mfma_f32_32x32x16_bf16 v[96:111], a[48:51], a[144:147], v[96:111]
    buffer_load_dwordx4 a[144:147], v62, s[40:43], s62 offen offset:0 sc1
    s_waitcnt vmcnt(15)
    v_mfma_f32_32x32x16_bf16 v[96:111], a[52:55], a[148:151], v[96:111]
    buffer_load_dwordx4 a[148:151], v62, s[40:43], s62 offen offset:1024 sc1
    s_waitcnt vmcnt(15)
    v_mfma_f32_32x32x16_bf16 v[96:111], a[56:59], a[152:155], v[96:111]
    buffer_load_dwordx4 a[152:155], v62, s[40:43], s62 offen offset:2048 sc1
    s_waitcnt vmcnt(15)
    v_mfma_f32_32x32x16_bf16 v[96:111], a[60:63], a[156:159], v[96:111]
    buffer_load_dwordx4 a[156:159], v62, s[40:43], s62 offen offset:3072 sc1
    s_waitcnt vmcnt(15)
    v_mfma_f32_32x32x16_bf16 v[96:111], a[64:67], a[0:3], v[96:111]
    buffer_load_dwordx4 a[0:3], v63, s[40:43], s62 offen offset:0 sc1
    s_waitcnt vmcnt(15)
    v_mfma_f32_32x32x16_bf16 v[96:111], a[68:71], a[4:7], v[96:111]
    buffer_load_dwordx4 a[4:7], v63, s[40:43], s62 offen offset:1024 sc1
    s_waitcnt vmcnt(15)
    v_mfma_f32_32x32x16_bf16 v[96:111], a[72:75], a[8:11], v[96:111]
    buffer_load_dwordx4 a[8:11], v63, s[40:43], s62 offen offset:2048 sc1
    s_waitcnt vmcnt(15)
    v_mfma_f32_32x32x16_bf16 v[96:111], a[76:79], a[12:15], v[96:111]
    buffer_load_dwordx4 a[12:15], v63, s[40:43], s62 offen offset:3072 sc1
    s_waitcnt vmcnt(15)
    v_mfma_f32_32x32x16_bf16 v[96:111], a[80:83], v[64:67], v[96:111]
    s_waitcnt vmcnt(14)
    v_mfma_f32_32x32x16_bf16 v[96:111], a[84:87], v[68:71], v[96:111]
    s_waitcnt vmcnt(13)
    v_mfma_f32_32x32x16_bf16 v[96:111], a[88:91], v[72:75], v[96:111]
    s_waitcnt vmcnt(12)
    v_mfma_f32_32x32x16_bf16 v[96:111], a[92:95], v[76:79], v[96:111]
    s_waitcnt vmcnt(11)
    v_mfma_f32_32x32x16_bf16 v[96:111], a[96:99], v[80:83], v[96:111]
    s_waitcnt vmcnt(10)
    v_mfma_f32_32x32x16_bf16 v[96:111], a[100:103], v[84:87], v[96:111]
    s_waitcnt vmcnt(9)
    v_mfma_f32_32x32x16_bf16 v[96:111], a[104:107], v[88:91], v[96:111]
    s_waitcnt vmcnt(8)
    v_mfma_f32_32x32x16_bf16 v[96:111], a[108:111], v[92:95], v[96:111]
    s_waitcnt vmcnt(7)
    v_mfma_f32_32x32x16_bf16 v[96:111], a[112:115], a[144:147], v[96:111]
    s_waitcnt vmcnt(6)
    v_mfma_f32_32x32x16_bf16 v[96:111], a[116:119], a[148:151], v[96:111]
    s_waitcnt vmcnt(5)
    v_mfma_f32_32x32x16_bf16 v[96:111], a[120:123], a[152:155], v[96:111]
    s_waitcnt vmcnt(4)
    v_mfma_f32_32x32x16_bf16 v[96:111], a[124:127], a[156:159], v[96:111]
    s_waitcnt vmcnt(3)
    v_mfma_f32_32x32x16_bf16 v[96:111], a[128:131], a[0:3], v[96:111]
    s_waitcnt vmcnt(2)
    v_mfma_f32_32x32x16_bf16 v[96:111], a[132:135], a[4:7], v[96:111]
    s_waitcnt vmcnt(1)
    v_mfma_f32_32x32x16_bf16 v[96:111], a[136:139], a[8:11], v[96:111]
    s_waitcnt vmcnt(0)
    v_mfma_f32_32x32x16_bf16 v[96:111], a[140:143], a[12:15], v[96:111]
    s_nop 11
    v_fmac_f32 v24, v96, v40
    v_fmac_f32 v25, v97, v41
    v_fmac_f32 v26, v98, v42
    v_fmac_f32 v27, v99, v43
    v_fmac_f32 v28, v100, v44
    v_fmac_f32 v29, v101, v45
    v_fmac_f32 v30, v102, v46
    v_fmac_f32 v31, v103, v47
    v_fmac_f32 v32, v104, v48
    v_fmac_f32 v33, v105, v49
    v_fmac_f32 v34, v106, v50
    v_fmac_f32 v35, v107, v51
    v_fmac_f32 v36, v108, v52
    v_fmac_f32 v37, v109, v53
    v_fmac_f32 v38, v110, v54
    v_fmac_f32 v39, v111, v55
    v_mul_f32 v64, v24, v112
    v_mul_f32 v65, v25, v113
    v_mul_f32 v66, v26, v114
    v_mul_f32 v67, v27, v115
    v_mul_f32 v68, v28, v116
    v_mul_f32 v69, v29, v117
    v_mul_f32 v70, v30, v118
    v_mul_f32 v71, v31, v119
    v_mul_f32 v72, v32, v120
    v_mul_f32 v73, v33, v121
    v_mul_f32 v74, v34, v122
    v_mul_f32 v75, v35, v123
    v_mul_f32 v76, v36, v124
    v_mul_f32 v77, v37, v125
    v_mul_f32 v78, v38, v126
    v_mul_f32 v79, v39, v127
    v_cvt_pk_bf16_f32 v96, v64, v65
    v_cvt_pk_bf16_f32 v97, v66, v67
    v_cvt_pk_bf16_f32 v98, v68, v69
    v_cvt_pk_bf16_f32 v99, v70, v71
    v_cvt_pk_bf16_f32 v100, v72, v73
    v_cvt_pk_bf16_f32 v101, v74, v75
    v_cvt_pk_bf16_f32 v102, v76, v77
    v_cvt_pk_bf16_f32 v103, v78, v79
    buffer_store_dwordx4 v[96:99], v15, s[40:43], s60 offen sc1
    buffer_store_dwordx4 v[100:103], v15, s[40:43], s60 offen offset:1024 sc1
    v_cvt_pk_bf16_f32 v104, v24, v25
    v_cvt_pk_bf16_f32 v105, v26, v27
    v_cvt_pk_bf16_f32 v106, v28, v29
    v_cvt_pk_bf16_f32 v107, v30, v31
    v_cvt_pk_bf16_f32 v108, v32, v33
    v_cvt_pk_bf16_f32 v109, v34, v35
    v_cvt_pk_bf16_f32 v110, v36, v37
    v_cvt_pk_bf16_f32 v111, v38, v39
    buffer_store_dwordx4 v[104:107], v15, s[40:43], s64 offen sc1
    buffer_store_dwordx4 v[108:111], v15, s[40:43], s64 offen offset:1024 sc1
    v_add_f32 v80, v24, v25
    v_mul_f32 v81, v24, v24
    v_add_f32 v82, v26, v27
    v_mul_f32 v83, v25, v25
    v_fmac_f32 v81, v26, v26
    v_fmac_f32 v83, v27, v27
    v_fmac_f32 v81, v28, v28
    v_fmac_f32 v83, v29, v29
    v_fmac_f32 v81, v30, v30
    v_fmac_f32 v83, v31, v31
    v_fmac_f32 v81, v32, v32
    v_fmac_f32 v83, v33, v33
    v_fmac_f32 v81, v34, v34
    v_fmac_f32 v83, v35, v35
    v_fmac_f32 v81, v36, v36
    v_fmac_f32 v83, v37, v37
    v_fmac_f32 v81, v38, v38
    v_fmac_f32 v83, v39, v39
    v_add_f32 v80, v80, v28
    v_add_f32 v82, v82, v29
    v_add_f32 v80, v80, v30
    v_add_f32 v82, v82, v31
    v_add_f32 v80, v80, v32
    v_add_f32 v82, v82, v33
    v_add_f32 v80, v80, v34
    v_add_f32 v82, v82, v35
    v_add_f32 v80, v80, v36
    v_add_f32 v82, v82, v37
    v_add_f32 v80, v80, v38
    v_add_f32 v82, v82, v39
    v_add_f32 v80, v80, v82
    v_add_f32 v81, v81, v83
    v_mov_b32 v82, v80
    v_mov_b32 v83, v81
    s_nop 0
    v_permlane32_swap_b32 v80, v82
    v_permlane32_swap_b32 v81, v83
    v_add_f32 v80, v80, v82
    v_add_f32 v81, v81, v83
    s_mov_b32 exec_hi, 0
    buffer_store_dwordx2 v[80:81], v7, s[40:43], s66 offen sc1
    s_mov_b64 exec, -1
    v_lshrrev_b32 v6, 5, v1
    s_waitcnt vmcnt(0)
    s_mov_b64 exec, 1
    buffer_store_dword v22, v21, s[40:43], s67 offen sc1
    s_mov_b64 exec, -1
    s_lshl_b32 s60, s78, 6
    s_lshl_b32 s60, s60, 4
    s_add_u32 s60, s60, 1310720
    s_mul_i32 s62, s78, 3584
    s_add_u32 s62, s62, 73728
    v_and_b32 v2, 31, v1
    v_lshlrev_b32 v9, 4, v2
    v_add_u32 v9, 148480, v9
    v_lshlrev_b32 v2, 3, v2
    v_mul_u32_u24 v5, 1792, v6
    v_add_u32 v7, v2, v5
    v_lshlrev_b32 v13, 6, v1
    v_add_u32 v13, s60, v13
    s_lshl_b32 s9, s15, 6
    s_add_u32 s9, s9, 1703040
    v_lshl_add_u32 v2, v1, 6, s9
    v_bfe_u32 v5, v1, 1, 5
    v_cmp_eq_u32 vcc, 7, v5
    s_nop 1
    v_cndmask_b32 v13, v13, v2, vcc
    s_lshl_b32 s89, s15, 10
    s_add_u32 s89, s89, 1835008
    s_mul_i32 s63, s5, 114688
    s_lshl_b32 s61, s4, 10
    s_add_u32 s63, s63, s61
    s_add_u32 s63, s63, 10485760
    v_add_u32 v10, 59392, v15
    s_mul_i32 s9, s4, 29696
    v_add_u32 v11, s9, v15
    s_lshl_b32 s9, s4, 9
    v_add_u32 v12, s9, v9
    s_mul_i32 s84, s5, 448
    s_lshl_b32 s11, s6, 3
    s_add_u32 s84, s84, s11
    s_lshl_b32 s11, s4, 1
    s_add_u32 s84, s84, s11
    s_lshl_b32 s84, s84, 10
    s_add_u32 s84, s84, 20971520
    s_add_u32 s85, s84, 229376
    s_add_u32 s86, s84, 114688
    s_add_u32 s87, s84, 344064
    s_and_b32 s80, s4, 1
    s_lshr_b32 s81, s4, 1
    s_lshl_b32 s9, s83, 1
    s_add_u32 s79, s9, s80
    s_xor_b32 s10, s79, 1
    s_mul_i32 s11, s4, 28
    s_mul_i32 s88, s79, 112
    s_add_u32 s88, s88, s11
    s_lshl_b32 s88, s88, 10
    s_add_u32 s88, s88, 14680064
    s_mul_i32 s90, s10, 112
    s_add_u32 s90, s90, s11
    s_lshl_b32 s90, s90, 10
    s_add_u32 s90, s90, 14680064
    s_lshl_b32 s72, s5, 6
    s_lshl_b32 s9, s6, 2
    s_add_u32 s72, s72, s9
    s_add_u32 s72, s72, s4
    s_lshl_b32 s72, s72, 2
    s_lshl_b32 s72, s72, 4
    s_add_u32 s72, s72, 1441792
    s_add_u32 s73, s72, 65536
    s_lshl_b32 s74, s5, 8
    s_mul_i32 s9, s4, 56
    s_add_u32 s74, s74, s9
    s_lshl_b32 s74, s74, 4
    s_add_u32 s74, s74, 1441792
    s_add_u32 s75, s74, 65536
    s_sleep 10
    s_mov_b64 exec, 0xffff
    s_mov_b32 s9, 0
LP_7:
    buffer_load_dword v2, v13, s[40:43], 0 offen sc1
    s_add_u32 s9, s9, 1
    s_cmp_gt_u32 s9, 0x4000
    s_cbranch_scc1 L_ABORT
    s_waitcnt vmcnt(0)
    v_cmp_ne_u32 vcc, s3, v2
    s_cbranch_vccz LD_8
    s_sleep 4
    s_branch LP_7
LD_8:
    s_mov_b64 exec, -1
    s_barrier
    v_min_u32 v13, 13, v1
    v_lshlrev_b32 v13, 6, v13
    s_add_u32 m0, s61, 0
    s_nop 0
    buffer_load_dwordx4 v14, s[40:43], s63 offen sc1 lds
    s_add_u32 m0, s61, 4096
    s_nop 0
    buffer_load_dwordx4 v17, s[40:43], s63 offen sc1 lds
    s_add_u32 m0, s61, 8192
    s_nop 0
    buffer_load_dwordx4 v18, s[40:43], s63 offen sc1 lds
    s_add_u32 m0, s61, 12288
    s_nop 0
    buffer_load_dwordx4 v19, s[40:43], s63 offen sc1 lds
    s_add_u32 m0, s61, 16384
    s_nop 0
    buffer_load_dwordx4 v20, s[40:43], s63 offen sc1 lds
    s_add_u32 m0, s61, 20480
    s_nop 0
    buffer_load_dwordx4 v3, s[40:43], s63 offen sc1 lds
    s_add_u32 m0, s61, 24576
    s_nop 0
    buffer_load_dwordx4 v4, s[40:43], s63 offen sc1 lds
    buffer_load_dwordx2 v[24:25], v7, s[40:43], s62 offen offset:0 sc1
    buffer_load_dwordx2 v[26:27], v7, s[40:43], s62 offen offset:256 sc1
    buffer_load_dwordx2 v[28:29], v7, s[40:43], s62 offen offset:512 sc1
    buffer_load_dwordx2 v[30:31], v7, s[40:43], s62 offen offset:768 sc1
    buffer_load_dwordx2 v[32:33], v7, s[40:43], s62 offen offset:1024 sc1
    buffer_load_dwordx2 v[34:35], v7, s[40:43], s62 offen offset:1280 sc1
    buffer_load_dwordx2 v[36:37], v7, s[40:43], s62 offen offset:1536 sc1
    buffer_load_dwordx4 v[56:59], v15, s[40:43], s89 offen sc1
    buffer_load_dwordx4 v[60:63], v15, s[40:43], s89 offen offset:1024 sc1
    s_waitcnt vmcnt(14)
    s_barrier
    ds_read_b128 a[0:3], v15 offset:0
    ds_read_b128 a[4:7], v15 offset:1024
    ds_read_b128 a[8:11], v15 offset:2048
    ds_read_b128 a[12:15], v15 offset:3072
    ds_read_b128 a[16:19], v15 offset:4096
    s_waitcnt lgkmcnt(4)
    v_mfma_f32_32x32x16_bf16 v[64:79], a[160:163], a[0:3], 0
    s_add_u32 m0, s61, 59392
    s_add_u32 s66, s63, 57344
    buffer_load_dwordx4 v14, s[40:43], s66 offen sc1 lds
    v_mfma_f32_32x32x16_bf16 v[80:95], a[164:167], a[0:3], 0
    ds_read_b128 a[20:23], v15 offset:5120
    s_waitcnt lgkmcnt(4)
    v_mfma_f32_32x32x16_bf16 v[64:79], a[168:171], a[4:7], v[64:79]
    s_add_u32 m0, s61, 63488
    s_nop 0
    buffer_load_dwordx4 v17, s[40:43], s66 offen sc1 lds
    v_mfma_f32_32x32x16_bf16 v[80:95], a[172:175], a[4:7], v[80:95]
    ds_read_b128 a[24:27], v15 offset:6144
    s_waitcnt lgkmcnt(4)
    v_mfma_f32_32x32x16_bf16 v[64:79], a[176:179], a[8:11], v[64:79]
    s_add_u32 m0, s61, 67584
    s_nop 0
    buffer_load_dwordx4 v18, s[40:43], s66 offen sc1 lds
    v_mfma_f32_32x32x16_bf16 v[80:95], a[180:183], a[8:11], v[80:95]
    ds_read_b128 a[28:31], v15 offset:7168
    s_waitcnt lgkmcnt(4)
    v_mfma_f32_32x32x16_bf16 v[64:79], a[184:187], a[12:15], v[64:79]
    s_add_u32 m0, s61, 71680
    s_nop 0
    buffer_load_dwordx4 v19, s[40:43], s66 offen sc1 lds
    v_mfma_f32_32x32x16_bf16 v[80:95], a[188:191], a[12:15], v[80:95]
    s_waitcnt vmcnt(13)
    s_barrier
    ds_read_b128 a[0:3], v15 offset:8192
    s_waitcnt lgkmcnt(4)
    v_mfma_f32_32x32x16_bf16 v[64:79], a[192:195], a[16:19], v[64:79]
    s_add_u32 m0, s61, 75776
    s_nop 0
    buffer_load_dwordx4 v20, s[40:43], s66 offen sc1 lds
    v_mfma_f32_32x32x16_bf16 v[80:95], a[196:199], a[16:19], v[80:95]
    ds_read_b128 a[4:7], v15 offset:9216
    s_waitcnt lgkmcnt(4)
    v_mfma_f32_32x32x16_bf16 v[64:79], a[200:203], a[20:23], v[64:79]
    s_add_u32 m0, s61, 79872
    s_nop 0
    buffer_load_dwordx4 v3, s[40:43], s66 offen sc1 lds
    v_mfma_f32_32x32x16_bf16 v[80:95], a[204:207], a[20:23], v[80:95]
    ds_read_b128 a[8:11], v15 offset:10240
    s_waitcnt lgkmcnt(4)
    v_mfma_f32_32x32x16_bf16 v[64:79], a[208:211], a[24:27], v[64:79]
    s_add_u32 m0, s61, 83968
    s_nop 0
    buffer_load_dwordx4 v4, s[40:43], s66 offen sc1 lds
    s_waitcnt vmcnt(9)
    v_add_f32 v24, v24, v26
    v_mfma_f32_32x32x16_bf16 v[80:95], a[212:215], a[24:27], v[80:95]
    v_add_f32 v25, v25, v27
    v_add_f32 v24, v24, v28
    ds_read_b128 a[12:15], v15 offset:11264
    s_waitcnt lgkmcnt(4)
    v_mfma_f32_32x32x16_bf16 v[64:79], a[216:219], a[28:31], v[64:79]
    v_add_f32 v25, v25, v29
    v_add_f32 v24, v24, v30
    v_mfma_f32_32x32x16_bf16 v[80:95], a[220:223], a[28:31], v[80:95]
    v_add_f32 v25, v25, v31
    v_add_f32 v24, v24, v32
    ds_read_b128 a[16:19], v15 offset:12288
    s_waitcnt lgkmcnt(4)
    v_mfma_f32_32x32x16_bf16 v[64:79], a[224:227], a[0:3], v[64:79]
    s_add_u32 m0, s61, 29696
    s_add_u32 s66, s63, 28672
    buffer_load_dwordx4 v14, s[40:43], s66 offen sc1 lds
    v_add_f32 v25, v25, v33
    v_add_f32 v24, v24, v34
    v_mfma_f32_32x32x16_bf16 v[80:95], a[228:231], a[0:3], v[80:95]
    v_add_f32 v25, v25, v35
    v_add_f32 v24, v24, v36
    ds_read_b128 a[20:23], v15 offset:13312
    s_waitcnt lgkmcnt(4)
    v_mfma_f32_32x32x16_bf16 v[64:79], a[232:235], a[4:7], v[64:79]
    v_add_f32 v25, v25, v37
    v_mov_b32 v26, v24
    v_mfma_f32_32x32x16_bf16 v[80:95], a[236:239], a[4:7], v[80:95]
    v_mov_b32 v27, v25
    s_nop 1
    ds_read_b128 a[24:27], v15 offset:14336
    s_waitcnt lgkmcnt(4)
    v_mfma_f32_32x32x16_bf16 v[64:79], a[240:243], a[8:11], v[64:79]
    s_add_u32 m0, s61, 33792
    s_nop 0
    buffer_load_dwordx4 v17, s[40:43], s66 offen sc1 lds
    v_permlane32_swap_b32 v24, v26
    v_permlane32_swap_b32 v25, v27
    v_mfma_f32_32x32x16_bf16 v[80:95], a[244:247], a[8:11], v[80:95]
    v_add_f32 v24, v24, v26
    v_add_f32 v25, v25, v27
    ds_read_b128 a[28:31], v15 offset:15360
    s_waitcnt lgkmcnt(4)
    v_mfma_f32_32x32x16_bf16 v[64:79], a[248:251], a[12:15], v[64:79]
    v_mul_f32 v24, -0.002232142857142857, v24
    v_mfma_f32_32x32x16_bf16 v[80:95], a[252:255], a[12:15], v[80:95]
    v_mul_f32 v25, 0.002232142857142857, v25
    ds_read_b128 a[0:3], v15 offset:16384
    s_waitcnt lgkmcnt(4)
    v_mfma_f32_32x32x16_bf16 v[64:79], v[128:131], a[16:19], v[64:79]
    s_add_u32 m0, s61, 37888
    s_nop 0
    buffer_load_dwordx4 v18, s[40:43], s66 offen sc1 lds
    v_fma_f32 v25, -v24, v24, v25
    v_mfma_f32_32x32x16_bf16 v[80:95], v[132:135], a[16:19], v[80:95]
    v_max_f32 v25, 0, v25
    ds_read_b128 a[4:7], v15 offset:17408
    s_waitcnt lgkmcnt(4)
    v_mfma_f32_32x32x16_bf16 v[64:79], v[136:139], a[20:23], v[64:79]
    v_add_f32 v46, 0x3727c5ac, v25
    v_mfma_f32_32x32x16_bf16 v[80:95], v[140:143], a[20:23], v[80:95]
    v_rsq_f32 v28, v46
    ds_read_b128 a[8:11], v15 offset:18432
    s_waitcnt lgkmcnt(4)
    v_mfma_f32_32x32x16_bf16 v[64:79], v[144:147], a[24:27], v[64:79]
    s_add_u32 m0, s61, 41984
    s_nop 0
    buffer_load_dwordx4 v19, s[40:43], s66 offen sc1 lds
    v_cvt_pk_bf16_f32 v26, v24, v24
    v_mfma_f32_32x32x16_bf16 v[80:95], v[148:151], a[24:27], v[80:95]
    v_mul_f32 v25, v46, v28
    ds_read_b128 a[12:15], v15 offset:19456
    s_waitcnt lgkmcnt(4)
    v_mfma_f32_32x32x16_bf16 v[64:79], v[152:155], a[28:31], v[64:79]
    v_and_b32 v26, s56, v26
    v_mfma_f32_32x32x16_bf16 v[80:95], v[156:159], a[28:31], v[80:95]
    v_cvt_pk_bf16_f32 v27, v25, v25
    ds_read_b128 a[16:19], v15 offset:20480
    s_waitcnt lgkmcnt(4)
    v_mfma_f32_32x32x16_bf16 v[64:79], v[160:163], a[0:3], v[64:79]
    s_add_u32 m0, s61, 46080
    s_nop 0
    buffer_load_dwordx4 v20, s[40:43], s66 offen sc1 lds
    v_sub_f32 v26, v24, v26
    v_mfma_f32_32x32x16_bf16 v[80:95], v[164:167], a[0:3], v[80:95]
    v_and_b32 v27, s56, v27
    ds_read_b128 a[20:23], v15 offset:21504
    s_waitcnt lgkmcnt(4)
    v_mfma_f32_32x32x16_bf16 v[64:79], v[168:171], a[4:7], v[64:79]
    v_sub_f32 v27, v25, v27
    v_mfma_f32_32x32x16_bf16 v[80:95], v[172:175], a[4:7], v[80:95]
    v_cvt_pk_bf16_f32 v40, v24, v26
    ds_read_b128 a[24:27], v15 offset:22528
    s_waitcnt lgkmcnt(4)
    v_mfma_f32_32x32x16_bf16 v[64:79], v[176:179], a[8:11], v[64:79]
    s_add_u32 m0, s61, 50176
    s_nop 0
    buffer_load_dwordx4 v3, s[40:43], s66 offen sc1 lds
    v_cvt_pk_bf16_f32 v41, v24, v25
    v_mfma_f32_32x32x16_bf16 v[80:95], v[180:183], a[8:11], v[80:95]
    v_cvt_pk_bf16_f32 v42, v27, v25
    ds_read_b128 a[28:31], v15 offset:23552
    s_waitcnt lgkmcnt(4)
    v_mfma_f32_32x32x16_bf16 v[64:79], v[184:187], a[12:15], v[64:79]
    v_mov_b32 v43, 0
    v_mfma_f32_32x32x16_bf16 v[80:95], v[188:191], a[12:15], v[80:95]
    v_mul_f32 v44, -2.302208198144325, v28
    ds_read_b128 a[0:3], v15 offset:24576
    s_waitcnt lgkmcnt(4)
    v_mfma_f32_32x32x16_bf16 v[64:79], v[192:195], a[16:19], v[64:79]
    s_add_u32 m0, s61, 54272
    s_nop 0
    buffer_load_dwordx4 v4, s[40:43], s66 offen sc1 lds
    v_mul_f32 v29, v28, v28
    v_mfma_f32_32x32x16_bf16 v[80:95], v[196:199], a[16:19], v[80:95]
    v_mul_f32 v45, v44, v29
    ds_read_b128 a[4:7], v15 offset:25600
    s_waitcnt lgkmcnt(4)
    v_mfma_f32_32x32x16_bf16 v[64:79], v[200:203], a[20:23], v[64:79]
    v_mul_f32 v45, 0.044715, v45
    v_mfma_f32_32x32x16_bf16 v[80:95], v[204:207], a[20:23], v[80:95]
    v_mov_b32 v47, 0
    ds_read_b128 a[8:11], v15 offset:26624
    s_waitcnt lgkmcnt(4)
    v_mfma_f32_32x32x16_bf16 v[64:79], v[208:211], a[24:27], v[64:79]
    s_add_u32 m0, s61, 89088
    s_add_u32 s66, s63, 86016
    buffer_load_dwordx4 v14, s[40:43], s66 offen sc1 lds
    ds_write_b128 v11, v[40:43] offset:28672
    v_mfma_f32_32x32x16_bf16 v[80:95], v[212:215], a[24:27], v[80:95]
    ds_write_b128 v12, v[44:47]
    ds_read_b128 a[12:15], v15 offset:27648
    s_waitcnt lgkmcnt(6)
    v_mfma_f32_32x32x16_bf16 v[64:79], v[216:219], a[28:31], v[64:79]
    v_mfma_f32_32x32x16_bf16 v[80:95], v[220:223], a[28:31], v[80:95]
    s_waitcnt lgkmcnt(1)
    s_waitcnt vmcnt(8)
    s_barrier
    ds_read_b128 v[44:47], v9 offset:0
    ds_read_b128 v[48:51], v9 offset:1024
    ds_read_b128 a[16:19], v15 offset:28672
    v_mfma_f32_32x32x16_bf16 v[64:79], v[224:227], a[0:3], v[64:79]
    s_add_u32 m0, s61, 93184
    s_nop 0
    buffer_load_dwordx4 v17, s[40:43], s66 offen sc1 lds
    v_mfma_f32_32x32x16_bf16 v[80:95], v[228:231], a[0:3], v[80:95]
    ds_read_b128 a[20:23], v10 offset:0
    v_mfma_f32_32x32x16_bf16 v[64:79], v[232:235], a[4:7], v[64:79]
    v_mfma_f32_32x32x16_bf16 v[80:95], v[236:239], a[4:7], v[80:95]
    ds_read_b128 a[24:27], v10 offset:1024
    v_mfma_f32_32x32x16_bf16 v[64:79], v[240:243], a[8:11], v[64:79]
    s_add_u32 m0, s61, 97280
    s_nop 0
    buffer_load_dwordx4 v18, s[40:43], s66 offen sc1 lds
    v_mfma_f32_32x32x16_bf16 v[80:95], v[244:247], a[8:11], v[80:95]
    ds_read_b128 a[28:31], v10 offset:2048
    s_waitcnt lgkmcnt(6)
    v_mfma_f32_32x32x16_bf16 v[64:79], v[248:251], a[12:15], v[64:79]
    v_mfma_f32_32x32x16_bf16 v[80:95], v[252:255], a[12:15], v[80:95]
    ds_read_b128 a[0:3], v10 offset:3072
    s_waitcnt lgkmcnt(4)
    v_mfma_f32_32x32x16_bf16 v[64:79], v[56:59], a[16:19], v[64:79]
    s_add_u32 m0, s61, 101376
    s_nop 0
    buffer_load_dwordx4 v19, s[40:43], s66 offen sc1 lds
    v_mfma_f32_32x32x16_bf16 v[80:95], v[60:63], a[16:19], v[80:95]
    ds_read_b128 a[4:7], v10 offset:4096
    s_waitcnt lgkmcnt(4)
    v_mfma_f32_32x32x16_bf16 v[96:111], a[160:163], a[20:23], 0
    v_mfma_f32_32x32x16_bf16 v[112:127], a[164:167], a[20:23], 0
    ds_read_b128 a[8:11], v10 offset:5120
    s_waitcnt lgkmcnt(4)
    v_mfma_f32_32x32x16_bf16 v[96:111], a[168:171], a[24:27], v[96:111]
    s_add_u32 m0, s61, 105472
    s_nop 0
    buffer_load_dwordx4 v20, s[40:43], s66 offen sc1 lds
    v_mul_f32 v24, v64, v64
    v_mul_f32 v25, v65, v65
    v_mfma_f32_32x32x16_bf16 v[112:127], a[172:175], a[24:27], v[112:127]
    v_mul_f32 v26, v66, v66
    v_mul_f32 v27, v67, v67
    v_mul_f32 v28, v72, v72
    ds_read_b128 a[12:15], v10 offset:6144
    s_waitcnt lgkmcnt(4)
    v_mfma_f32_32x32x16_bf16 v[96:111], a[176:179], a[28:31], v[96:111]
    v_mul_f32 v29, v73, v73
    v_mul_f32 v30, v74, v74
    v_mul_f32 v31, v75, v75
    v_mfma_f32_32x32x16_bf16 v[112:127], a[180:183], a[28:31], v[112:127]
    v_fma_f32 v24, v24, v45, v44
    v_fma_f32 v25, v25, v45, v44
    v_fma_f32 v26, v26, v45, v44
    ds_read_b128 a[16:19], v10 offset:7168
    s_waitcnt lgkmcnt(4)
    v_mfma_f32_32x32x16_bf16 v[96:111], a[184:187], a[0:3], v[96:111]
    s_add_u32 m0, s61, 109568
    s_nop 0
    buffer_load_dwordx4 v3, s[40:43], s66 offen sc1 lds
    v_fma_f32 v27, v27, v45, v44
    v_fma_f32 v28, v28, v45, v44
    v_fma_f32 v29, v29, v45, v44
    v_mfma_f32_32x32x16_bf16 v[112:127], a[188:191], a[0:3], v[112:127]
    v_fma_f32 v30, v30, v45, v44
    v_fma_f32 v31, v31, v45, v44
    v_mul_f32 v24, v24, v64
    ds_read_b128 a[20:23], v10 offset:8192
    s_waitcnt lgkmcnt(4)
    v_mfma_f32_32x32x16_bf16 v[96:111], a[192:195], a[4:7], v[96:111]
    v_mul_f32 v25, v25, v65
    v_mul_f32 v26, v26, v66
    v_mul_f32 v27, v27, v67
    v_mfma_f32_32x32x16_bf16 v[112:127], a[196:199], a[4:7], v[112:127]
    v_mul_f32 v28, v28, v72
    v_mul_f32 v29, v29, v73
    v_mul_f32 v30, v30, v74
    ds_read_b128 a[24:27], v10 offset:9216
    s_waitcnt lgkmcnt(4)
    v_mfma_f32_32x32x16_bf16 v[96:111], a[200:203], a[8:11], v[96:111]
    s_add_u32 m0, s61, 113664
    s_nop 0
    buffer_load_dwordx4 v4, s[40:43], s66 offen sc1 lds
    v_mul_f32 v31, v31, v75
    v_exp_f32 v24, v24
    v_mul_f32 v68, v68, v64
    v_mfma_f32_32x32x16_bf16 v[112:127], a[204:207], a[8:11], v[112:127]
    v_exp_f32 v25, v25
    v_mul_f32 v69, v69, v65
    v_exp_f32 v26, v26
    ds_read_b128 a[28:31], v10 offset:10240
    s_waitcnt lgkmcnt(4)
    v_mfma_f32_32x32x16_bf16 v[96:111], a[208:211], a[12:15], v[96:111]
    buffer_load_dwordx4 a[32:35], v14, s[40:43], s88 offen offset:0 sc1
    v_mul_f32 v70, v70, v66
    v_exp_f32 v27, v27
    v_mul_f32 v71, v71, v67
    v_mfma_f32_32x32x16_bf16 v[112:127], a[212:215], a[12:15], v[112:127]
    v_exp_f32 v28, v28
    v_mul_f32 v76, v76, v72
    v_exp_f32 v29, v29
    ds_read_b128 a[0:3], v10 offset:11264
    s_waitcnt lgkmcnt(4)
    v_mfma_f32_32x32x16_bf16 v[96:111], a[216:219], a[16:19], v[96:111]
    v_mul_f32 v77, v77, v73
    v_exp_f32 v30, v30
    v_mul_f32 v78, v78, v74
    v_mfma_f32_32x32x16_bf16 v[112:127], a[220:223], a[16:19], v[112:127]
    v_exp_f32 v31, v31
    v_mul_f32 v79, v79, v75
    v_fma_f32 v24, v24, v46, v46
    ds_read_b128 a[4:7], v10 offset:12288
    s_waitcnt lgkmcnt(4)
    v_mfma_f32_32x32x16_bf16 v[96:111], a[224:227], a[20:23], v[96:111]
    buffer_load_dwordx4 a[36:39], v14, s[40:43], s90 offen offset:0 sc1
    v_fma_f32 v25, v25, v46, v46
    v_fma_f32 v26, v26, v46, v46
    v_fma_f32 v27, v27, v46, v46
    v_mfma_f32_32x32x16_bf16 v[112:127], a[228:231], a[20:23], v[112:127]
    v_fma_f32 v28, v28, v46, v46
    v_fma_f32 v29, v29, v46, v46
    v_fma_f32 v30, v30, v46, v46
    ds_read_b128 a[8:11], v10 offset:13312
    s_waitcnt lgkmcnt(4)
    v_mfma_f32_32x32x16_bf16 v[96:111], a[232:235], a[24:27], v[96:111]
    buffer_load_dwordx4 a[40:43], v14, s[40:43], s88 offen offset:1024 sc1
    v_fma_f32 v31, v31, v46, v46
    v_rcp_f32 v24, v24
    v_rcp_f32 v25, v25
    v_mfma_f32_32x32x16_bf16 v[112:127], a[236:239], a[24:27], v[112:127]
    v_rcp_f32 v26, v26
    v_rcp_f32 v27, v27
    v_rcp_f32 v28, v28
    ds_read_b128 a[12:15], v10 offset:14336
    s_waitcnt lgkmcnt(4)
    v_mfma_f32_32x32x16_bf16 v[96:111], a[240:243], a[28:31], v[96:111]
    v_rcp_f32 v29, v29
    v_rcp_f32 v30, v30
    v_rcp_f32 v31, v31
    v_mfma_f32_32x32x16_bf16 v[112:127], a[244:247], a[28:31], v[112:127]
    v_mul_f32 v68, v68, v24
    v_mul_f32 v69, v69, v25
    v_mul_f32 v70, v70, v26
    s_lshl_b32 s9, s13, 2
    s_add_u32 s9, s9, s4
    s_lshl_b32 s9, s9, 13
    v_lshl_add_u32 v2, v1, 7, s9
    v_min_u32 v2, L_CODE_END-L_PC2-4, v2
    global_load_dword v2, v2, s[100:101]
    ds_read_b128 a[16:19], v10 offset:15360
    s_waitcnt lgkmcnt(4)
    v_mfma_f32_32x32x16_bf16 v[96:111], a[248:251], a[0:3], v[96:111]
    buffer_load_dwordx4 a[44:47], v14, s[40:43], s90 offen offset:1024 sc1
    v_mul_f32 v71, v71, v27
    v_mul_f32 v76, v76, v28
    v_mul_f32 v77, v77, v29
    v_mfma_f32_32x32x16_bf16 v[112:127], a[252:255], a[0:3], v[112:127]
    v_mul_f32 v78, v78, v30
    v_mul_f32 v79, v79, v31
    v_cvt_pk_bf16_f32 v52, v68, v69
    ds_read_b128 a[20:23], v10 offset:16384
    s_waitcnt lgkmcnt(4)
    v_mfma_f32_32x32x16_bf16 v[96:111], v[128:131], a[4:7], v[96:111]
    buffer_load_dwordx4 a[48:51], v14, s[40:43], s88 offen offset:2048 sc1
    v_cvt_pk_bf16_f32 v53, v70, v71
    v_cvt_pk_bf16_f32 v54, v76, v77
    v_cvt_pk_bf16_f32 v55, v78, v79
    v_mfma_f32_32x32x16_bf16 v[112:127], v[132:135], a[4:7], v[112:127]
    buffer_store_dwordx4 v[52:55], v15, s[40:43], s84 offen offset:0 sc1
    v_mul_f32 v32, v80, v80
    v_mul_f32 v33, v81, v81
    ds_read_b128 a[24:27], v10 offset:17408
    s_waitcnt lgkmcnt(4)
    v_mfma_f32_32x32x16_bf16 v[96:111], v[136:139], a[8:11], v[96:111]
    v_mul_f32 v34, v82, v82
    v_mul_f32 v35, v83, v83
    v_mul_f32 v36, v88, v88
    v_mfma_f32_32x32x16_bf16 v[112:127], v[140:143], a[8:11], v[112:127]
    v_mul_f32 v37, v89, v89
    v_mul_f32 v38, v90, v90
    v_mul_f32 v39, v91, v91
    ds_read_b128 a[28:31], v10 offset:18432
    s_waitcnt lgkmcnt(4)
    v_mfma_f32_32x32x16_bf16 v[96:111], v[144:147], a[12:15], v[96:111]
    buffer_load_dwordx4 a[52:55], v14, s[40:43], s90 offen offset:2048 sc1
    v_fma_f32 v32, v32, v45, v44
    v_fma_f32 v33, v33, v45, v44
    v_fma_f32 v34, v34, v45, v44
    v_mfma_f32_32x32x16_bf16 v[112:127], v[148:151], a[12:15], v[112:127]
    v_fma_f32 v35, v35, v45, v44
    v_fma_f32 v36, v36, v45, v44
    v_fma_f32 v37, v37, v45, v44
    ds_read_b128 a[0:3], v10 offset:19456
    s_waitcnt lgkmcnt(4)
    v_mfma_f32_32x32x16_bf16 v[96:111], v[152:155], a[16:19], v[96:111]
    buffer_load_dwordx4 a[56:59], v14, s[40:43], s88 offen offset:3072 sc1
    v_fma_f32 v38, v38, v45, v44
    v_fma_f32 v39, v39, v45, v44
    v_mul_f32 v32, v32, v80
    v_mfma_f32_32x32x16_bf16 v[112:127], v[156:159], a[16:19], v[112:127]
    v_mul_f32 v33, v33, v81
    v_mul_f32 v34, v34, v82
    v_mul_f32 v35, v35, v83
    ds_read_b128 a[4:7], v10 offset:20480
    s_waitcnt lgkmcnt(4)
    v_mfma_f32_32x32x16_bf16 v[96:111], v[160:163], a[20:23], v[96:111]
    v_mul_f32 v36, v36, v88
    v_mul_f32 v37, v37, v89
    v_mul_f32 v38, v38, v90
    v_mfma_f32_32x32x16_bf16 v[112:127], v[164:167], a[20:23], v[112:127]
    v_mul_f32 v39, v39, v91
    v_exp_f32 v32, v32
    v_mul_f32 v84, v84, v80
    ds_read_b128 a[8:11], v10 offset:21504
    s_waitcnt lgkmcnt(4)
    v_mfma_f32_32x32x16_bf16 v[96:111], v[168:171], a[24:27], v[96:111]
    buffer_load_dwordx4 a[60:63], v14, s[40:43], s90 offen offset:3072 sc1
    v_exp_f32 v33, v33
    v_mul_f32 v85, v85, v81
    v_exp_f32 v34, v34
    v_mfma_f32_32x32x16_bf16 v[112:127], v[172:175], a[24:27], v[112:127]
    v_mul_f32 v86, v86, v82
    v_exp_f32 v35, v35
    v_mul_f32 v87, v87, v83
    ds_read_b128 a[12:15], v10 offset:22528
    s_waitcnt lgkmcnt(4)
    v_mfma_f32_32x32x16_bf16 v[96:111], v[176:179], a[28:31], v[96:111]
    buffer_load_dwordx4 a[64:67], v17, s[40:43], s88 offen offset:0 sc1
    v_exp_f32 v36, v36
    v_mul_f32 v92, v92, v88
    v_exp_f32 v37, v37
    v_mfma_f32_32x32x16_bf16 v[112:127], v[180:183], a[28:31], v[112:127]
    v_mul_f32 v93, v93, v89
    v_exp_f32 v38, v38
    ds_read_b128 a[16:19], v10 offset:23552
    s_waitcnt lgkmcnt(4)
    v_mfma_f32_32x32x16_bf16 v[96:111], v[184:187], a[0:3], v[96:111]
    v_mul_f32 v94, v94, v90
    v_exp_f32 v39, v39
    v_mfma_f32_32x32x16_bf16 v[112:127], v[188:191], a[0:3], v[112:127]
    v_mul_f32 v95, v95, v91
    v_fma_f32 v32, v32, v46, v46
    ds_read_b128 a[20:23], v10 offset:24576
    s_waitcnt lgkmcnt(4)
    v_mfma_f32_32x32x16_bf16 v[96:111], v[192:195], a[4:7], v[96:111]
    buffer_load_dwordx4 a[68:71], v17, s[40:43], s90 offen offset:0 sc1
    v_fma_f32 v33, v33, v46, v46
    v_fma_f32 v34, v34, v46, v46
    v_mfma_f32_32x32x16_bf16 v[112:127], v[196:199], a[4:7], v[112:127]
    v_fma_f32 v35, v35, v46, v46
    v_fma_f32 v36, v36, v46, v46
    ds_read_b128 a[24:27], v10 offset:25600
    s_waitcnt lgkmcnt(4)
    v_mfma_f32_32x32x16_bf16 v[96:111], v[200:203], a[8:11], v[96:111]
    buffer_load_dwordx4 a[72:75], v17, s[40:43], s88 offen offset:1024 sc1
    v_fma_f32 v37, v37, v46, v46
    v_fma_f32 v38, v38, v46, v46
    v_mfma_f32_32x32x16_bf16 v[112:127], v[204:207], a[8:11], v[112:127]
    v_fma_f32 v39, v39, v46, v46
    v_rcp_f32 v32, v32
    ds_read_b128 a[28:31], v10 offset:26624
    s_waitcnt lgkmcnt(4)
    v_mfma_f32_32x32x16_bf16 v[96:111], v[208:211], a[12:15], v[96:111]
    v_rcp_f32 v33, v33
    v_rcp_f32 v34, v34
    v_mfma_f32_32x32x16_bf16 v[112:127], v[212:215], a[12:15], v[112:127]
    v_rcp_f32 v35, v35
    v_rcp_f32 v36, v36
    ds_read_b128 a[0:3], v10 offset:27648
    s_waitcnt lgkmcnt(4)
    v_mfma_f32_32x32x16_bf16 v[96:111], v[216:219], a[16:19], v[96:111]
    buffer_load_dwordx4 a[76:79], v17, s[40:43], s90 offen offset:1024 sc1
    v_rcp_f32 v37, v37
    v_rcp_f32 v38, v38
    v_mfma_f32_32x32x16_bf16 v[112:127], v[220:223], a[16:19], v[112:127]
    v_rcp_f32 v39, v39
    v_mul_f32 v84, v84, v32
    ds_read_b128 a[4:7], v10 offset:28672
    s_waitcnt lgkmcnt(4)
    v_mfma_f32_32x32x16_bf16 v[96:111], v[224:227], a[20:23], v[96:111]
    buffer_load_dwordx4 a[80:83], v17, s[40:43], s88 offen offset:2048 sc1
    v_mul_f32 v85, v85, v33
    v_mul_f32 v86, v86, v34
    v_mfma_f32_32x32x16_bf16 v[112:127], v[228:231], a[20:23], v[112:127]
    v_mul_f32 v87, v87, v35
    v_mul_f32 v92, v92, v36
    s_waitcnt vmcnt(22)
    s_barrier
    ds_read_b128 a[8:11], v15 offset:29696
    s_waitcnt lgkmcnt(4)
    v_mfma_f32_32x32x16_bf16 v[96:111], v[232:235], a[24:27], v[96:111]
    v_mul_f32 v93, v93, v37
    v_mul_f32 v94, v94, v38
    v_mfma_f32_32x32x16_bf16 v[112:127], v[236:239], a[24:27], v[112:127]
    v_mul_f32 v95, v95, v39
    v_cvt_pk_bf16_f32 v40, v84, v85
    ds_read_b128 a[12:15], v15 offset:30720
    s_waitcnt lgkmcnt(4)
    v_mfma_f32_32x32x16_bf16 v[96:111], v[240:243], a[28:31], v[96:111]
    buffer_load_dwordx4 a[84:87], v17, s[40:43], s90 offen offset:2048 sc1
    v_cvt_pk_bf16_f32 v41, v86, v87
    v_cvt_pk_bf16_f32 v42, v92, v93
    v_mfma_f32_32x32x16_bf16 v[112:127], v[244:247], a[28:31], v[112:127]
    v_cvt_pk_bf16_f32 v43, v94, v95
    buffer_store_dwordx4 v[40:43], v15, s[40:43], s84 offen offset:1024 sc1
    ds_read_b128 a[16:19], v15 offset:31744
    s_waitcnt lgkmcnt(4)
    v_mfma_f32_32x32x16_bf16 v[96:111], v[248:251], a[0:3], v[96:111]
    buffer_load_dwordx4 a[88:91], v17, s[40:43], s88 offen offset:3072 sc1
    v_mfma_f32_32x32x16_bf16 v[112:127], v[252:255], a[0:3], v[112:127]
    ds_read_b128 a[20:23], v15 offset:32768
    s_waitcnt lgkmcnt(4)
    v_mfma_f32_32x32x16_bf16 v[96:111], v[56:59], a[4:7], v[96:111]
    v_mfma_f32_32x32x16_bf16 v[112:127], v[60:63], a[4:7], v[112:127]
    ds_read_b128 v[44:47], v9 offset:512
    ds_read_b128 a[24:27], v15 offset:33792
    s_waitcnt lgkmcnt(5)
    v_mfma_f32_32x32x16_bf16 v[64:79], a[160:163], a[8:11], 0
    buffer_load_dwordx4 a[92:95], v17, s[40:43], s90 offen offset:3072 sc1
    v_mfma_f32_32x32x16_bf16 v[80:95], a[164:167], a[8:11], 0
    ds_read_b128 a[28:31], v15 offset:34816
    s_waitcnt lgkmcnt(5)
    v_mfma_f32_32x32x16_bf16 v[64:79], a[168:171], a[12:15], v[64:79]
    buffer_load_dwordx4 a[96:99], v18, s[40:43], s88 offen offset:0 sc1
    s_nop 0
    v_mul_f32 v24, v96, v96
    v_mul_f32 v25, v97, v97
    v_mul_f32 v26, v98, v98
    v_mfma_f32_32x32x16_bf16 v[80:95], a[172:175], a[12:15], v[80:95]
    v_mul_f32 v27, v99, v99
    v_mul_f32 v28, v104, v104
    v_mul_f32 v29, v105, v105
    ds_read_b128 a[0:3], v15 offset:35840
    s_waitcnt lgkmcnt(5)
    v_mfma_f32_32x32x16_bf16 v[64:79], a[176:179], a[16:19], v[64:79]
    v_mul_f32 v30, v106, v106
    v_mul_f32 v31, v107, v107
    v_fma_f32 v24, v24, v49, v48
    v_mfma_f32_32x32x16_bf16 v[80:95], a[180:183], a[16:19], v[80:95]
    v_fma_f32 v25, v25, v49, v48
    v_fma_f32 v26, v26, v49, v48
    v_fma_f32 v27, v27, v49, v48
    ds_read_b128 a[4:7], v15 offset:36864
    s_waitcnt lgkmcnt(5)
    v_mfma_f32_32x32x16_bf16 v[64:79], a[184:187], a[20:23], v[64:79]
    buffer_load_dwordx4 a[100:103], v18, s[40:43], s90 offen offset:0 sc1
    v_fma_f32 v28, v28, v49, v48
    v_fma_f32 v29, v29, v49, v48
    v_fma_f32 v30, v30, v49, v48
    v_mfma_f32_32x32x16_bf16 v[80:95], a[188:191], a[20:23], v[80:95]
    v_fma_f32 v31, v31, v49, v48
    v_mul_f32 v24, v24, v96
    v_mul_f32 v25, v25, v97
    ds_read_b128 a[8:11], v15 offset:37888
    s_waitcnt lgkmcnt(4)
    v_mfma_f32_32x32x16_bf16 v[64:79], a[192:195], a[24:27], v[64:79]
    buffer_load_dwordx4 a[104:107], v18, s[40:43], s88 offen offset:1024 sc1
    v_mul_f32 v26, v26, v98
    v_mul_f32 v27, v27, v99
    v_mul_f32 v28, v28, v104
    v_mfma_f32_32x32x16_bf16 v[80:95], a[196:199], a[24:27], v[80:95]
    v_mul_f32 v29, v29, v105
    v_mul_f32 v30, v30, v106
    v_mul_f32 v31, v31, v107
    ds_read_b128 a[12:15], v15 offset:38912
    s_waitcnt lgkmcnt(4)
    v_mfma_f32_32x32x16_bf16 v[64:79], a[200:203], a[28:31], v[64:79]
    v_exp_f32 v24, v24
    v_mul_f32 v100, v100, v96
    v_exp_f32 v25, v25
    v_mfma_f32_32x32x16_bf16 v[80:95], a[204:207], a[28:31], v[80:95]
    v_mul_f32 v101, v101, v97
    v_exp_f32 v26, v26
    v_mul_f32 v102, v102, v98
    ds_read_b128 a[16:19], v15 offset:39936
    s_waitcnt lgkmcnt(4)
    v_mfma_f32_32x32x16_bf16 v[64:79], a[208:211], a[0:3], v[64:79]
    buffer_load_dwordx4 a[108:111], v18, s[40:43], s90 offen offset:1024 sc1
    v_exp_f32 v27, v27
    v_mul_f32 v103, v103, v99
    v_exp_f32 v28, v28
    v_mfma_f32_32x32x16_bf16 v[80:95], a[212:215], a[0:3], v[80:95]
    v_mul_f32 v108, v108, v104
    v_exp_f32 v29, v29
    v_mul_f32 v109, v109, v105
    ds_read_b128 a[20:23], v15 offset:40960
    s_waitcnt lgkmcnt(4)
    v_mfma_f32_32x32x16_bf16 v[64:79], a[216:219], a[4:7], v[64:79]
    buffer_load_dwordx4 a[112:115], v18, s[40:43], s88 offen offset:2048 sc1
    v_exp_f32 v30, v30
    v_mul_f32 v110, v110, v106
    v_exp_f32 v31, v31
    v_mfma_f32_32x32x16_bf16 v[80:95], a[220:223], a[4:7], v[80:95]
    v_mul_f32 v111, v111, v107
    v_fma_f32 v24, v24, v50, v50
    v_fma_f32 v25, v25, v50, v50
    ds_read_b128 a[24:27], v15 offset:41984
    s_waitcnt lgkmcnt(4)
    v_mfma_f32_32x32x16_bf16 v[64:79], a[224:227], a[8:11], v[64:79]
    v_fma_f32 v26, v26, v50, v50
    v_fma_f32 v27, v27, v50, v50
    v_fma_f32 v28, v28, v50, v50
    v_mfma_f32_32x32x16_bf16 v[80:95], a[228:231], a[8:11], v[80:95]
    v_fma_f32 v29, v29, v50, v50
    v_fma_f32 v30, v30, v50, v50
    v_fma_f32 v31, v31, v50, v50
    ds_read_b128 a[28:31], v15 offset:43008
    s_waitcnt lgkmcnt(4)
    v_mfma_f32_32x32x16_bf16 v[64:79], a[232:235], a[12:15], v[64:79]
    buffer_load_dwordx4 a[116:119], v18, s[40:43], s90 offen offset:2048 sc1
    v_rcp_f32 v24, v24
    v_rcp_f32 v25, v25
    v_rcp_f32 v26, v26
    v_mfma_f32_32x32x16_bf16 v[80:95], a[236:239], a[12:15], v[80:95]
    v_rcp_f32 v27, v27
    v_rcp_f32 v28, v28
    v_rcp_f32 v29, v29
    ds_read_b128 a[0:3], v15 offset:44032
    s_waitcnt lgkmcnt(4)
    v_mfma_f32_32x32x16_bf16 v[64:79], a[240:243], a[16:19], v[64:79]
    buffer_load_dwordx4 a[120:123], v18, s[40:43], s88 offen offset:3072 sc1
    v_rcp_f32 v30, v30
    v_rcp_f32 v31, v31
    v_mul_f32 v100, v100, v24
    v_mfma_f32_32x32x16_bf16 v[80:95], a[244:247], a[16:19], v[80:95]
    v_mul_f32 v101, v101, v25
    v_mul_f32 v102, v102, v26
    v_mul_f32 v103, v103, v27
    ds_read_b128 a[4:7], v15 offset:45056
    s_waitcnt lgkmcnt(4)
    v_mfma_f32_32x32x16_bf16 v[64:79], a[248:251], a[20:23], v[64:79]
    v_mul_f32 v108, v108, v28
    v_mul_f32 v109, v109, v29
    v_mul_f32 v110, v110, v30
    v_mfma_f32_32x32x16_bf16 v[80:95], a[252:255], a[20:23], v[80:95]
    v_mul_f32 v111, v111, v31
    v_cvt_pk_bf16_f32 v52, v100, v101
    v_cvt_pk_bf16_f32 v53, v102, v103
    ds_read_b128 a[8:11], v15 offset:46080
    s_waitcnt lgkmcnt(4)
    v_mfma_f32_32x32x16_bf16 v[64:79], v[128:131], a[24:27], v[64:79]
    buffer_load_dwordx4 a[124:127], v18, s[40:43], s90 offen offset:3072 sc1
    v_cvt_pk_bf16_f32 v54, v108, v109
    v_cvt_pk_bf16_f32 v55, v110, v111
    buffer_store_dwordx4 v[52:55], v15, s[40:43], s85 offen offset:0 sc1
    v_mfma_f32_32x32x16_bf16 v[80:95], v[132:135], a[24:27], v[80:95]
    v_mul_f32 v32, v112, v112
    v_mul_f32 v33, v113, v113
    v_mul_f32 v34, v114, v114
    ds_read_b128 a[12:15], v15 offset:47104
    s_waitcnt lgkmcnt(4)
    v_mfma_f32_32x32x16_bf16 v[64:79], v[136:139], a[28:31], v[64:79]
    buffer_load_dwordx4 a[128:131], v19, s[40:43], s88 offen offset:0 sc1
    v_mul_f32 v35, v115, v115
    v_mul_f32 v36, v120, v120
    v_mul_f32 v37, v121, v121
    v_mfma_f32_32x32x16_bf16 v[80:95], v[140:143], a[28:31], v[80:95]
    v_mul_f32 v38, v122, v122
    v_mul_f32 v39, v123, v123
    v_fma_f32 v32, v32, v49, v48
    ds_read_b128 a[16:19], v15 offset:48128
    s_waitcnt lgkmcnt(4)
    v_mfma_f32_32x32x16_bf16 v[64:79], v[144:147], a[0:3], v[64:79]
    v_fma_f32 v33, v33, v49, v48
    v_fma_f32 v34, v34, v49, v48
    v_fma_f32 v35, v35, v49, v48
    v_mfma_f32_32x32x16_bf16 v[80:95], v[148:151], a[0:3], v[80:95]
    v_fma_f32 v36, v36, v49, v48
    v_fma_f32 v37, v37, v49, v48
    v_fma_f32 v38, v38, v49, v48
    ds_read_b128 a[20:23], v15 offset:49152
    s_waitcnt lgkmcnt(4)
    v_mfma_f32_32x32x16_bf16 v[64:79], v[152:155], a[4:7], v[64:79]
    buffer_load_dwordx4 a[132:135], v19, s[40:43], s90 offen offset:0 sc1
    v_fma_f32 v39, v39, v49, v48
    v_mul_f32 v32, v32, v112
    v_mul_f32 v33, v33, v113
    v_mfma_f32_32x32x16_bf16 v[80:95], v[156:159], a[4:7], v[80:95]
    v_mul_f32 v34, v34, v114
    v_mul_f32 v35, v35, v115
    v_mul_f32 v36, v36, v120
    ds_read_b128 a[24:27], v15 offset:50176
    s_waitcnt lgkmcnt(4)
    v_mfma_f32_32x32x16_bf16 v[64:79], v[160:163], a[8:11], v[64:79]
    buffer_load_dwordx4 a[136:139], v19, s[40:43], s88 offen offset:1024 sc1
    v_mul_f32 v37, v37, v121
    v_mul_f32 v38, v38, v122
    v_mul_f32 v39, v39, v123
    v_mfma_f32_32x32x16_bf16 v[80:95], v[164:167], a[8:11], v[80:95]
    v_exp_f32 v32, v32
    v_mul_f32 v116, v116, v112
    v_exp_f32 v33, v33
    ds_read_b128 a[28:31], v15 offset:51200
    s_waitcnt lgkmcnt(4)
    v_mfma_f32_32x32x16_bf16 v[64:79], v[168:171], a[12:15], v[64:79]
    v_mul_f32 v117, v117, v113
    v_exp_f32 v34, v34
    v_mul_f32 v118, v118, v114
    v_mfma_f32_32x32x16_bf16 v[80:95], v[172:175], a[12:15], v[80:95]
    v_exp_f32 v35, v35
    v_mul_f32 v119, v119, v115
    v_exp_f32 v36, v36
    ds_read_b128 a[0:3], v15 offset:52224
    s_waitcnt lgkmcnt(4)
    v_mfma_f32_32x32x16_bf16 v[64:79], v[176:179], a[16:19], v[64:79]
    buffer_load_dwordx4 a[140:143], v19, s[40:43], s90 offen offset:1024 sc1
    v_mul_f32 v124, v124, v120
    v_exp_f32 v37, v37
    v_mul_f32 v125, v125, v121
    v_mfma_f32_32x32x16_bf16 v[80:95], v[180:183], a[16:19], v[80:95]
    v_exp_f32 v38, v38
    v_mul_f32 v126, v126, v122
    v_exp_f32 v39, v39
    ds_read_b128 a[4:7], v15 offset:53248
    s_waitcnt lgkmcnt(4)
    v_mfma_f32_32x32x16_bf16 v[64:79], v[184:187], a[20:23], v[64:79]
    buffer_load_dwordx4 a[144:147], v19, s[40:43], s88 offen offset:2048 sc1
    v_mul_f32 v127, v127, v123
    v_fma_f32 v32, v32, v50, v50
    v_fma_f32 v33, v33, v50, v50
    v_mfma_f32_32x32x16_bf16 v[80:95], v[188:191], a[20:23], v[80:95]
    v_fma_f32 v34, v34, v50, v50
    v_fma_f32 v35, v35, v50, v50
    v_fma_f32 v36, v36, v50, v50
    ds_read_b128 a[8:11], v15 offset:54272
    s_waitcnt lgkmcnt(4)
    v_mfma_f32_32x32x16_bf16 v[64:79], v[192:195], a[24:27], v[64:79]
    v_fma_f32 v37, v37, v50, v50
    v_fma_f32 v38, v38, v50, v50
    v_fma_f32 v39, v39, v50, v50
    v_mfma_f32_32x32x16_bf16 v[80:95], v[196:199], a[24:27], v[80:95]
    v_rcp_f32 v32, v32
    v_rcp_f32 v33, v33
    v_rcp_f32 v34, v34
    ds_read_b128 a[12:15], v15 offset:55296
    s_waitcnt lgkmcnt(4)
    v_mfma_f32_32x32x16_bf16 v[64:79], v[200:203], a[28:31], v[64:79]
    buffer_load_dwordx4 a[148:151], v19, s[40:43], s90 offen offset:2048 sc1
    v_rcp_f32 v35, v35
    v_rcp_f32 v36, v36
    v_rcp_f32 v37, v37
    v_mfma_f32_32x32x16_bf16 v[80:95], v[204:207], a[28:31], v[80:95]
    v_rcp_f32 v38, v38
    v_rcp_f32 v39, v39
    v_mul_f32 v116, v116, v32
    ds_read_b128 a[16:19], v15 offset:56320
    s_waitcnt lgkmcnt(4)
    v_mfma_f32_32x32x16_bf16 v[64:79], v[208:211], a[0:3], v[64:79]
    buffer_load_dwordx4 a[152:155], v19, s[40:43], s88 offen offset:3072 sc1
    v_mul_f32 v117, v117, v33
    v_mul_f32 v118, v118, v34
    v_mul_f32 v119, v119, v35
    v_mfma_f32_32x32x16_bf16 v[80:95], v[212:215], a[0:3], v[80:95]
    v_mul_f32 v124, v124, v36
    v_mul_f32 v125, v125, v37
    v_mul_f32 v126, v126, v38
    ds_read_b128 a[20:23], v15 offset:57344
    s_waitcnt lgkmcnt(4)
    v_mfma_f32_32x32x16_bf16 v[64:79], v[216:219], a[4:7], v[64:79]
    v_mul_f32 v127, v127, v39
    v_cvt_pk_bf16_f32 v40, v116, v117
    v_cvt_pk_bf16_f32 v41, v118, v119
    v_mfma_f32_32x32x16_bf16 v[80:95], v[220:223], a[4:7], v[80:95]
    v_cvt_pk_bf16_f32 v42, v124, v125
    v_cvt_pk_bf16_f32 v43, v126, v127
    buffer_store_dwordx4 v[40:43], v15, s[40:43], s85 offen offset:1024 sc1
    ds_read_b128 a[24:27], v15 offset:58368
    s_waitcnt lgkmcnt(4)
    v_mfma_f32_32x32x16_bf16 v[64:79], v[224:227], a[8:11], v[64:79]
    buffer_load_dwordx4 a[156:159], v19, s[40:43], s90 offen offset:3072 sc1
    v_mfma_f32_32x32x16_bf16 v[80:95], v[228:231], a[8:11], v[80:95]
    s_waitcnt vmcnt(37)
    s_barrier
    ds_read_b128 a[28:31], v10 offset:29696
    s_waitcnt lgkmcnt(4)
    v_mfma_f32_32x32x16_bf16 v[64:79], v[232:235], a[12:15], v[64:79]
    v_mfma_f32_32x32x16_bf16 v[80:95], v[236:239], a[12:15], v[80:95]
    ds_read_b128 a[0:3], v10 offset:30720
    s_waitcnt lgkmcnt(4)
    v_mfma_f32_32x32x16_bf16 v[64:79], v[240:243], a[16:19], v[64:79]
    v_mfma_f32_32x32x16_bf16 v[80:95], v[244:247], a[16:19], v[80:95]
    ds_read_b128 a[4:7], v10 offset:31744
    s_waitcnt lgkmcnt(4)
    v_mfma_f32_32x32x16_bf16 v[64:79], v[248:251], a[20:23], v[64:79]
    v_mfma_f32_32x32x16_bf16 v[80:95], v[252:255], a[20:23], v[80:95]
    ds_read_b128 a[8:11], v10 offset:32768
    s_waitcnt lgkmcnt(4)
    v_mfma_f32_32x32x16_bf16 v[64:79], v[56:59], a[24:27], v[64:79]
    v_mfma_f32_32x32x16_bf16 v[80:95], v[60:63], a[24:27], v[80:95]
    ds_read_b128 v[48:51], v9 offset:1536
    ds_read_b128 a[12:15], v10 offset:33792
    s_waitcnt lgkmcnt(5)
    v_mfma_f32_32x32x16_bf16 v[96:111], a[160:163], a[28:31], 0
    v_mfma_f32_32x32x16_bf16 v[112:127], a[164:167], a[28:31], 0
    ds_read_b128 a[16:19], v10 offset:34816
    s_waitcnt lgkmcnt(5)
    v_mfma_f32_32x32x16_bf16 v[96:111], a[168:171], a[0:3], v[96:111]
    buffer_load_dwordx4 a[160:163], v20, s[40:43], s88 offen offset:0 sc1
    s_nop 1
    v_mul_f32 v24, v64, v64
    v_mul_f32 v25, v65, v65
    v_mfma_f32_32x32x16_bf16 v[112:127], a[172:175], a[0:3], v[112:127]
    v_mul_f32 v26, v66, v66
    v_mul_f32 v27, v67, v67
    v_mul_f32 v28, v72, v72
    ds_read_b128 a[20:23], v10 offset:35840
    s_waitcnt lgkmcnt(5)
    v_mfma_f32_32x32x16_bf16 v[96:111], a[176:179], a[4:7], v[96:111]
    buffer_load_dwordx4 a[164:167], v20, s[40:43], s90 offen offset:0 sc1
    v_mul_f32 v29, v73, v73
    v_mul_f32 v30, v74, v74
    v_mul_f32 v31, v75, v75
    v_mfma_f32_32x32x16_bf16 v[112:127], a[180:183], a[4:7], v[112:127]
    v_fma_f32 v24, v24, v45, v44
    v_fma_f32 v25, v25, v45, v44
    v_fma_f32 v26, v26, v45, v44
    ds_read_b128 a[24:27], v10 offset:36864
    s_waitcnt lgkmcnt(5)
    v_mfma_f32_32x32x16_bf16 v[96:111], a[184:187], a[8:11], v[96:111]
    buffer_load_dwordx4 a[168:171], v20, s[40:43], s88 offen offset:1024 sc1
    buffer_load_dwordx4 a[172:175], v20, s[40:43], s90 offen offset:1024 sc1
    v_fma_f32 v27, v27, v45, v44
    v_fma_f32 v28, v28, v45, v44
    v_fma_f32 v29, v29, v45, v44
    v_mfma_f32_32x32x16_bf16 v[112:127], a[188:191], a[8:11], v[112:127]
    v_fma_f32 v30, v30, v45, v44
    v_fma_f32 v31, v31, v45, v44
    v_mul_f32 v24, v24, v64
    ds_read_b128 a[28:31], v10 offset:37888
    s_waitcnt lgkmcnt(4)
    v_mfma_f32_32x32x16_bf16 v[96:111], a[192:195], a[12:15], v[96:111]
    buffer_load_dwordx4 a[176:179], v20, s[40:43], s88 offen offset:2048 sc1
    v_mul_f32 v25, v25, v65
    v_mul_f32 v26, v26, v66
    v_mul_f32 v27, v27, v67
    v_mfma_f32_32x32x16_bf16 v[112:127], a[196:199], a[12:15], v[112:127]
    v_mul_f32 v28, v28, v72
    v_mul_f32 v29, v29, v73
    v_mul_f32 v30, v30, v74
    ds_read_b128 a[0:3], v10 offset:38912
    s_waitcnt lgkmcnt(4)
    v_mfma_f32_32x32x16_bf16 v[96:111], a[200:203], a[16:19], v[96:111]
    buffer_load_dwordx4 a[180:183], v20, s[40:43], s90 offen offset:2048 sc1
    v_mul_f32 v31, v31, v75
    v_exp_f32 v24, v24
    v_mul_f32 v68, v68, v64
    v_mfma_f32_32x32x16_bf16 v[112:127], a[204:207], a[16:19], v[112:127]
    v_exp_f32 v25, v25
    v_mul_f32 v69, v69, v65
    v_exp_f32 v26, v26
    ds_read_b128 a[4:7], v10 offset:39936
    s_waitcnt lgkmcnt(4)
    v_mfma_f32_32x32x16_bf16 v[96:111], a[208:211], a[20:23], v[96:111]
    buffer_load_dwordx4 a[184:187], v20, s[40:43], s88 offen offset:3072 sc1
    buffer_load_dwordx4 a[188:191], v20, s[40:43], s90 offen offset:3072 sc1
    v_mul_f32 v70, v70, v66
    v_exp_f32 v27, v27
    v_mul_f32 v71, v71, v67
    v_mfma_f32_32x32x16_bf16 v[112:127], a[212:215], a[20:23], v[112:127]
    v_exp_f32 v28, v28
    v_mul_f32 v76, v76, v72
    v_exp_f32 v29, v29
    ds_read_b128 a[8:11], v10 offset:40960
    s_waitcnt lgkmcnt(4)
    v_mfma_f32_32x32x16_bf16 v[96:111], a[216:219], a[24:27], v[96:111]
    buffer_load_dwordx4 a[192:195], v3, s[40:43], s88 offen offset:0 sc1
    v_mul_f32 v77, v77, v73
    v_exp_f32 v30, v30
    v_mul_f32 v78, v78, v74
    v_mfma_f32_32x32x16_bf16 v[112:127], a[220:223], a[24:27], v[112:127]
    v_exp_f32 v31, v31
    v_mul_f32 v79, v79, v75
    v_fma_f32 v24, v24, v46, v46
    ds_read_b128 a[12:15], v10 offset:41984
    s_waitcnt lgkmcnt(4)
    v_mfma_f32_32x32x16_bf16 v[96:111], a[224:227], a[28:31], v[96:111]
    buffer_load_dwordx4 a[196:199], v3, s[40:43], s90 offen offset:0 sc1
    v_fma_f32 v25, v25, v46, v46
    v_fma_f32 v26, v26, v46, v46
    v_fma_f32 v27, v27, v46, v46
    v_mfma_f32_32x32x16_bf16 v[112:127], a[228:231], a[28:31], v[112:127]
    v_fma_f32 v28, v28, v46, v46
    v_fma_f32 v29, v29, v46, v46
    v_fma_f32 v30, v30, v46, v46
    ds_read_b128 a[16:19], v10 offset:43008
    s_waitcnt lgkmcnt(4)
    v_mfma_f32_32x32x16_bf16 v[96:111], a[232:235], a[0:3], v[96:111]
    buffer_load_dwordx4 a[200:203], v3, s[40:43], s88 offen offset:1024 sc1
    buffer_load_dwordx4 a[204:207], v3, s[40:43], s90 offen offset:1024 sc1
    v_fma_f32 v31, v31, v46, v46
    v_rcp_f32 v24, v24
    v_rcp_f32 v25, v25
    v_mfma_f32_32x32x16_bf16 v[112:127], a[236:239], a[0:3], v[112:127]
    v_rcp_f32 v26, v26
    v_rcp_f32 v27, v27
    v_rcp_f32 v28, v28
    ds_read_b128 a[20:23], v10 offset:44032
    s_waitcnt lgkmcnt(4)
    v_mfma_f32_32x32x16_bf16 v[96:111], a[240:243], a[4:7], v[96:111]
    buffer_load_dwordx4 a[208:211], v3, s[40:43], s88 offen offset:2048 sc1
    v_rcp_f32 v29, v29
    v_rcp_f32 v30, v30
    v_rcp_f32 v31, v31
    v_mfma_f32_32x32x16_bf16 v[112:127], a[244:247], a[4:7], v[112:127]
    v_mul_f32 v68, v68, v24
    v_mul_f32 v69, v69, v25
    v_mul_f32 v70, v70, v26
    ds_read_b128 a[24:27], v10 offset:45056
    s_waitcnt lgkmcnt(4)
    v_mfma_f32_32x32x16_bf16 v[96:111], a[248:251], a[8:11], v[96:111]
    buffer_load_dwordx4 a[212:215], v3, s[40:43], s90 offen offset:2048 sc1
    v_mul_f32 v71, v71, v27
    v_mul_f32 v76, v76, v28
    v_mul_f32 v77, v77, v29
    v_mfma_f32_32x32x16_bf16 v[112:127], a[252:255], a[8:11], v[112:127]
    v_mul_f32 v78, v78, v30
    v_mul_f32 v79, v79, v31
    v_cvt_pk_bf16_f32 v52, v68, v69
    ds_read_b128 a[28:31], v10 offset:46080
    s_waitcnt lgkmcnt(4)
    v_mfma_f32_32x32x16_bf16 v[96:111], v[128:131], a[12:15], v[96:111]
    buffer_load_dwordx4 a[216:219], v3, s[40:43], s88 offen offset:3072 sc1
    buffer_load_dwordx4 a[220:223], v3, s[40:43], s90 offen offset:3072 sc1
    v_cvt_pk_bf16_f32 v53, v70, v71
    v_cvt_pk_bf16_f32 v54, v76, v77
    v_cvt_pk_bf16_f32 v55, v78, v79
    v_mfma_f32_32x32x16_bf16 v[112:127], v[132:135], a[12:15], v[112:127]
    buffer_store_dwordx4 v[52:55], v15, s[40:43], s86 offen offset:0 sc1
    v_mul_f32 v32, v80, v80
    v_mul_f32 v33, v81, v81
    ds_read_b128 a[0:3], v10 offset:47104
    s_waitcnt lgkmcnt(4)
    v_mfma_f32_32x32x16_bf16 v[96:111], v[136:139], a[16:19], v[96:111]
    buffer_load_dwordx4 a[224:227], v4, s[40:43], s88 offen offset:0 sc1
    v_mul_f32 v34, v82, v82
    v_mul_f32 v35, v83, v83
    v_mul_f32 v36, v88, v88
    v_mfma_f32_32x32x16_bf16 v[112:127], v[140:143], a[16:19], v[112:127]
    v_mul_f32 v37, v89, v89
    v_mul_f32 v38, v90, v90
    v_mul_f32 v39, v91, v91
    ds_read_b128 a[4:7], v10 offset:48128
    s_waitcnt lgkmcnt(4)
    v_mfma_f32_32x32x16_bf16 v[96:111], v[144:147], a[20:23], v[96:111]
    buffer_load_dwordx4 a[228:231], v4, s[40:43], s90 offen offset:0 sc1
    v_fma_f32 v32, v32, v45, v44
    v_fma_f32 v33, v33, v45, v44
    v_fma_f32 v34, v34, v45, v44
    v_mfma_f32_32x32x16_bf16 v[112:127], v[148:151], a[20:23], v[112:127]
    v_fma_f32 v35, v35, v45, v44
    v_fma_f32 v36, v36, v45, v44
    v_fma_f32 v37, v37, v45, v44
    ds_read_b128 a[8:11], v10 offset:49152
    s_waitcnt lgkmcnt(4)
    v_mfma_f32_32x32x16_bf16 v[96:111], v[152:155], a[24:27], v[96:111]
    buffer_load_dwordx4 a[232:235], v4, s[40:43], s88 offen offset:1024 sc1
    buffer_load_dwordx4 a[236:239], v4, s[40:43], s90 offen offset:1024 sc1
    v_fma_f32 v38, v38, v45, v44
    v_fma_f32 v39, v39, v45, v44
    v_mul_f32 v32, v32, v80
    v_mfma_f32_32x32x16_bf16 v[112:127], v[156:159], a[24:27], v[112:127]
    v_mul_f32 v33, v33, v81
    v_mul_f32 v34, v34, v82
    v_mul_f32 v35, v35, v83
    ds_read_b128 a[12:15], v10 offset:50176
    s_waitcnt lgkmcnt(4)
    v_mfma_f32_32x32x16_bf16 v[96:111], v[160:163], a[28:31], v[96:111]
    buffer_load_dwordx4 a[240:243], v4, s[40:43], s88 offen offset:2048 sc1
    v_mul_f32 v36, v36, v88
    v_mul_f32 v37, v37, v89
    v_mul_f32 v38, v38, v90
    v_mfma_f32_32x32x16_bf16 v[112:127], v[164:167], a[28:31], v[112:127]
    v_mul_f32 v39, v39, v91
    v_exp_f32 v32, v32
    v_mul_f32 v84, v84, v80
    ds_read_b128 a[16:19], v10 offset:51200
    s_waitcnt lgkmcnt(4)
    v_mfma_f32_32x32x16_bf16 v[96:111], v[168:171], a[0:3], v[96:111]
    buffer_load_dwordx4 a[244:247], v4, s[40:43], s90 offen offset:2048 sc1
    v_exp_f32 v33, v33
    v_mul_f32 v85, v85, v81
    v_exp_f32 v34, v34
    v_mfma_f32_32x32x16_bf16 v[112:127], v[172:175], a[0:3], v[112:127]
    v_mul_f32 v86, v86, v82
    v_exp_f32 v35, v35
    v_mul_f32 v87, v87, v83
    ds_read_b128 a[20:23], v10 offset:52224
    s_waitcnt lgkmcnt(4)
    v_mfma_f32_32x32x16_bf16 v[96:111], v[176:179], a[4:7], v[96:111]
    buffer_load_dwordx4 a[248:251], v4, s[40:43], s88 offen offset:3072 sc1
    buffer_load_dwordx4 a[252:255], v4, s[40:43], s90 offen offset:3072 sc1
    v_exp_f32 v36, v36
    v_mul_f32 v92, v92, v88
    v_exp_f32 v37, v37
    v_mfma_f32_32x32x16_bf16 v[112:127], v[180:183], a[4:7], v[112:127]
    v_mul_f32 v93, v93, v89
    v_exp_f32 v38, v38
    s_waitcnt vmcnt(26)
    s_mov_b64 exec, 1
    buffer_store_dword v22, v21, s[40:43], s72 offen sc1
    s_mov_b64 exec, -1
    ds_read_b128 a[24:27], v10 offset:53248
    s_waitcnt lgkmcnt(4)
    v_mfma_f32_32x32x16_bf16 v[96:111], v[184:187], a[8:11], v[96:111]
    v_mul_f32 v94, v94, v90
    v_exp_f32 v39, v39
    v_mfma_f32_32x32x16_bf16 v[112:127], v[188:191], a[8:11], v[112:127]
    v_mul_f32 v95, v95, v91
    v_fma_f32 v32, v32, v46, v46
    ds_read_b128 a[28:31], v10 offset:54272
    s_waitcnt lgkmcnt(4)
    v_mfma_f32_32x32x16_bf16 v[96:111], v[192:195], a[12:15], v[96:111]
    v_fma_f32 v33, v33, v46, v46
    v_fma_f32 v34, v34, v46, v46
    v_mfma_f32_32x32x16_bf16 v[112:127], v[196:199], a[12:15], v[112:127]
    v_fma_f32 v35, v35, v46, v46
    v_fma_f32 v36, v36, v46, v46
    ds_read_b128 a[0:3], v10 offset:55296
    s_waitcnt lgkmcnt(4)
    v_mfma_f32_32x32x16_bf16 v[96:111], v[200:203], a[16:19], v[96:111]
    v_fma_f32 v37, v37, v46, v46
    v_fma_f32 v38, v38, v46, v46
    v_mfma_f32_32x32x16_bf16 v[112:127], v[204:207], a[16:19], v[112:127]
    v_fma_f32 v39, v39, v46, v46
    v_rcp_f32 v32, v32
    ds_read_b128 a[4:7], v10 offset:56320
    s_waitcnt lgkmcnt(4)
    v_mfma_f32_32x32x16_bf16 v[96:111], v[208:211], a[20:23], v[96:111]
    v_rcp_f32 v33, v33
    v_rcp_f32 v34, v34
    v_mfma_f32_32x32x16_bf16 v[112:127], v[212:215], a[20:23], v[112:127]
    v_rcp_f32 v35, v35
    v_rcp_f32 v36, v36
    ds_read_b128 a[8:11], v10 offset:57344
    s_waitcnt lgkmcnt(4)
    v_mfma_f32_32x32x16_bf16 v[96:111], v[216:219], a[24:27], v[96:111]
    v_rcp_f32 v37, v37
    v_rcp_f32 v38, v38
    v_mfma_f32_32x32x16_bf16 v[112:127], v[220:223], a[24:27], v[112:127]
    v_rcp_f32 v39, v39
    v_mul_f32 v84, v84, v32
    ds_read_b128 a[12:15], v10 offset:58368
    s_waitcnt lgkmcnt(4)
    v_mfma_f32_32x32x16_bf16 v[96:111], v[224:227], a[28:31], v[96:111]
    v_mul_f32 v85, v85, v33
    v_mul_f32 v86, v86, v34
    v_mfma_f32_32x32x16_bf16 v[112:127], v[228:231], a[28:31], v[112:127]
    v_mul_f32 v87, v87, v35
    v_mul_f32 v92, v92, v36
    s_waitcnt lgkmcnt(3)
    v_mfma_f32_32x32x16_bf16 v[96:111], v[232:235], a[0:3], v[96:111]
    v_mul_f32 v93, v93, v37
    v_mul_f32 v94, v94, v38
    v_mfma_f32_32x32x16_bf16 v[112:127], v[236:239], a[0:3], v[112:127]
    v_mul_f32 v95, v95, v39
    v_cvt_pk_bf16_f32 v40, v84, v85
    s_waitcnt lgkmcnt(2)
    v_mfma_f32_32x32x16_bf16 v[96:111], v[240:243], a[4:7], v[96:111]
    v_cvt_pk_bf16_f32 v41, v86, v87
    v_cvt_pk_bf16_f32 v42, v92, v93
    v_mfma_f32_32x32x16_bf16 v[112:127], v[244:247], a[4:7], v[112:127]
    v_cvt_pk_bf16_f32 v43, v94, v95
    buffer_store_dwordx4 v[40:43], v15, s[40:43], s86 offen offset:1024 sc1
    s_waitcnt lgkmcnt(1)
    v_mfma_f32_32x32x16_bf16 v[96:111], v[248:251], a[8:11], v[96:111]
    v_mfma_f32_32x32x16_bf16 v[112:127], v[252:255], a[8:11], v[112:127]
    s_waitcnt lgkmcnt(0)
    v_mfma_f32_32x32x16_bf16 v[96:111], v[56:59], a[12:15], v[96:111]
    v_mfma_f32_32x32x16_bf16 v[112:127], v[60:63], a[12:15], v[112:127]
    s_nop 10
    v_mul_f32 v24, v96, v96
    v_mul_f32 v32, v112, v112
    v_mul_f32 v25, v97, v97
    v_mul_f32 v33, v113, v113
    v_mul_f32 v26, v98, v98
    v_mul_f32 v34, v114, v114
    v_mul_f32 v27, v99, v99
    v_mul_f32 v35, v115, v115
    v_mul_f32 v28, v104, v104
    v_mul_f32 v36, v120, v120
    v_mul_f32 v29, v105, v105
    v_mul_f32 v37, v121, v121
    v_mul_f32 v30, v106, v106
    v_mul_f32 v38, v122, v122
    v_mul_f32 v31, v107, v107
    v_mul_f32 v39, v123, v123
    v_fma_f32 v24, v24, v49, v48
    v_fma_f32 v32, v32, v49, v48
    v_fma_f32 v25, v25, v49, v48
    v_fma_f32 v33, v33, v49, v48
    v_fma_f32 v26, v26, v49, v48
    v_fma_f32 v34, v34, v49, v48
    v_fma_f32 v27, v27, v49, v48
    v_fma_f32 v35, v35, v49, v48
    v_fma_f32 v28, v28, v49, v48
    v_fma_f32 v36, v36, v49, v48
    v_fma_f32 v29, v29, v49, v48
    v_fma_f32 v37, v37, v49, v48
    v_fma_f32 v30, v30, v49, v48
    v_fma_f32 v38, v38, v49, v48
    v_fma_f32 v31, v31, v49, v48
    v_fma_f32 v39, v39, v49, v48
    v_mul_f32 v24, v24, v96
    v_mul_f32 v32, v32, v112
    v_mul_f32 v25, v25, v97
    v_mul_f32 v33, v33, v113
    v_mul_f32 v26, v26, v98
    v_mul_f32 v34, v34, v114
    v_mul_f32 v27, v27, v99
    v_mul_f32 v35, v35, v115
    v_mul_f32 v28, v28, v104
    v_mul_f32 v36, v36, v120
    v_mul_f32 v29, v29, v105
    v_mul_f32 v37, v37, v121
    v_mul_f32 v30, v30, v106
    v_mul_f32 v38, v38, v122
    v_mul_f32 v31, v31, v107
    v_mul_f32 v39, v39, v123
    v_exp_f32 v24, v24
    v_exp_f32 v32, v32
    v_mul_f32 v100, v100, v96
    v_mul_f32 v116, v116, v112
    v_exp_f32 v25, v25
    v_exp_f32 v33, v33
    v_mul_f32 v101, v101, v97
    v_mul_f32 v117, v117, v113
    v_exp_f32 v26, v26
    v_exp_f32 v34, v34
    v_mul_f32 v102, v102, v98
    v_mul_f32 v118, v118, v114
    v_exp_f32 v27, v27
    v_exp_f32 v35, v35
    v_mul_f32 v103, v103, v99
    v_mul_f32 v119, v119, v115
    v_exp_f32 v28, v28
    v_exp_f32 v36, v36
    v_mul_f32 v108, v108, v104
    v_mul_f32 v124, v124, v120
    v_exp_f32 v29, v29
    v_exp_f32 v37, v37
    v_mul_f32 v109, v109, v105
    v_mul_f32 v125, v125, v121
    v_exp_f32 v30, v30
    v_exp_f32 v38, v38
    v_mul_f32 v110, v110, v106
    v_mul_f32 v126, v126, v122
    v_exp_f32 v31, v31
    v_exp_f32 v39, v39
    v_mul_f32 v111, v111, v107
    v_mul_f32 v127, v127, v123
    v_fma_f32 v24, v24, v50, v50
    v_fma_f32 v32, v32, v50, v50
    v_fma_f32 v25, v25, v50, v50
    v_fma_f32 v33, v33, v50, v50
    v_fma_f32 v26, v26, v50, v50
    v_fma_f32 v34, v34, v50, v50
    v_fma_f32 v27, v27, v50, v50
    v_fma_f32 v35, v35, v50, v50
    v_fma_f32 v28, v28, v50, v50
    v_fma_f32 v36, v36, v50, v50
    v_fma_f32 v29, v29, v50, v50
    v_fma_f32 v37, v37, v50, v50
    v_fma_f32 v30, v30, v50, v50
    v_fma_f32 v38, v38, v50, v50
    v_fma_f32 v31, v31, v50, v50
    v_fma_f32 v39, v39, v50, v50
    v_rcp_f32 v24, v24
    v_rcp_f32 v32, v32
    v_rcp_f32 v25, v25
    v_rcp_f32 v33, v33
    v_rcp_f32 v26, v26
    v_rcp_f32 v34, v34
    v_rcp_f32 v27, v27
    v_rcp_f32 v35, v35
    v_rcp_f32 v28, v28
    v_rcp_f32 v36, v36
    v_rcp_f32 v29, v29
    v_rcp_f32 v37, v37
    v_rcp_f32 v30, v30
    v_rcp_f32 v38, v38
    v_rcp_f32 v31, v31
    v_rcp_f32 v39, v39
    v_mul_f32 v100, v100, v24
    v_mul_f32 v116, v116, v32
    v_mul_f32 v101, v101, v25
    v_mul_f32 v117, v117, v33
    v_mul_f32 v102, v102, v26
    v_mul_f32 v118, v118, v34
    v_mul_f32 v103, v103, v27
    v_mul_f32 v119, v119, v35
    v_mul_f32 v108, v108, v28
    v_mul_f32 v124, v124, v36
    v_mul_f32 v109, v109, v29
    v_mul_f32 v125, v125, v37
    v_mul_f32 v110, v110, v30
    v_mul_f32 v126, v126, v38
    v_mul_f32 v111, v111, v31
    v_mul_f32 v127, v127, v39
    v_cvt_pk_bf16_f32 v52, v100, v101
    v_cvt_pk_bf16_f32 v40, v116, v117
    v_cvt_pk_bf16_f32 v53, v102, v103
    v_cvt_pk_bf16_f32 v41, v118, v119
    v_cvt_pk_bf16_f32 v54, v108, v109
    v_cvt_pk_bf16_f32 v42, v124, v125
    v_cvt_pk_bf16_f32 v55, v110, v111
    v_cvt_pk_bf16_f32 v43, v126, v127
    buffer_store_dwordx4 v[52:55], v15, s[40:43], s87 offen offset:0 sc1
    buffer_store_dwordx4 v[40:43], v15, s[40:43], s87 offen offset:1024 sc1
    buffer_load_dword v5, v13, s[40:43], s74 offen sc1
    s_lshl_b32 s86, s5, 2
    s_lshl_b32 s9, s82, 1
    s_add_u32 s86, s86, s9
    s_add_u32 s84, s86, s81
    s_mul_i32 s62, s86, 112
    s_mul_i32 s9, s4, 28
    s_add_u32 s62, s62, s9
    s_lshl_b32 s62, s62, 10
    s_add_u32 s62, s62, 20971520
    s_add_u32 s63, s62, 114688
    s_lshl_b32 s9, s79, 7
    s_add_u32 s9, s9, 162048
    v_lshl_add_u32 v2, v6, 4, s9
    s_mul_i32 s64, s84, 14
    s_add_u32 s64, s64, s79
    s_lshl_b32 s64, s64, 11
    s_add_u32 s64, s64, 12582912
    s_lshl_b32 s61, s4, 14
    v_add_u32 v9, s61, v15
    ds_read_b128 v[200:203], v2 offset:0
    ds_read_b128 v[204:207], v2 offset:32
    ds_read_b128 v[208:211], v2 offset:64
    ds_read_b128 v[212:215], v2 offset:96
    s_xor_b32 s9, s4, 1
    s_lshl_b32 s9, s9, 14
    v_add_u32 v10, s9, v15
    s_xor_b32 s9, s4, 2
    s_lshl_b32 s9, s9, 14
    v_add_u32 v11, s9, v15
    s_xor_b32 s9, s4, 3
    s_lshl_b32 s9, s9, 14
    v_add_u32 v12, s9, v15
    s_mov_b32 s44, s34
    s_mov_b32 s45, s35
    s_mov_b32 s46, 1835008
    s_mov_b32 s47, 0x20000
    v_and_b32 v7, 31, v1
    s_movk_i32 s9, 896
    v_mul_lo_u32 v7, v7, s9
    v_lshl_add_u32 v7, v6, 4, v7
    s_mul_i32 s68, s84, 28672
    s_lshl_b32 s9, s79, 6
    s_add_u32 s68, s68, s9
    s_waitcnt vmcnt(1)
    s_mov_b64 exec, 1
    buffer_store_dword v22, v21, s[40:43], s73 offen sc1
    s_mov_b64 exec, -1
    s_waitcnt vmcnt(1)
    s_mov_b64 exec, 0x3fff
    v_cmp_ne_u32 vcc, s3, v5
    s_mov_b64 exec, -1
    s_cbranch_vccz L_FH1
    s_mov_b64 exec, 0x3fff
    s_mov_b32 s9, 0
LP_9:
    buffer_load_dword v2, v13, s[40:43], s74 offen sc1
    s_add_u32 s9, s9, 1
    s_cmp_gt_u32 s9, 0x4000
    s_cbranch_scc1 L_ABORT
    s_waitcnt vmcnt(0)
    v_cmp_ne_u32 vcc, s3, v2
    s_cbranch_vccz LD_10
    s_sleep 4
    s_branch LP_9
LD_10:
    s_mov_b64 exec, -1
L_FH1:
    buffer_load_dwordx4 v[24:27], v14, s[40:43], s62 offen offset:0 sc1
    buffer_load_dwordx4 v[28:31], v14, s[40:43], s62 offen offset:1024 sc1
    buffer_load_dwordx4 v[32:35], v14, s[40:43], s62 offen offset:2048 sc1
    buffer_load_dwordx4 v[36:39], v14, s[40:43], s62 offen offset:3072 sc1
    buffer_load_dwordx4 v[40:43], v17, s[40:43], s62 offen offset:0 sc1
    buffer_load_dwordx4 v[44:47], v17, s[40:43], s62 offen offset:1024 sc1
    buffer_load_dwordx4 v[48:51], v17, s[40:43], s62 offen offset:2048 sc1
    buffer_load_dwordx4 v[52:55], v17, s[40:43], s62 offen offset:3072 sc1
    buffer_load_dwordx4 v[56:59], v18, s[40:43], s62 offen offset:0 sc1
    buffer_load_dwordx4 v[60:63], v18, s[40:43], s62 offen offset:1024 sc1
    buffer_load_dwordx4 v[216:219], v15, s[40:43], s64 offen sc1
    buffer_load_dwordx4 v[220:223], v15, s[40:43], s64 offen offset:1024 sc1
    s_barrier
    s_waitcnt vmcnt(11)
    v_mfma_f32_32x32x16_bf16 v[128:143], a[32:35], v[24:27], 0
    buffer_load_dwordx4 v[64:67], v18, s[40:43], s62 offen offset:2048 sc1
    v_mfma_f32_32x32x16_bf16 v[144:159], a[36:39], v[24:27], 0
    s_waitcnt vmcnt(11)
    v_mfma_f32_32x32x16_bf16 v[128:143], a[40:43], v[28:31], v[128:143]
    buffer_load_dwordx4 v[68:71], v18, s[40:43], s62 offen offset:3072 sc1
    v_mfma_f32_32x32x16_bf16 v[144:159], a[44:47], v[28:31], v[144:159]
    s_waitcnt vmcnt(11)
    v_mfma_f32_32x32x16_bf16 v[128:143], a[48:51], v[32:35], v[128:143]
    buffer_load_dwordx4 v[72:75], v19, s[40:43], s62 offen offset:0 sc1
    v_mfma_f32_32x32x16_bf16 v[144:159], a[52:55], v[32:35], v[144:159]
    s_waitcnt vmcnt(11)
    v_mfma_f32_32x32x16_bf16 v[128:143], a[56:59], v[36:39], v[128:143]
    buffer_load_dwordx4 v[76:79], v19, s[40:43], s62 offen offset:1024 sc1
    v_mfma_f32_32x32x16_bf16 v[144:159], a[60:63], v[36:39], v[144:159]
    s_waitcnt vmcnt(11)
    v_mfma_f32_32x32x16_bf16 v[128:143], a[64:67], v[40:43], v[128:143]
    buffer_load_dwordx4 v[80:83], v19, s[40:43], s62 offen offset:2048 sc1
    v_mfma_f32_32x32x16_bf16 v[144:159], a[68:71], v[40:43], v[144:159]
    s_waitcnt vmcnt(11)
    v_mfma_f32_32x32x16_bf16 v[128:143], a[72:75], v[44:47], v[128:143]
    buffer_load_dwordx4 v[84:87], v19, s[40:43], s62 offen offset:3072 sc1
    v_mfma_f32_32x32x16_bf16 v[144:159], a[76:79], v[44:47], v[144:159]
    s_waitcnt vmcnt(11)
    v_mfma_f32_32x32x16_bf16 v[128:143], a[80:83], v[48:51], v[128:143]
    buffer_load_dwordx4 v[88:91], v20, s[40:43], s62 offen offset:0 sc1
    v_mfma_f32_32x32x16_bf16 v[144:159], a[84:87], v[48:51], v[144:159]
    s_waitcnt vmcnt(11)
    v_mfma_f32_32x32x16_bf16 v[128:143], a[88:91], v[52:55], v[128:143]
    buffer_load_dwordx4 v[92:95], v20, s[40:43], s62 offen offset:1024 sc1
    v_mfma_f32_32x32x16_bf16 v[144:159], a[92:95], v[52:55], v[144:159]
    s_waitcnt vmcnt(11)
    v_mfma_f32_32x32x16_bf16 v[128:143], a[96:99], v[56:59], v[128:143]
    buffer_load_dwordx4 v[96:99], v20, s[40:43], s62 offen offset:2048 sc1
    v_mfma_f32_32x32x16_bf16 v[144:159], a[100:103], v[56:59], v[144:159]
    s_waitcnt vmcnt(11)
    v_mfma_f32_32x32x16_bf16 v[128:143], a[104:107], v[60:63], v[128:143]
    buffer_load_dwordx4 v[100:103], v20, s[40:43], s62 offen offset:3072 sc1
    v_mfma_f32_32x32x16_bf16 v[144:159], a[108:111], v[60:63], v[144:159]
    s_waitcnt vmcnt(9)
    v_mfma_f32_32x32x16_bf16 v[128:143], a[112:115], v[64:67], v[128:143]
    buffer_load_dwordx4 v[104:107], v3, s[40:43], s62 offen offset:0 sc1
    v_mfma_f32_32x32x16_bf16 v[144:159], a[116:119], v[64:67], v[144:159]
    s_waitcnt vmcnt(9)
    v_mfma_f32_32x32x16_bf16 v[128:143], a[120:123], v[68:71], v[128:143]
    buffer_load_dwordx4 v[108:111], v3, s[40:43], s62 offen offset:1024 sc1
    v_mfma_f32_32x32x16_bf16 v[144:159], a[124:127], v[68:71], v[144:159]
    s_waitcnt vmcnt(9)
    v_mfma_f32_32x32x16_bf16 v[128:143], a[128:131], v[72:75], v[128:143]
    buffer_load_dwordx4 v[112:115], v3, s[40:43], s62 offen offset:2048 sc1
    v_mfma_f32_32x32x16_bf16 v[144:159], a[132:135], v[72:75], v[144:159]
    s_waitcnt vmcnt(9)
    v_mfma_f32_32x32x16_bf16 v[128:143], a[136:139], v[76:79], v[128:143]
    buffer_load_dwordx4 v[116:119], v3, s[40:43], s62 offen offset:3072 sc1
    v_mfma_f32_32x32x16_bf16 v[144:159], a[140:143], v[76:79], v[144:159]
    s_waitcnt vmcnt(9)
    v_mfma_f32_32x32x16_bf16 v[128:143], a[144:147], v[80:83], v[128:143]
    buffer_load_dwordx4 v[120:123], v4, s[40:43], s62 offen offset:0 sc1
    v_mfma_f32_32x32x16_bf16 v[144:159], a[148:151], v[80:83], v[144:159]
    s_waitcnt vmcnt(9)
    v_mfma_f32_32x32x16_bf16 v[128:143], a[152:155], v[84:87], v[128:143]
    buffer_load_dwordx4 v[124:127], v4, s[40:43], s62 offen offset:1024 sc1
    v_mfma_f32_32x32x16_bf16 v[144:159], a[156:159], v[84:87], v[144:159]
    s_waitcnt vmcnt(9)
    v_mfma_f32_32x32x16_bf16 v[128:143], a[160:163], v[88:91], v[128:143]
    buffer_load_dwordx4 v[24:27], v4, s[40:43], s62 offen offset:2048 sc1
    v_mfma_f32_32x32x16_bf16 v[144:159], a[164:167], v[88:91], v[144:159]
    s_waitcnt vmcnt(9)
    v_mfma_f32_32x32x16_bf16 v[128:143], a[168:171], v[92:95], v[128:143]
    buffer_load_dwordx4 v[28:31], v4, s[40:43], s62 offen offset:3072 sc1
    v_mfma_f32_32x32x16_bf16 v[144:159], a[172:175], v[92:95], v[144:159]
    s_waitcnt vmcnt(9)
    v_mfma_f32_32x32x16_bf16 v[128:143], a[176:179], v[96:99], v[128:143]
    v_mfma_f32_32x32x16_bf16 v[144:159], a[180:183], v[96:99], v[144:159]
    s_waitcnt vmcnt(8)
    v_mfma_f32_32x32x16_bf16 v[128:143], a[184:187], v[100:103], v[128:143]
    v_mfma_f32_32x32x16_bf16 v[144:159], a[188:191], v[100:103], v[144:159]
    s_waitcnt vmcnt(7)
    v_mfma_f32_32x32x16_bf16 v[128:143], a[192:195], v[104:107], v[128:143]
    v_mfma_f32_32x32x16_bf16 v[144:159], a[196:199], v[104:107], v[144:159]
    s_waitcnt vmcnt(6)
    v_mfma_f32_32x32x16_bf16 v[128:143], a[200:203], v[108:111], v[128:143]
    v_mfma_f32_32x32x16_bf16 v[144:159], a[204:207], v[108:111], v[144:159]
    s_waitcnt vmcnt(5)
    v_mfma_f32_32x32x16_bf16 v[128:143], a[208:211], v[112:115], v[128:143]
    buffer_load_dword v5, v13, s[40:43], s75 offen sc1
    v_mfma_f32_32x32x16_bf16 v[144:159], a[212:215], v[112:115], v[144:159]
    s_waitcnt vmcnt(5)
    v_mfma_f32_32x32x16_bf16 v[128:143], a[216:219], v[116:119], v[128:143]
    v_mfma_f32_32x32x16_bf16 v[144:159], a[220:223], v[116:119], v[144:159]
    s_waitcnt vmcnt(4)
    v_mfma_f32_32x32x16_bf16 v[128:143], a[224:227], v[120:123], v[128:143]
    v_mfma_f32_32x32x16_bf16 v[144:159], a[228:231], v[120:123], v[144:159]
    s_waitcnt vmcnt(3)
    v_mfma_f32_32x32x16_bf16 v[128:143], a[232:235], v[124:127], v[128:143]
    v_mfma_f32_32x32x16_bf16 v[144:159], a[236:239], v[124:127], v[144:159]
    s_waitcnt vmcnt(2)
    v_mfma_f32_32x32x16_bf16 v[128:143], a[240:243], v[24:27], v[128:143]
    v_mfma_f32_32x32x16_bf16 v[144:159], a[244:247], v[24:27], v[144:159]
    s_waitcnt vmcnt(1)
    v_mfma_f32_32x32x16_bf16 v[128:143], a[248:251], v[28:31], v[128:143]
    v_mfma_f32_32x32x16_bf16 v[144:159], a[252:255], v[28:31], v[144:159]
    s_cmp_lg_u32 s81, 0
    s_cbranch_scc1 L_DW1
    s_nop 9
    ds_write_b128 v9, v[144:147] offset:0
    ds_write_b128 v9, v[148:151] offset:1024
    ds_write_b128 v9, v[152:155] offset:2048
    ds_write_b128 v9, v[156:159] offset:3072
    s_branch L_DW2
L_DW1:
    s_nop 8
    ds_write_b128 v9, v[128:131] offset:4096
    ds_write_b128 v9, v[132:135] offset:5120
    ds_write_b128 v9, v[136:139] offset:6144
    ds_write_b128 v9, v[140:143] offset:7168
    ds_write_b128 v9, v[144:147] offset:8192
    ds_write_b128 v9, v[148:151] offset:9216
    ds_write_b128 v9, v[152:155] offset:10240
    ds_write_b128 v9, v[156:159] offset:11264
L_DW2:
    s_waitcnt vmcnt(0)
    s_mov_b64 exec, 0x3fff
    v_cmp_ne_u32 vcc, s3, v5
    s_mov_b64 exec, -1
    s_cbranch_vccz L_FH2
    s_mov_b64 exec, 0x3fff
    s_mov_b32 s9, 0
LP_11:
    buffer_load_dword v2, v13, s[40:43], s75 offen sc1
    s_add_u32 s9, s9, 1
    s_cmp_gt_u32 s9, 0x4000
    s_cbranch_scc1 L_ABORT
    s_waitcnt vmcnt(0)
    v_cmp_ne_u32 vcc, s3, v2
    s_cbranch_vccz LD_12
    s_sleep 4
    s_branch LP_11
LD_12:
    s_mov_b64 exec, -1
L_FH2:
    buffer_load_dwordx4 v[32:35], v14, s[40:43], s63 offen offset:0 sc1
    buffer_load_dwordx4 v[36:39], v14, s[40:43], s63 offen offset:1024 sc1
    buffer_load_dwordx4 v[40:43], v14, s[40:43], s63 offen offset:2048 sc1
    buffer_load_dwordx4 v[44:47], v14, s[40:43], s63 offen offset:3072 sc1
    buffer_load_dwordx4 v[48:51], v17, s[40:43], s63 offen offset:0 sc1
    buffer_load_dwordx4 v[52:55], v17, s[40:43], s63 offen offset:1024 sc1
    buffer_load_dwordx4 v[56:59], v17, s[40:43], s63 offen offset:2048 sc1
    buffer_load_dwordx4 v[60:63], v17, s[40:43], s63 offen offset:3072 sc1
    buffer_load_dwordx4 v[64:67], v18, s[40:43], s63 offen offset:0 sc1
    buffer_load_dwordx4 v[68:71], v18, s[40:43], s63 offen offset:1024 sc1
    v_lshlrev_b32 v224, 16, v216
    v_and_b32 v225, s56, v216
    v_lshlrev_b32 v226, 16, v217
    v_and_b32 v227, s56, v217
    v_lshlrev_b32 v228, 16, v218
    v_and_b32 v229, s56, v218
    v_lshlrev_b32 v230, 16, v219
    v_and_b32 v231, s56, v219
    v_lshlrev_b32 v232, 16, v220
    v_and_b32 v233, s56, v220
    v_lshlrev_b32 v234, 16, v221
    v_and_b32 v235, s56, v221
    v_lshlrev_b32 v236, 16, v222
    v_and_b32 v237, s56, v222
    v_lshlrev_b32 v238, 16, v223
    v_and_b32 v239, s56, v223
    s_waitcnt vmcnt(9)
    v_mfma_f32_32x32x16_bf16 v[160:175], a[32:35], v[32:35], 0
    buffer_load_dwordx4 v[72:75], v18, s[40:43], s63 offen offset:2048 sc1
    v_mfma_f32_32x32x16_bf16 v[176:191], a[36:39], v[32:35], 0
    s_waitcnt vmcnt(9)
    v_mfma_f32_32x32x16_bf16 v[160:175], a[40:43], v[36:39], v[160:175]
    buffer_load_dwordx4 v[76:79], v18, s[40:43], s63 offen offset:3072 sc1
    v_mfma_f32_32x32x16_bf16 v[176:191], a[44:47], v[36:39], v[176:191]
    s_waitcnt vmcnt(9)
    v_mfma_f32_32x32x16_bf16 v[160:175], a[48:51], v[40:43], v[160:175]
    buffer_load_dwordx4 v[80:83], v19, s[40:43], s63 offen offset:0 sc1
    v_mfma_f32_32x32x16_bf16 v[176:191], a[52:55], v[40:43], v[176:191]
    s_waitcnt vmcnt(9)
    v_mfma_f32_32x32x16_bf16 v[160:175], a[56:59], v[44:47], v[160:175]
    buffer_load_dwordx4 v[84:87], v19, s[40:43], s63 offen offset:1024 sc1
    v_mfma_f32_32x32x16_bf16 v[176:191], a[60:63], v[44:47], v[176:191]
    s_waitcnt vmcnt(9)
    v_mfma_f32_32x32x16_bf16 v[160:175], a[64:67], v[48:51], v[160:175]
    buffer_load_dwordx4 v[88:91], v19, s[40:43], s63 offen offset:2048 sc1
    v_mfma_f32_32x32x16_bf16 v[176:191], a[68:71], v[48:51], v[176:191]
    s_waitcnt vmcnt(9)
    v_mfma_f32_32x32x16_bf16 v[160:175], a[72:75], v[52:55], v[160:175]
    buffer_load_dwordx4 v[92:95], v19, s[40:43], s63 offen offset:3072 sc1
    v_mfma_f32_32x32x16_bf16 v[176:191], a[76:79], v[52:55], v[176:191]
    s_waitcnt vmcnt(9)
    v_mfma_f32_32x32x16_bf16 v[160:175], a[80:83], v[56:59], v[160:175]
    buffer_load_dwordx4 v[96:99], v20, s[40:43], s63 offen offset:0 sc1
    v_mfma_f32_32x32x16_bf16 v[176:191], a[84:87], v[56:59], v[176:191]
    s_waitcnt vmcnt(9)
    v_mfma_f32_32x32x16_bf16 v[160:175], a[88:91], v[60:63], v[160:175]
    buffer_load_dwordx4 v[100:103], v20, s[40:43], s63 offen offset:1024 sc1
    v_mfma_f32_32x32x16_bf16 v[176:191], a[92:95], v[60:63], v[176:191]
    s_waitcnt vmcnt(9)
    v_mfma_f32_32x32x16_bf16 v[160:175], a[96:99], v[64:67], v[160:175]
    buffer_load_dwordx4 v[104:107], v20, s[40:43], s63 offen offset:2048 sc1
    v_mfma_f32_32x32x16_bf16 v[176:191], a[100:103], v[64:67], v[176:191]
    s_waitcnt vmcnt(9)
    v_mfma_f32_32x32x16_bf16 v[160:175], a[104:107], v[68:71], v[160:175]
    buffer_load_dwordx4 v[108:111], v20, s[40:43], s63 offen offset:3072 sc1
    v_mfma_f32_32x32x16_bf16 v[176:191], a[108:111], v[68:71], v[176:191]
    s_waitcnt vmcnt(9)
    v_mfma_f32_32x32x16_bf16 v[160:175], a[112:115], v[72:75], v[160:175]
    buffer_load_dwordx4 v[112:115], v3, s[40:43], s63 offen offset:0 sc1
    v_mfma_f32_32x32x16_bf16 v[176:191], a[116:119], v[72:75], v[176:191]
    s_waitcnt vmcnt(9)
    v_mfma_f32_32x32x16_bf16 v[160:175], a[120:123], v[76:79], v[160:175]
    buffer_load_dwordx4 v[116:119], v3, s[40:43], s63 offen offset:1024 sc1
    v_mfma_f32_32x32x16_bf16 v[176:191], a[124:127], v[76:79], v[176:191]
    s_waitcnt vmcnt(9)
    v_mfma_f32_32x32x16_bf16 v[160:175], a[128:131], v[80:83], v[160:175]
    buffer_load_dwordx4 v[120:123], v3, s[40:43], s63 offen offset:2048 sc1
    v_mfma_f32_32x32x16_bf16 v[176:191], a[132:135], v[80:83], v[176:191]
    s_waitcnt vmcnt(9)
    v_mfma_f32_32x32x16_bf16 v[160:175], a[136:139], v[84:87], v[160:175]
    buffer_load_dwordx4 v[124:127], v3, s[40:43], s63 offen offset:3072 sc1
    v_mfma_f32_32x32x16_bf16 v[176:191], a[140:143], v[84:87], v[176:191]
    s_waitcnt vmcnt(9)
    v_mfma_f32_32x32x16_bf16 v[160:175], a[144:147], v[88:91], v[160:175]
    buffer_load_dwordx4 v[24:27], v4, s[40:43], s63 offen offset:0 sc1
    v_mfma_f32_32x32x16_bf16 v[176:191], a[148:151], v[88:91], v[176:191]
    s_waitcnt vmcnt(9)
    v_mfma_f32_32x32x16_bf16 v[160:175], a[152:155], v[92:95], v[160:175]
    buffer_load_dwordx4 v[28:31], v4, s[40:43], s63 offen offset:1024 sc1
    v_mfma_f32_32x32x16_bf16 v[176:191], a[156:159], v[92:95], v[176:191]
    s_waitcnt vmcnt(9)
    v_mfma_f32_32x32x16_bf16 v[160:175], a[160:163], v[96:99], v[160:175]
    buffer_load_dwordx4 v[32:35], v4, s[40:43], s63 offen offset:2048 sc1
    v_mfma_f32_32x32x16_bf16 v[176:191], a[164:167], v[96:99], v[176:191]
    s_waitcnt vmcnt(9)
    v_mfma_f32_32x32x16_bf16 v[160:175], a[168:171], v[100:103], v[160:175]
    buffer_load_dwordx4 v[36:39], v4, s[40:43], s63 offen offset:3072 sc1
    v_mfma_f32_32x32x16_bf16 v[176:191], a[172:175], v[100:103], v[176:191]
    s_waitcnt vmcnt(9)
    v_mfma_f32_32x32x16_bf16 v[160:175], a[176:179], v[104:107], v[160:175]
    v_mfma_f32_32x32x16_bf16 v[176:191], a[180:183], v[104:107], v[176:191]
    s_waitcnt vmcnt(8)
    v_mfma_f32_32x32x16_bf16 v[160:175], a[184:187], v[108:111], v[160:175]
    v_mfma_f32_32x32x16_bf16 v[176:191], a[188:191], v[108:111], v[176:191]
    s_waitcnt vmcnt(7)
    v_mfma_f32_32x32x16_bf16 v[160:175], a[192:195], v[112:115], v[160:175]
    v_mfma_f32_32x32x16_bf16 v[176:191], a[196:199], v[112:115], v[176:191]
    s_waitcnt vmcnt(6)
    v_mfma_f32_32x32x16_bf16 v[160:175], a[200:203], v[116:119], v[160:175]
    v_mfma_f32_32x32x16_bf16 v[176:191], a[204:207], v[116:119], v[176:191]
    s_waitcnt vmcnt(5)
    v_mfma_f32_32x32x16_bf16 v[160:175], a[208:211], v[120:123], v[160:175]
    v_mfma_f32_32x32x16_bf16 v[176:191], a[212:215], v[120:123], v[176:191]
    s_waitcnt vmcnt(4)
    v_mfma_f32_32x32x16_bf16 v[160:175], a[216:219], v[124:127], v[160:175]
    v_mfma_f32_32x32x16_bf16 v[176:191], a[220:223], v[124:127], v[176:191]
    s_waitcnt vmcnt(3)
    v_mfma_f32_32x32x16_bf16 v[160:175], a[224:227], v[24:27], v[160:175]
    v_mfma_f32_32x32x16_bf16 v[176:191], a[228:231], v[24:27], v[176:191]
    s_waitcnt vmcnt(2)
    v_mfma_f32_32x32x16_bf16 v[160:175], a[232:235], v[28:31], v[160:175]
    v_mfma_f32_32x32x16_bf16 v[176:191], a[236:239], v[28:31], v[176:191]
    s_waitcnt vmcnt(1)
    v_mfma_f32_32x32x16_bf16 v[160:175], a[240:243], v[32:35], v[160:175]
    v_mfma_f32_32x32x16_bf16 v[176:191], a[244:247], v[32:35], v[176:191]
    s_waitcnt vmcnt(0)
    v_mfma_f32_32x32x16_bf16 v[160:175], a[248:251], v[36:39], v[160:175]
    v_mfma_f32_32x32x16_bf16 v[176:191], a[252:255], v[36:39], v[176:191]
    s_cmp_lg_u32 s81, 0
    s_cbranch_scc1 L_DX1
    s_nop 8
    ds_write_b128 v9, v[160:163] offset:4096
    ds_write_b128 v9, v[164:167] offset:5120
    ds_write_b128 v9, v[168:171] offset:6144
    ds_write_b128 v9, v[172:175] offset:7168
    ds_write_b128 v9, v[176:179] offset:8192
    ds_write_b128 v9, v[180:183] offset:9216
    ds_write_b128 v9, v[184:187] offset:10240
    ds_write_b128 v9, v[188:191] offset:11264
    v_fmac_f32 v224, v128, v200
    v_fmac_f32 v225, v129, v201
    v_fmac_f32 v226, v130, v202
    v_fmac_f32 v227, v131, v203
    v_fmac_f32 v228, v132, v204
    v_fmac_f32 v229, v133, v205
    v_fmac_f32 v230, v134, v206
    v_fmac_f32 v231, v135, v207
    v_fmac_f32 v232, v136, v208
    v_fmac_f32 v233, v137, v209
    v_fmac_f32 v234, v138, v210
    v_fmac_f32 v235, v139, v211
    v_fmac_f32 v236, v140, v212
    v_fmac_f32 v237, v141, v213
    v_fmac_f32 v238, v142, v214
    v_fmac_f32 v239, v143, v215
    s_branch L_DX2
L_DX1:
    s_nop 9
    ds_write_b128 v9, v[176:179] offset:0
    ds_write_b128 v9, v[180:183] offset:1024
    ds_write_b128 v9, v[184:187] offset:2048
    ds_write_b128 v9, v[188:191] offset:3072
    v_fmac_f32 v224, v160, v200
    v_fmac_f32 v225, v161, v201
    v_fmac_f32 v226, v162, v202
    v_fmac_f32 v227, v163, v203
    v_fmac_f32 v228, v164, v204
    v_fmac_f32 v229, v165, v205
    v_fmac_f32 v230, v166, v206
    v_fmac_f32 v231, v167, v207
    v_fmac_f32 v232, v168, v208
    v_fmac_f32 v233, v169, v209
    v_fmac_f32 v234, v170, v210
    v_fmac_f32 v235, v171, v211
    v_fmac_f32 v236, v172, v212
    v_fmac_f32 v237, v173, v213
    v_fmac_f32 v238, v174, v214
    v_fmac_f32 v239, v175, v215
L_DX2:
    s_waitcnt lgkmcnt(0)
    s_barrier
    ds_read_b128 v[48:51], v10 offset:0
    ds_read_b128 v[52:55], v10 offset:1024
    ds_read_b128 v[56:59], v10 offset:2048
    ds_read_b128 v[60:63], v10 offset:3072
    ds_read_b128 v[64:67], v11 offset:4096
    ds_read_b128 v[68:71], v11 offset:5120
    ds_read_b128 v[72:75], v11 offset:6144
    ds_read_b128 v[76:79], v11 offset:7168
    ds_read_b128 v[80:83], v12 offset:8192
    ds_read_b128 v[84:87], v12 offset:9216
    ds_read_b128 v[88:91], v12 offset:10240
    ds_read_b128 v[92:95], v12 offset:11264
    s_waitcnt lgkmcnt(4)
    v_add_f32 v48, v48, v64
    v_add_f32 v49, v49, v65
    v_add_f32 v50, v50, v66
    v_add_f32 v51, v51, v67
    v_add_f32 v52, v52, v68
    v_add_f32 v53, v53, v69
    v_add_f32 v54, v54, v70
    v_add_f32 v55, v55, v71
    v_add_f32 v56, v56, v72
    v_add_f32 v57, v57, v73
    v_add_f32 v58, v58, v74
    v_add_f32 v59, v59, v75
    v_add_f32 v60, v60, v76
    v_add_f32 v61, v61, v77
    v_add_f32 v62, v62, v78
    v_add_f32 v63, v63, v79
    s_waitcnt lgkmcnt(0)
    v_add_f32 v48, v48, v80
    v_add_f32 v49, v49, v81
    v_add_f32 v50, v50, v82
    v_add_f32 v51, v51, v83
    v_add_f32 v52, v52, v84
    v_add_f32 v53, v53, v85
    v_add_f32 v54, v54, v86
    v_add_f32 v55, v55, v87
    v_add_f32 v56, v56, v88
    v_add_f32 v57, v57, v89
    v_add_f32 v58, v58, v90
    v_add_f32 v59, v59, v91
    v_add_f32 v60, v60, v92
    v_add_f32 v61, v61, v93
    v_add_f32 v62, v62, v94
    v_add_f32 v63, v63, v95
    v_fmac_f32 v224, v48, v200
    v_fmac_f32 v225, v49, v201
    v_fmac_f32 v226, v50, v202
    v_fmac_f32 v227, v51, v203
    v_fmac_f32 v228, v52, v204
    v_fmac_f32 v229, v53, v205
    v_fmac_f32 v230, v54, v206
    v_fmac_f32 v231, v55, v207
    v_fmac_f32 v232, v56, v208
    v_fmac_f32 v233, v57, v209
    v_fmac_f32 v234, v58, v210
    v_fmac_f32 v235, v59, v211
    v_fmac_f32 v236, v60, v212
    v_fmac_f32 v237, v61, v213
    v_fmac_f32 v238, v62, v214
    v_fmac_f32 v239, v63, v215
    v_cvt_pk_bf16_f32 v32, v224, v225
    v_cvt_pk_bf16_f32 v33, v226, v227
    v_cvt_pk_bf16_f32 v34, v228, v229
    v_cvt_pk_bf16_f32 v35, v230, v231
    v_cvt_pk_bf16_f32 v36, v232, v233
    v_cvt_pk_bf16_f32 v37, v234, v235
    v_cvt_pk_bf16_f32 v38, v236, v237
    v_cvt_pk_bf16_f32 v39, v238, v239
    v_permlane32_swap_b32 v32, v34
    v_permlane32_swap_b32 v33, v35
    buffer_store_dwordx4 v[32:35], v7, s[44:47], s68 offen offset:0
    v_permlane32_swap_b32 v36, v38
    v_permlane32_swap_b32 v37, v39
    buffer_store_dwordx4 v[36:39], v7, s[44:47], s68 offen offset:32
    s_or_b32 s9, s2, s4
    s_cmp_lg_u32 s9, 0
    s_cbranch_scc1 L_END
    v_mov_b32 v2, s65
    s_mov_b64 exec, 1
    buffer_store_dword v2, v21, s[40:43], 0 offen
    s_branch L_END
L_ABORT:
    s_mov_b64 exec, 1
    v_mov_b32 v2, 0xdead
    v_mov_b32 v3, 0
    global_store_dword v3, v2, s[36:37]
L_END:
L_END0:
    s_endpgm
L_CODE_END:
.section .rodata,"a"
.p2align 6
.amdhsa_kernel adaLN_cond__mha_block__glu_gated_geglu__prompt_kernel
  .amdhsa_next_free_vgpr 512
  .amdhsa_next_free_sgpr 102
  .amdhsa_accum_offset 256
  .amdhsa_group_segment_fixed_size 0
  .amdhsa_kernarg_size 96
  .amdhsa_user_sgpr_count 2
  .amdhsa_user_sgpr_kernarg_segment_ptr 1
  .amdhsa_system_sgpr_workgroup_id_x 1
.end_amdhsa_kernel
```
